```python
import torch

def _softmax(x, axis=-1):
    return torch.softmax(x, dim=axis)
def _gelu(x):
    return torch.nn.functional.gelu(x, approximate="tanh")
def _silu(x):
    return torch.nn.functional.silu(x)
def _sigmoid(x):
    return torch.sigmoid(x)
def _layernorm(x, axis=-1, eps=1e-5):
    m = x.mean(dim=axis, keepdim=True)
    v = x.var(dim=axis, keepdim=True, unbiased=False)
    return (x - m) / torch.sqrt(v + eps)
def _scatter_add(tgt, idx, src, axis=0):
    return tgt.clone().index_add_(axis, idx, src)
def _segment_sum(src, seg, n):
    out = torch.zeros((n,) + src.shape[1:], dtype=src.dtype)
    return out.index_add_(0, seg, src)
def _pad(x, pw):
    flat = tuple(v for pair in reversed(pw) for v in pair)
    return torch.nn.functional.pad(x, flat)

kernel_name = 'sequential_preLN__sliding_block__moe_arch_mod__prompt'

def setup_inputs():

    _w = (lambda a: (lambda t: t.to(torch.bfloat16) if t.is_floating_point() else t)(torch.as_tensor(a)))
    def _A_setup():
        B, S, D = 1, 2048, 640
        return {
            "x": _w((lambda *s: torch.randn(*s, dtype=torch.bfloat16) * 0.05)(B, S, D)),
            "wqkv": _w((lambda *s: torch.randn(*s, dtype=torch.bfloat16) * 0.05)(D, 3 * D)),
            "wo": _w((lambda *s: torch.randn(*s, dtype=torch.bfloat16) * 0.05)(D, D)),
        }
    _A_in = _A_setup()

    def _B_setup():
        B, S, D, F, C = 1, 2048, 640, 1536, 8
        return {
            "x": _w((lambda *s: torch.randn(*s, dtype=torch.bfloat16) * 0.05)(B, S, D)),
            "w_r": _w((lambda *s: torch.randn(*s, dtype=torch.bfloat16) * 0.05)(D)),
            "w_gate": _w((lambda *s: torch.randn(*s, dtype=torch.bfloat16) * 0.05)(D, F)),
            "w_up": _w((lambda *s: torch.randn(*s, dtype=torch.bfloat16) * 0.05)(D, F)),
            "w_down": _w((lambda *s: torch.randn(*s, dtype=torch.bfloat16) * 0.05)(F, D)),
        }
    _B_in = _B_setup()

    return {
        "A_x": _A_in["x"],
        "A_wqkv": _A_in["wqkv"],
        "A_wo": _A_in["wo"],
        "B_x": _B_in["x"],
        "B_w_r": _B_in["w_r"],
        "B_w_gate": _B_in["w_gate"],
        "B_w_up": _B_in["w_up"],
        "B_w_down": _B_in["w_down"],
    }

def reference(A_x, A_wqkv, A_wo, B_x, B_w_r, B_w_gate, B_w_up, B_w_down):
    def _A_ref(x, wqkv, wo):
        B, S, D = x.shape
        H = 32; Dh = D // H; W = 256
        qkv = (lambda x, *d: x.permute(*d))((x @ wqkv).reshape(B, S, 3, H, Dh), 2, 0, 3, 1, 4)
        q, k, v = qkv[0], qkv[1], qkv[2]
        scores = torch.einsum("bhqd,bhkd->bhqk", q, k) * (Dh ** -0.5)
        idx = torch.arange(S)
        mask = (idx[:, None] - idx[None, :] >= 0) & (idx[:, None] - idx[None, :] < W)
        scores = torch.where(mask[None, None], scores, -1e9)
        p = _softmax(scores, axis=-1)
        o = torch.einsum("bhqk,bhkd->bhqd", p, v)
        return (lambda x, *d: x.permute(*d))(o, 0, 2, 1, 3).reshape(B, S, D) @ wo

    def _B_ref(x, w_r, w_gate, w_up, w_down):
        B, S, D = x.shape
        C = 8
        r = x @ w_r
        idx = torch.argsort(-r, axis=-1)[:, :C]
        idx_e = (lambda x, n, axis: torch.repeat_interleave(x, n, dim=axis))(idx.reshape(B, C, 1), D, axis=2)
        x_sel = (lambda x, i, axis: torch.take_along_dim(x, i, dim=axis))(x, idx_e, axis=1)
        g = _silu(x_sel @ w_gate)
        u = x_sel @ w_up
        y = (g * u) @ w_down
        r_sel = _sigmoid((lambda x, i, axis: torch.take_along_dim(x, i, dim=axis))(r, idx, axis=1))
        y = y * r_sel.reshape(B, C, 1)
        b_off = (torch.arange(B) * S).reshape(B, 1)
        flat_idx = (idx + b_off).reshape(B * C)
        zero = (x * 0.0).reshape(B * S, D)
        upd = _scatter_add(zero, flat_idx, y.reshape(B * C, D), axis=0)
        return x + upd.reshape(B, S, D)

    x = A_x
    h = x + _A_ref(_layernorm(x, axis=-1), A_wqkv, A_wo)
    h2 = h + _B_ref(_layernorm(h, axis=-1), B_w_r, B_w_gate, B_w_up, B_w_down)
    return h2
```

```asm
; @launch grid=(256,1,1) block=(512,1,1) lds=163840
.amdgcn_target "amdgcn-amd-amdhsa--gfx950"
.text
.globl sequential_preLN__sliding_block__moe_arch_mod__prompt_kernel
.p2align 12
.fill 832, 4, 0xbf800000
.p2align 8
.type sequential_preLN__sliding_block__moe_arch_mod__prompt_kernel,@function
sequential_preLN__sliding_block__moe_arch_mod__prompt_kernel:
    s_cmp_ge_u32 s2, 256
    s_cbranch_scc1 L_EXIT
    s_load_dwordx16 s[64:79], s[0:1], 0
    s_load_dwordx4 s[80:83], s[0:1], 64
    s_load_dwordx2 s[84:85], s[0:1], 80
    v_lshrrev_b32 v1, 6, v0
    s_and_b32 s34, s2, 7
    s_lshr_b32 s35, s2, 3
    v_readfirstlane_b32 s33, v1
    s_and_b32 s3, s35, 1
    s_lshl_b32 s36, s34, 1
    s_add_u32 s36, s36, s3
    s_lshr_b32 s37, s35, 1
    v_and_b32 v1, 63, v0
    s_lshr_b32 s3, s34, 1
    s_lshl_b32 s3, s3, 2
    s_and_b32 s42, s34, 1
    s_and_b32 s60, s35, 3
    s_lshr_b32 s62, s35, 2
    s_lshl_b32 s43, s42, 1
    s_add_u32 s43, s43, s60
    s_lshl_b32 s42, s42, 3
    s_cmp_eq_u32 s62, 7
    s_cselect_b32 s60, s43, s60
    s_cselect_b32 s42, 0, s42
    s_add_u32 s60, s60, s3
    s_add_u32 s62, s62, s42
    s_cmp_lt_u32 s33, 4
    s_cbranch_scc1 L_P1_C
    s_sub_u32 s42, s33, 4
    v_lshrrev_b32 v44, 3, v1
    v_mul_u32_u24 v44, 1280, v44
    v_and_b32 v45, 7, v1
    v_lshrrev_b32 v46, 4, v1
    v_xor_b32 v47, v45, v46
    v_lshl_add_u32 v56, v47, 4, v44
    v_xor_b32 v47, 4, v47
    v_lshl_add_u32 v57, v47, 4, v44
    v_and_b32 v45, 15, v1
    v_lshlrev_b32 v47, 2, v46
    v_xor_b32 v45, v45, v47
    v_mul_u32_u24 v44, 3840, v46
    v_lshl_add_u32 v58, v45, 4, v44
    v_xor_b32 v45, 3, v45
    v_lshl_add_u32 v59, v45, 4, v44
    s_lshl_b32 s43, s60, 2
    s_add_u32 s43, s43, s42
    s_mul_i32 s51, s43, 40960
    s_mul_i32 s52, s42, 61440
    s_lshl_b32 s43, s62, 8
    s_add_u32 s52, s52, s43
    s_lshl_b32 s53, s42, 12
    s_mov_b32 s43, 1679844384
    s_mov_b32 s44, 1679844384
    s_bitcmp1_b32 s35, 3
    s_cselect_b32 s43, 1679844384, s43
    s_cselect_b32 s44, 5268512, s44
    s_bitcmp1_b32 s35, 4
    s_cselect_b32 s43, s44, s43
    s_and_b32 s44, s35, 7
    s_lshl_b32 s44, s44, 2
    s_lshr_b32 s43, s43, s44
    s_and_b32 s54, s43, 15
    s_lshr_b32 s43, s34, 1
    s_mul_i32 s43, s43, 1
    s_add_u32 s54, s54, s43
    s_cmp_ge_u32 s35, 20
    s_cselect_b32 s44, 1, 1
    s_bitcmp1_b32 s34, 0
    s_cselect_b32 s43, s44, 0
    s_add_u32 s54, s54, s43
    s_mul_i32 s43, s54, 26
    s_lshr_b32 s43, s43, 8
    s_mul_i32 s43, s43, 10
    s_sub_u32 s54, s54, s43
    s_waitcnt lgkmcnt(0)
    s_load_dword s32, s[84:85], 0
    s_mov_b32 s4, s64
    s_mov_b32 s5, s65
    s_mov_b32 s6, 2621440
    s_mov_b32 s7, 0x20000
    s_mov_b32 s8, s66
    s_mov_b32 s9, s67
    s_mov_b32 s10, 2457600
    s_mov_b32 s11, 0x20000
    s_cmp_eq_u32 s37, 15
    s_cbranch_scc1 L_P1_SPARE
    s_lshl_b32 s43, s54, 7
    s_add_u32 s55, s51, s43
    s_mul_i32 s43, s54, 245760
    s_add_u32 s56, s52, s43
    s_add_u32 m0, s53, 32768
    s_add_u32 s43, s55, 0
    buffer_load_dwordx4 v56, s[4:7], s43 offen lds
    s_add_u32 m0, s53, 98304
    s_add_u32 s43, s56, 0
    buffer_load_dwordx4 v58, s[8:11], s43 offen lds
    s_add_u32 m0, s53, 33792
    s_add_u32 s43, s55, 10240
    buffer_load_dwordx4 v56, s[4:7], s43 offen lds
    s_add_u32 m0, s53, 99328
    s_add_u32 s43, s56, 15360
    buffer_load_dwordx4 v58, s[8:11], s43 offen lds
    s_add_u32 m0, s53, 34816
    s_add_u32 s43, s55, 20480
    buffer_load_dwordx4 v57, s[4:7], s43 offen lds
    s_add_u32 m0, s53, 100352
    s_add_u32 s43, s56, 30720
    buffer_load_dwordx4 v59, s[8:11], s43 offen lds
    s_add_u32 m0, s53, 35840
    s_add_u32 s43, s55, 30720
    buffer_load_dwordx4 v57, s[4:7], s43 offen lds
    s_add_u32 m0, s53, 101376
    s_add_u32 s43, s56, 46080
    buffer_load_dwordx4 v59, s[8:11], s43 offen lds
    s_add_u32 s54, s54, 1
    s_cmp_eq_u32 s54, 10
    s_cselect_b32 s54, 0, s54
    s_lshl_b32 s43, s54, 7
    s_add_u32 s55, s51, s43
    s_mul_i32 s43, s54, 245760
    s_add_u32 s56, s52, s43
    s_add_u32 m0, s53, 49152
    s_add_u32 s43, s55, 0
    buffer_load_dwordx4 v56, s[4:7], s43 offen lds
    s_add_u32 m0, s53, 114688
    s_add_u32 s43, s56, 0
    buffer_load_dwordx4 v58, s[8:11], s43 offen lds
    s_add_u32 m0, s53, 50176
    s_add_u32 s43, s55, 10240
    buffer_load_dwordx4 v56, s[4:7], s43 offen lds
    s_add_u32 m0, s53, 115712
    s_add_u32 s43, s56, 15360
    buffer_load_dwordx4 v58, s[8:11], s43 offen lds
    s_add_u32 m0, s53, 51200
    s_add_u32 s43, s55, 20480
    buffer_load_dwordx4 v57, s[4:7], s43 offen lds
    s_add_u32 m0, s53, 116736
    s_add_u32 s43, s56, 30720
    buffer_load_dwordx4 v59, s[8:11], s43 offen lds
    s_add_u32 m0, s53, 52224
    s_add_u32 s43, s55, 30720
    buffer_load_dwordx4 v57, s[4:7], s43 offen lds
    s_add_u32 m0, s53, 117760
    s_add_u32 s43, s56, 46080
    buffer_load_dwordx4 v59, s[8:11], s43 offen lds
    s_add_u32 s54, s54, 1
    s_cmp_eq_u32 s54, 10
    s_cselect_b32 s54, 0, s54
    s_bfe_u32 s3, s35, 65537
    s_bitcmp1_b32 s35, 0
    s_cselect_b32 s38, 0, 2
    s_add_u32 s3, s3, s38
    s_lshl_b32 s38, s34, 2
    s_add_u32 s38, s38, s3
    s_lshr_b32 s39, s35, 2
    s_getreg_b32 s71, hwreg(HW_REG_XCC_ID, 0, 4)
    s_mov_b32 s70, 0
    s_mov_b32 s16, s84
    s_mov_b32 s17, s85
    s_mov_b32 s18, 17825792
    s_mov_b32 s19, 0x20000
    s_mov_b32 s12, s68
    s_mov_b32 s13, s69
    s_mov_b32 s14, 819200
    s_mov_b32 s15, 0x20000
    s_mov_b32 s20, s80
    s_mov_b32 s21, s81
    s_mov_b32 s22, 2621440
    s_mov_b32 s23, 0x20000
    s_mov_b32 s28, s72
    s_mov_b32 s29, s73
    s_mov_b32 s30, 1280
    s_mov_b32 s31, 0x20000
    s_mov_b32 s40, 0
    s_mov_b32 s41, 0
    s_mov_b32 s61, 0
    s_mov_b32 s24, s74
    s_mov_b32 s25, s75
    s_mov_b32 s26, 0
    s_mov_b32 s27, 0x20000
    s_cmp_ge_u32 s35, 17
    s_cbranch_scc1 RL_1_E
    s_cmp_ge_u32 s35, 12
    s_cbranch_scc1 RL_1_D
    s_mov_b32 s40, 1
    s_mul_i32 s41, s34, 12
    s_add_u32 s41, s41, s35
    s_and_b32 s61, s33, 3
    s_mul_i32 s61, s61, 491520
    s_mov_b32 s26, 1966080
    s_cmp_lt_u32 s33, 4
    s_cbranch_scc1 RL_1_E
    s_mov_b32 s24, s76
    s_mov_b32 s25, s77
    s_branch RL_1_E
RL_1_D:
    s_mov_b32 s40, 2
    s_mul_i32 s41, s34, 5
    s_add_u32 s41, s41, s35
    s_sub_u32 s41, s41, 12
    s_mul_i32 s61, s33, 245760
RL_1_E:
    s_lshl_b32 s3, s41, 5
    s_add_u32 s61, s61, s3
    s_waitcnt lgkmcnt(0)
    s_add_u32 s32, s32, 0x9E3779B9
    s_lshl_b32 s43, s34, 5
    s_add_u32 s43, s43, s35
    s_lshl_b32 s43, s43, 7
    s_add_u32 s43, s43, 98304
    v_mov_b32 v44, s71
    v_mov_b32 v45, s71
    v_mov_b32 v46, s32
    v_mov_b32 v47, s32
    v_mov_b32 v63, 0
    s_cmp_eq_u32 s42, 0
    s_cselect_b32 exec_lo, 1, 0
    s_mov_b32 exec_hi, 0
    buffer_store_dwordx4 v[44:47], v63, s[16:19], s43 offen sc1
    s_mov_b64 exec, -1
    s_lshl_b32 s43, s60, 2
    s_add_u32 s43, s43, s42
    s_lshl_b32 s57, s43, 9
    s_add_u32 s57, s57, 65536
    s_lshl_b32 s43, s34, 2
    s_add_u32 s43, s43, s42
    s_lshl_b32 s43, s43, 10
    s_add_u32 s43, s43, 98304
    v_and_b32 v60, 7, v1
    v_lshl_add_u32 v60, v60, 7, s43
    v_lshl_add_u32 v61, v1, 4, s57
    v_cmp_gt_u32 vcc, 32, v1
    s_nop 1
    v_cndmask_b32 v60, v60, v61, vcc
    s_lshl_b32 s43, s42, 7
    s_add_u32 s43, s43, 131072
    v_lshl_add_u32 v53, v1, 2, s43
    v_mov_b32 v61, 1
    v_mov_b32 v62, 132096
    ds_write_b32 v62, v61
    s_waitcnt lgkmcnt(0)
    v_mul_u32_u24 v5, 26, v1
    v_lshrrev_b32 v5, 8, v5
    v_mul_u32_u24 v4, 10, v5
    v_sub_u32 v4, v1, v4
    v_mul_u32_u24 v5, 1280, v5
    v_lshl_add_u32 v145, v4, 4, v5
    s_and_b32 s3, s35, 3
    s_mul_i32 s3, s3, 6
    s_and_b32 s3, s3, -4
    s_add_u32 s72, s3, s33
    s_mul_i32 s73, s39, 160
    s_mov_b32 s64, -1
    s_mov_b32 s65, 0x3ffff
    s_waitcnt vmcnt(9)
    s_barrier
    s_lshl_b32 s43, s54, 7
    s_add_u32 s55, s51, s43
    s_mul_i32 s43, s54, 245760
    s_add_u32 s56, s52, s43
    s_add_u32 m0, s53, 0
    s_add_u32 s43, s55, 0
    buffer_load_dwordx4 v56, s[4:7], s43 offen lds
    s_add_u32 m0, s53, 65536
    s_add_u32 s43, s56, 0
    buffer_load_dwordx4 v58, s[8:11], s43 offen lds
    s_add_u32 m0, s53, 1024
    s_add_u32 s43, s55, 10240
    buffer_load_dwordx4 v56, s[4:7], s43 offen lds
    s_add_u32 m0, s53, 66560
    s_add_u32 s43, s56, 15360
    buffer_load_dwordx4 v58, s[8:11], s43 offen lds
    s_add_u32 m0, s53, 2048
    s_add_u32 s43, s55, 20480
    buffer_load_dwordx4 v57, s[4:7], s43 offen lds
    s_add_u32 m0, s53, 67584
    s_add_u32 s43, s56, 30720
    buffer_load_dwordx4 v59, s[8:11], s43 offen lds
    s_add_u32 m0, s53, 3072
    s_add_u32 s43, s55, 30720
    buffer_load_dwordx4 v57, s[4:7], s43 offen lds
    s_add_u32 m0, s53, 68608
    s_add_u32 s43, s56, 46080
    buffer_load_dwordx4 v59, s[8:11], s43 offen lds
    s_add_u32 s54, s54, 1
    s_cmp_eq_u32 s54, 10
    s_cselect_b32 s54, 0, s54
    s_waitcnt vmcnt(9)
    s_barrier
    s_lshl_b32 s43, s54, 7
    s_add_u32 s55, s51, s43
    s_mul_i32 s43, s54, 245760
    s_add_u32 s56, s52, s43
    s_add_u32 m0, s53, 16384
    s_add_u32 s43, s55, 0
    buffer_load_dwordx4 v56, s[4:7], s43 offen lds
    s_add_u32 m0, s53, 81920
    s_add_u32 s43, s56, 0
    buffer_load_dwordx4 v58, s[8:11], s43 offen lds
    s_add_u32 m0, s53, 17408
    s_add_u32 s43, s55, 10240
    buffer_load_dwordx4 v56, s[4:7], s43 offen lds
    s_add_u32 m0, s53, 82944
    s_add_u32 s43, s56, 15360
    buffer_load_dwordx4 v58, s[8:11], s43 offen lds
    s_add_u32 m0, s53, 18432
    s_add_u32 s43, s55, 20480
    buffer_load_dwordx4 v57, s[4:7], s43 offen lds
    s_add_u32 m0, s53, 83968
    s_add_u32 s43, s56, 30720
    buffer_load_dwordx4 v59, s[8:11], s43 offen lds
    s_add_u32 m0, s53, 19456
    s_add_u32 s43, s55, 30720
    buffer_load_dwordx4 v57, s[4:7], s43 offen lds
    s_add_u32 m0, s53, 84992
    s_add_u32 s43, s56, 46080
    buffer_load_dwordx4 v59, s[8:11], s43 offen lds
    s_add_u32 s54, s54, 1
    s_cmp_eq_u32 s54, 10
    s_cselect_b32 s54, 0, s54
    s_cmp_eq_u32 s33, 4
    s_cbranch_scc1 L_TC0
    s_cmp_eq_u32 s33, 5
    s_cbranch_scc1 L_TC1
    s_cmp_eq_u32 s33, 6
    s_cbranch_scc1 L_CH_AR
    s_cmp_eq_u32 s33, 7
    s_cbranch_scc1 L_CH_AR
L_CH_AR:
    s_waitcnt vmcnt(8)
    s_barrier
    s_lshl_b32 s43, s54, 7
    s_add_u32 s55, s51, s43
    s_mul_i32 s43, s54, 245760
    s_add_u32 s56, s52, s43
    s_add_u32 m0, s53, 32768
    s_add_u32 s43, s55, 0
    buffer_load_dwordx4 v56, s[4:7], s43 offen lds
    s_add_u32 m0, s53, 98304
    s_add_u32 s43, s56, 0
    buffer_load_dwordx4 v58, s[8:11], s43 offen lds
    s_add_u32 m0, s53, 33792
    s_add_u32 s43, s55, 10240
    buffer_load_dwordx4 v56, s[4:7], s43 offen lds
    s_add_u32 m0, s53, 99328
    s_add_u32 s43, s56, 15360
    buffer_load_dwordx4 v58, s[8:11], s43 offen lds
    s_add_u32 m0, s53, 34816
    s_add_u32 s43, s55, 20480
    buffer_load_dwordx4 v57, s[4:7], s43 offen lds
    s_add_u32 m0, s53, 100352
    s_add_u32 s43, s56, 30720
    buffer_load_dwordx4 v59, s[8:11], s43 offen lds
    s_add_u32 m0, s53, 35840
    s_add_u32 s43, s55, 30720
    buffer_load_dwordx4 v57, s[4:7], s43 offen lds
    s_add_u32 m0, s53, 101376
    s_add_u32 s43, s56, 46080
    buffer_load_dwordx4 v59, s[8:11], s43 offen lds
    s_add_u32 s54, s54, 1
    s_cmp_eq_u32 s54, 10
    s_cselect_b32 s54, 0, s54
    s_waitcnt vmcnt(8)
    s_barrier
    s_lshl_b32 s43, s54, 7
    s_add_u32 s55, s51, s43
    s_mul_i32 s43, s54, 245760
    s_add_u32 s56, s52, s43
    s_add_u32 m0, s53, 49152
    s_add_u32 s43, s55, 0
    buffer_load_dwordx4 v56, s[4:7], s43 offen lds
    s_add_u32 m0, s53, 114688
    s_add_u32 s43, s56, 0
    buffer_load_dwordx4 v58, s[8:11], s43 offen lds
    s_add_u32 m0, s53, 50176
    s_add_u32 s43, s55, 10240
    buffer_load_dwordx4 v56, s[4:7], s43 offen lds
    s_add_u32 m0, s53, 115712
    s_add_u32 s43, s56, 15360
    buffer_load_dwordx4 v58, s[8:11], s43 offen lds
    s_add_u32 m0, s53, 51200
    s_add_u32 s43, s55, 20480
    buffer_load_dwordx4 v57, s[4:7], s43 offen lds
    s_add_u32 m0, s53, 116736
    s_add_u32 s43, s56, 30720
    buffer_load_dwordx4 v59, s[8:11], s43 offen lds
    s_add_u32 m0, s53, 52224
    s_add_u32 s43, s55, 30720
    buffer_load_dwordx4 v57, s[4:7], s43 offen lds
    s_add_u32 m0, s53, 117760
    s_add_u32 s43, s56, 46080
    buffer_load_dwordx4 v59, s[8:11], s43 offen lds
    s_add_u32 s54, s54, 1
    s_cmp_eq_u32 s54, 10
    s_cselect_b32 s54, 0, s54
    s_waitcnt vmcnt(8)
    s_barrier
    s_lshl_b32 s43, s54, 7
    s_add_u32 s55, s51, s43
    s_mul_i32 s43, s54, 245760
    s_add_u32 s56, s52, s43
    s_add_u32 m0, s53, 0
    s_add_u32 s43, s55, 0
    buffer_load_dwordx4 v56, s[4:7], s43 offen lds
    s_add_u32 m0, s53, 65536
    s_add_u32 s43, s56, 0
    buffer_load_dwordx4 v58, s[8:11], s43 offen lds
    s_add_u32 m0, s53, 1024
    s_add_u32 s43, s55, 10240
    buffer_load_dwordx4 v56, s[4:7], s43 offen lds
    s_add_u32 m0, s53, 66560
    s_add_u32 s43, s56, 15360
    buffer_load_dwordx4 v58, s[8:11], s43 offen lds
    s_add_u32 m0, s53, 2048
    s_add_u32 s43, s55, 20480
    buffer_load_dwordx4 v57, s[4:7], s43 offen lds
    s_add_u32 m0, s53, 67584
    s_add_u32 s43, s56, 30720
    buffer_load_dwordx4 v59, s[8:11], s43 offen lds
    s_add_u32 m0, s53, 3072
    s_add_u32 s43, s55, 30720
    buffer_load_dwordx4 v57, s[4:7], s43 offen lds
    s_add_u32 m0, s53, 68608
    s_add_u32 s43, s56, 46080
    buffer_load_dwordx4 v59, s[8:11], s43 offen lds
    s_add_u32 s54, s54, 1
    s_cmp_eq_u32 s54, 10
    s_cselect_b32 s54, 0, s54
    s_lshl_b32 s43, s36, 2
    s_add_u32 s43, s43, s42
    s_lshl_b32 s43, s43, 4
    s_add_u32 s43, s43, s37
    s_lshl_b32 s43, s43, 8
    s_add_u32 s43, s43, 262144
    s_load_dword s46, s[84:85], s43
    s_add_u32 s43, s43, 128
    s_load_dword s46, s[84:85], s43
    s_lshl_b32 s43, s38, 2
    s_add_u32 s43, s43, s42
    s_lshl_b32 s43, s43, 3
    s_add_u32 s43, s43, s39
    s_lshl_b32 s43, s43, 8
    s_add_u32 s43, s43, 524288
    s_load_dword s46, s[84:85], s43
    s_add_u32 s43, s43, 128
    s_load_dword s46, s[84:85], s43
    s_waitcnt vmcnt(8)
    s_barrier
    s_lshl_b32 s43, s54, 7
    s_add_u32 s55, s51, s43
    s_mul_i32 s43, s54, 245760
    s_add_u32 s56, s52, s43
    s_add_u32 m0, s53, 16384
    s_add_u32 s43, s55, 0
    buffer_load_dwordx4 v56, s[4:7], s43 offen lds
    s_add_u32 m0, s53, 81920
    s_add_u32 s43, s56, 0
    buffer_load_dwordx4 v58, s[8:11], s43 offen lds
    s_add_u32 m0, s53, 17408
    s_add_u32 s43, s55, 10240
    buffer_load_dwordx4 v56, s[4:7], s43 offen lds
    s_add_u32 m0, s53, 82944
    s_add_u32 s43, s56, 15360
    buffer_load_dwordx4 v58, s[8:11], s43 offen lds
    s_add_u32 m0, s53, 18432
    s_add_u32 s43, s55, 20480
    buffer_load_dwordx4 v57, s[4:7], s43 offen lds
    s_add_u32 m0, s53, 83968
    s_add_u32 s43, s56, 30720
    buffer_load_dwordx4 v59, s[8:11], s43 offen lds
    s_add_u32 m0, s53, 19456
    s_add_u32 s43, s55, 30720
    buffer_load_dwordx4 v57, s[4:7], s43 offen lds
    s_add_u32 m0, s53, 84992
    s_add_u32 s43, s56, 46080
    buffer_load_dwordx4 v59, s[8:11], s43 offen lds
    s_add_u32 s54, s54, 1
    s_cmp_eq_u32 s54, 10
    s_cselect_b32 s54, 0, s54
    s_lshl_b32 s43, s60, 4
    s_add_u32 s43, s43, s62
    s_lshl_b32 s43, s43, 2
    s_add_u32 s43, s43, s42
    s_lshl_b32 s43, s43, 7
    s_add_u32 s43, s43, 131072
    s_load_dword s46, s[84:85], s43
    s_waitcnt vmcnt(8)
    s_barrier
    s_lshl_b32 s43, s54, 7
    s_add_u32 s55, s51, s43
    s_mul_i32 s43, s54, 245760
    s_add_u32 s56, s52, s43
    s_add_u32 m0, s53, 32768
    s_add_u32 s43, s55, 0
    buffer_load_dwordx4 v56, s[4:7], s43 offen lds
    s_add_u32 m0, s53, 98304
    s_add_u32 s43, s56, 0
    buffer_load_dwordx4 v58, s[8:11], s43 offen lds
    s_add_u32 m0, s53, 33792
    s_add_u32 s43, s55, 10240
    buffer_load_dwordx4 v56, s[4:7], s43 offen lds
    s_add_u32 m0, s53, 99328
    s_add_u32 s43, s56, 15360
    buffer_load_dwordx4 v58, s[8:11], s43 offen lds
    s_add_u32 m0, s53, 34816
    s_add_u32 s43, s55, 20480
    buffer_load_dwordx4 v57, s[4:7], s43 offen lds
    s_add_u32 m0, s53, 100352
    s_add_u32 s43, s56, 30720
    buffer_load_dwordx4 v59, s[8:11], s43 offen lds
    s_add_u32 m0, s53, 35840
    s_add_u32 s43, s55, 30720
    buffer_load_dwordx4 v57, s[4:7], s43 offen lds
    s_add_u32 m0, s53, 101376
    s_add_u32 s43, s56, 46080
    buffer_load_dwordx4 v59, s[8:11], s43 offen lds
    s_add_u32 s54, s54, 1
    s_cmp_eq_u32 s54, 10
    s_cselect_b32 s54, 0, s54
    s_waitcnt vmcnt(8)
    s_barrier
    s_lshl_b32 s43, s54, 7
    s_add_u32 s55, s51, s43
    s_mul_i32 s43, s54, 245760
    s_add_u32 s56, s52, s43
    s_add_u32 m0, s53, 49152
    s_add_u32 s43, s55, 0
    buffer_load_dwordx4 v56, s[4:7], s43 offen lds
    s_add_u32 m0, s53, 114688
    s_add_u32 s43, s56, 0
    buffer_load_dwordx4 v58, s[8:11], s43 offen lds
    s_add_u32 m0, s53, 50176
    s_add_u32 s43, s55, 10240
    buffer_load_dwordx4 v56, s[4:7], s43 offen lds
    s_add_u32 m0, s53, 115712
    s_add_u32 s43, s56, 15360
    buffer_load_dwordx4 v58, s[8:11], s43 offen lds
    s_add_u32 m0, s53, 51200
    s_add_u32 s43, s55, 20480
    buffer_load_dwordx4 v57, s[4:7], s43 offen lds
    s_add_u32 m0, s53, 116736
    s_add_u32 s43, s56, 30720
    buffer_load_dwordx4 v59, s[8:11], s43 offen lds
    s_add_u32 m0, s53, 52224
    s_add_u32 s43, s55, 30720
    buffer_load_dwordx4 v57, s[4:7], s43 offen lds
    s_add_u32 m0, s53, 117760
    s_add_u32 s43, s56, 46080
    buffer_load_dwordx4 v59, s[8:11], s43 offen lds
    s_add_u32 s54, s54, 1
    s_cmp_eq_u32 s54, 10
    s_cselect_b32 s54, 0, s54
    buffer_load_dwordx4 v[8:11], v60, s[16:19], 0 offen sc1
    s_waitcnt vmcnt(9)
    s_barrier
    s_mov_b64 exec, s[64:65]
    s_add_u32 s3, s42, 0
    s_mul_i32 s62, s3, 3200
    s_lshl_b32 s60, s62, 3
    s_add_u32 s60, s60, s73
    s_add_u32 m0, s62, 0
    s_add_u32 s3, s60, 0
    buffer_load_dwordx4 v145, s[12:15], s3 offen lds
    s_add_u32 m0, s62, 800
    s_add_u32 s3, s60, 6400
    buffer_load_dwordx4 v145, s[12:15], s3 offen lds
    s_add_u32 m0, s62, 1600
    s_add_u32 s3, s60, 12800
    buffer_load_dwordx4 v145, s[12:15], s3 offen lds
    s_add_u32 m0, s62, 2400
    s_add_u32 s3, s60, 19200
    buffer_load_dwordx4 v145, s[12:15], s3 offen lds
    s_add_u32 s3, s42, 21
    s_mul_i32 s62, s3, 3200
    s_lshl_b32 s60, s62, 3
    s_add_u32 s60, s60, s73
    s_add_u32 m0, s62, 0
    s_add_u32 s3, s60, 0
    buffer_load_dwordx4 v145, s[12:15], s3 offen lds
    s_add_u32 m0, s62, 800
    s_add_u32 s3, s60, 6400
    buffer_load_dwordx4 v145, s[12:15], s3 offen lds
    s_add_u32 m0, s62, 1600
    s_add_u32 s3, s60, 12800
    buffer_load_dwordx4 v145, s[12:15], s3 offen lds
    s_add_u32 m0, s62, 2400
    s_add_u32 s3, s60, 19200
    buffer_load_dwordx4 v145, s[12:15], s3 offen lds
    s_mov_b64 exec, -1
    s_waitcnt vmcnt(9)
    s_barrier
    s_mov_b32 s58, 50000
    s_waitcnt vmcnt(8)
    s_branch L_P1_SP1
L_P1_SPOLL:
    s_waitcnt vmcnt(0)
L_P1_SP1:
    v_cmp_ne_u32 vcc, s32, v11
    s_cbranch_vccz L_P1_SOK
    buffer_load_dwordx4 v[8:11], v60, s[16:19], 0 offen sc1
    s_sub_u32 s58, s58, 1
    s_cmp_lg_u32 s58, 0
    s_cbranch_scc1 L_P1_SPOLL
    s_waitcnt vmcnt(0)
L_P1_SOK:
    v_cmp_ne_u32 vcc, s71, v8
    s_mov_b32 exec_hi, 0
    ds_write_b32 v53, v8
    ds_write_b32 v53, v9 offset:512
    s_mov_b32 exec_lo, 0
    s_mov_b32 exec_hi, vcc_hi
    v_mov_b32 v61, 0
    ds_write_b32 v62, v61
    s_mov_b64 exec, -1
    s_waitcnt lgkmcnt(0)
    s_barrier
    ds_read_b32 v2, v62
    s_waitcnt lgkmcnt(0)
    v_readfirstlane_b32 s70, v2
    s_branch L_P1_END
L_P1_SPARE:
    s_lshl_b32 s43, s36, 7
    s_lshl_b32 s44, s37, 3
    s_add_u32 s43, s43, s44
    s_lshl_b32 s44, s42, 1
    s_add_u32 s50, s43, s44
    s_mul_i32 s59, s50, 1280
    v_lshrrev_b32 v19, 5, v1
    v_and_b32 v20, 31, v1
    v_mul_u32_u24 v18, 1280, v19
    v_lshl_add_u32 v18, v20, 3, v18
    v_add_u32 v19, s50, v19
    v_lshlrev_b32 v19, 4, v19
    buffer_load_dwordx2 v[8:9], v18, s[4:7], s59 offen offset:0
    buffer_load_dwordx2 v[10:11], v18, s[4:7], s59 offen offset:256
    buffer_load_dwordx2 v[12:13], v18, s[4:7], s59 offen offset:512
    buffer_load_dwordx2 v[14:15], v18, s[4:7], s59 offen offset:768
    buffer_load_dwordx2 v[16:17], v18, s[4:7], s59 offen offset:1024
    s_bfe_u32 s3, s35, 65537
    s_bitcmp1_b32 s35, 0
    s_cselect_b32 s38, 0, 2
    s_add_u32 s3, s3, s38
    s_lshl_b32 s38, s34, 2
    s_add_u32 s38, s38, s3
    s_lshr_b32 s39, s35, 2
    s_getreg_b32 s71, hwreg(HW_REG_XCC_ID, 0, 4)
    s_mov_b32 s70, 0
    s_mov_b32 s16, s84
    s_mov_b32 s17, s85
    s_mov_b32 s18, 17825792
    s_mov_b32 s19, 0x20000
    s_mov_b32 s12, s68
    s_mov_b32 s13, s69
    s_mov_b32 s14, 819200
    s_mov_b32 s15, 0x20000
    s_mov_b32 s20, s80
    s_mov_b32 s21, s81
    s_mov_b32 s22, 2621440
    s_mov_b32 s23, 0x20000
    s_mov_b32 s28, s72
    s_mov_b32 s29, s73
    s_mov_b32 s30, 1280
    s_mov_b32 s31, 0x20000
    s_mov_b32 s40, 0
    s_mov_b32 s41, 0
    s_mov_b32 s61, 0
    s_mov_b32 s24, s74
    s_mov_b32 s25, s75
    s_mov_b32 s26, 0
    s_mov_b32 s27, 0x20000
    s_cmp_ge_u32 s35, 17
    s_cbranch_scc1 RL_2_E
    s_cmp_ge_u32 s35, 12
    s_cbranch_scc1 RL_2_D
    s_mov_b32 s40, 1
    s_mul_i32 s41, s34, 12
    s_add_u32 s41, s41, s35
    s_and_b32 s61, s33, 3
    s_mul_i32 s61, s61, 491520
    s_mov_b32 s26, 1966080
    s_cmp_lt_u32 s33, 4
    s_cbranch_scc1 RL_2_E
    s_mov_b32 s24, s76
    s_mov_b32 s25, s77
    s_branch RL_2_E
RL_2_D:
    s_mov_b32 s40, 2
    s_mul_i32 s41, s34, 5
    s_add_u32 s41, s41, s35
    s_sub_u32 s41, s41, 12
    s_mul_i32 s61, s33, 245760
RL_2_E:
    s_lshl_b32 s3, s41, 5
    s_add_u32 s61, s61, s3
    s_waitcnt lgkmcnt(0)
    s_add_u32 s32, s32, 0x9E3779B9
    s_lshl_b32 s43, s34, 5
    s_add_u32 s43, s43, s35
    s_lshl_b32 s43, s43, 7
    s_add_u32 s43, s43, 98304
    v_mov_b32 v44, s71
    v_mov_b32 v45, s71
    v_mov_b32 v46, s32
    v_mov_b32 v47, s32
    v_mov_b32 v63, 0
    s_cmp_eq_u32 s42, 0
    s_cselect_b32 exec_lo, 1, 0
    s_mov_b32 exec_hi, 0
    buffer_store_dwordx4 v[44:47], v63, s[16:19], s43 offen sc1
    s_mov_b64 exec, -1
    s_nop 0
    v_mov_b32 v44, 0x3f803f80
    s_waitcnt vmcnt(0)
    v_dot2_f32_bf16 v20, v8, v44, 0
    v_dot2_f32_bf16 v21, v8, v8, 0
    v_dot2_f32_bf16 v20, v9, v44, v20
    v_dot2_f32_bf16 v21, v9, v9, v21
    v_dot2_f32_bf16 v20, v10, v44, v20
    v_dot2_f32_bf16 v21, v10, v10, v21
    v_dot2_f32_bf16 v20, v11, v44, v20
    v_dot2_f32_bf16 v21, v11, v11, v21
    v_dot2_f32_bf16 v20, v12, v44, v20
    v_dot2_f32_bf16 v21, v12, v12, v21
    v_dot2_f32_bf16 v20, v13, v44, v20
    v_dot2_f32_bf16 v21, v13, v13, v21
    v_dot2_f32_bf16 v20, v14, v44, v20
    v_dot2_f32_bf16 v21, v14, v14, v21
    v_dot2_f32_bf16 v20, v15, v44, v20
    v_dot2_f32_bf16 v21, v15, v15, v21
    v_dot2_f32_bf16 v20, v16, v44, v20
    v_dot2_f32_bf16 v21, v16, v16, v21
    v_dot2_f32_bf16 v20, v17, v44, v20
    v_dot2_f32_bf16 v21, v17, v17, v21
    s_nop 1
    v_add_f32_dpp v20, v20, v20 row_ror:8 row_mask:0xf bank_mask:0xf
    v_add_f32_dpp v21, v21, v21 row_ror:8 row_mask:0xf bank_mask:0xf
    s_nop 0
    v_add_f32_dpp v20, v20, v20 row_ror:4 row_mask:0xf bank_mask:0xf
    v_add_f32_dpp v21, v21, v21 row_ror:4 row_mask:0xf bank_mask:0xf
    s_nop 0
    v_add_f32_dpp v20, v20, v20 row_ror:2 row_mask:0xf bank_mask:0xf
    v_add_f32_dpp v21, v21, v21 row_ror:2 row_mask:0xf bank_mask:0xf
    s_nop 0
    v_add_f32_dpp v20, v20, v20 row_ror:1 row_mask:0xf bank_mask:0xf
    v_add_f32_dpp v21, v21, v21 row_ror:1 row_mask:0xf bank_mask:0xf
    v_mov_b32 v22, v20
    v_mov_b32 v23, v21
    s_nop 0
    v_permlane16_swap_b32 v20, v22
    v_permlane16_swap_b32 v21, v23
    v_add_f32 v20, v20, v22
    v_add_f32 v21, v21, v23
    v_mul_f32 v24, 0xbacccccd, v20
    v_mov_b32 v22, 0x3727c5ac
    v_fmac_f32 v22, 0x3acccccd, v21
    v_mov_b32 v26, s32
    v_fma_f32 v22, -v24, v24, v22
    v_mov_b32 v27, s32
    v_max_f32 v22, 0x3727c5ac, v22
    v_rsq_f32 v25, v22
    s_mov_b32 s43, 65536
    s_mov_b32 exec_lo, 1
    s_mov_b32 exec_hi, 1
    buffer_store_dwordx4 v[24:27], v19, s[16:19], s43 offen sc1
    s_mov_b64 exec, -1
    s_lshl_b32 s43, s36, 2
    s_add_u32 s43, s43, s42
    s_lshl_b32 s43, s43, 4
    s_add_u32 s43, s43, s37
    s_lshl_b32 s43, s43, 8
    s_add_u32 s43, s43, 262144
    s_load_dword s46, s[84:85], s43
    s_add_u32 s43, s43, 128
    s_load_dword s46, s[84:85], s43
    s_lshl_b32 s43, s38, 2
    s_add_u32 s43, s43, s42
    s_lshl_b32 s43, s43, 3
    s_add_u32 s43, s43, s39
    s_lshl_b32 s43, s43, 8
    s_add_u32 s43, s43, 524288
    s_load_dword s46, s[84:85], s43
    s_add_u32 s43, s43, 128
    s_load_dword s46, s[84:85], s43
    v_mul_u32_u24 v5, 26, v1
    v_lshrrev_b32 v5, 8, v5
    v_mul_u32_u24 v4, 10, v5
    v_sub_u32 v4, v1, v4
    v_mul_u32_u24 v5, 1280, v5
    v_lshl_add_u32 v145, v4, 4, v5
    s_and_b32 s3, s35, 3
    s_mul_i32 s3, s3, 6
    s_and_b32 s3, s3, -4
    s_add_u32 s72, s3, s33
    s_mul_i32 s73, s39, 160
    s_mov_b32 s64, -1
    s_mov_b32 s65, 0x3ffff
    s_barrier
    s_mov_b64 exec, s[64:65]
    s_add_u32 s3, s42, 0
    s_mul_i32 s62, s3, 3200
    s_lshl_b32 s60, s62, 3
    s_add_u32 s60, s60, s73
    s_add_u32 m0, s62, 0
    s_add_u32 s3, s60, 0
    buffer_load_dwordx4 v145, s[12:15], s3 offen lds
    s_add_u32 m0, s62, 800
    s_add_u32 s3, s60, 6400
    buffer_load_dwordx4 v145, s[12:15], s3 offen lds
    s_add_u32 m0, s62, 1600
    s_add_u32 s3, s60, 12800
    buffer_load_dwordx4 v145, s[12:15], s3 offen lds
    s_add_u32 m0, s62, 2400
    s_add_u32 s3, s60, 19200
    buffer_load_dwordx4 v145, s[12:15], s3 offen lds
    s_add_u32 s3, s42, 21
    s_mul_i32 s62, s3, 3200
    s_lshl_b32 s60, s62, 3
    s_add_u32 s60, s60, s73
    s_add_u32 m0, s62, 0
    s_add_u32 s3, s60, 0
    buffer_load_dwordx4 v145, s[12:15], s3 offen lds
    s_add_u32 m0, s62, 800
    s_add_u32 s3, s60, 6400
    buffer_load_dwordx4 v145, s[12:15], s3 offen lds
    s_add_u32 m0, s62, 1600
    s_add_u32 s3, s60, 12800
    buffer_load_dwordx4 v145, s[12:15], s3 offen lds
    s_add_u32 m0, s62, 2400
    s_add_u32 s3, s60, 19200
    buffer_load_dwordx4 v145, s[12:15], s3 offen lds
    s_mov_b64 exec, -1
    s_barrier
    v_mov_b32 v2, 132096
    ds_read_b32 v2, v2
    s_waitcnt lgkmcnt(0)
    v_readfirstlane_b32 s70, v2
    s_branch L_P1_END
    .p2align 12
L_P1_C:
    s_waitcnt lgkmcnt(0)
    s_load_dword s32, s[84:85], 0
    s_mov_b32 s4, s64
    s_mov_b32 s5, s65
    s_mov_b32 s6, 2621440
    s_mov_b32 s7, 0x20000
    s_mov_b32 s8, s66
    s_mov_b32 s9, s67
    s_mov_b32 s10, 2457600
    s_mov_b32 s11, 0x20000
    s_bfe_u32 s3, s35, 65537
    s_bitcmp1_b32 s35, 0
    s_cselect_b32 s38, 0, 2
    s_add_u32 s3, s3, s38
    s_lshl_b32 s38, s34, 2
    s_add_u32 s38, s38, s3
    s_lshr_b32 s39, s35, 2
    s_getreg_b32 s71, hwreg(HW_REG_XCC_ID, 0, 4)
    s_mov_b32 s70, 0
    s_mov_b32 s16, s84
    s_mov_b32 s17, s85
    s_mov_b32 s18, 17825792
    s_mov_b32 s19, 0x20000
    s_mov_b32 s12, s68
    s_mov_b32 s13, s69
    s_mov_b32 s14, 819200
    s_mov_b32 s15, 0x20000
    s_mov_b32 s20, s80
    s_mov_b32 s21, s81
    s_mov_b32 s22, 2621440
    s_mov_b32 s23, 0x20000
    s_mov_b32 s28, s72
    s_mov_b32 s29, s73
    s_mov_b32 s30, 1280
    s_mov_b32 s31, 0x20000
    s_mov_b32 s40, 0
    s_mov_b32 s41, 0
    s_mov_b32 s61, 0
    s_mov_b32 s24, s74
    s_mov_b32 s25, s75
    s_mov_b32 s26, 0
    s_mov_b32 s27, 0x20000
    s_cmp_ge_u32 s35, 17
    s_cbranch_scc1 RL_3_E
    s_cmp_ge_u32 s35, 12
    s_cbranch_scc1 RL_3_D
    s_mov_b32 s40, 1
    s_mul_i32 s41, s34, 12
    s_add_u32 s41, s41, s35
    s_and_b32 s61, s33, 3
    s_mul_i32 s61, s61, 491520
    s_mov_b32 s26, 1966080
    s_cmp_lt_u32 s33, 4
    s_cbranch_scc1 RL_3_E
    s_mov_b32 s24, s76
    s_mov_b32 s25, s77
    s_branch RL_3_E
RL_3_D:
    s_mov_b32 s40, 2
    s_mul_i32 s41, s34, 5
    s_add_u32 s41, s41, s35
    s_sub_u32 s41, s41, 12
    s_mul_i32 s61, s33, 245760
RL_3_E:
    s_lshl_b32 s3, s41, 5
    s_add_u32 s61, s61, s3
    s_and_b32 s42, s35, 3
    s_cmp_lg_u32 s42, s33
    s_cbranch_scc1 L_P1_NOCPF
    s_and_b32 s42, s35, 7
    s_getpc_b64 s[44:45]
L_PC:
    s_mov_b32 s46, L_CODE_END-L_PC
    s_mov_b32 s47, 0x20000
    s_lshl_b32 s42, s42, 13
    v_lshlrev_b32 v2, 7, v1
    buffer_load_dword v255, v2, s[44:47], s42 offen
L_P1_NOCPF:
    s_waitcnt lgkmcnt(0)
    s_add_u32 s32, s32, 0x9E3779B9
    s_cmp_lg_u32 s40, 1
    s_cbranch_scc1 L_P1_NOPOI
    s_lshl_b32 s42, s41, 8
    s_mul_i32 s43, s33, 0x6000
    s_add_u32 s42, s42, s43
    s_add_u32 s42, s42, 917504
    v_mov_b32 v2, -1
    v_lshlrev_b32 v3, 2, v1
    buffer_store_dword v2, v3, s[16:19], s42 offen sc1
L_P1_NOPOI:
    s_cmp_eq_u32 s37, 15
    s_cbranch_scc1 L_P1_CDONE
    s_cmp_ge_u32 s62, 10
    s_cbranch_scc1 L_P1_V
    s_lshl_b32 s43, s36, 7
    s_lshl_b32 s44, s37, 3
    s_add_u32 s43, s43, s44
    s_lshl_b32 s44, s33, 1
    s_add_u32 s50, s43, s44
    s_mul_i32 s59, s50, 1280
    v_lshrrev_b32 v19, 5, v1
    v_and_b32 v20, 31, v1
    v_mul_u32_u24 v18, 1280, v19
    v_lshl_add_u32 v18, v20, 3, v18
    v_add_u32 v19, s50, v19
    v_lshlrev_b32 v19, 4, v19
    s_lshr_b32 s42, s33, 1
    s_and_b32 s43, s33, 1
    v_and_b32 v198, 15, v1
    v_lshrrev_b32 v199, 4, v1
    v_lshrrev_b32 v200, 3, v198
    v_and_b32 v201, 7, v198
    v_lshl_add_u32 v200, v200, 4, v201
    s_lshl_b32 s44, s42, 13
    v_lshl_add_u32 v201, v200, 7, s44
    v_lshrrev_b32 v202, 1, v198
    v_add_u32 v203, 0, v199
    v_xor_b32 v203, v203, v202
    v_lshl_add_u32 v192, v203, 4, v201
    v_add_u32 v203, 4, v199
    v_xor_b32 v203, v203, v202
    v_lshl_add_u32 v193, v203, 4, v201
    v_bfe_u32 v201, v1, 2, 2
    v_and_b32 v202, 3, v1
    v_lshl_add_u32 v203, v199, 3, v201
    v_lshlrev_b32 v203, 8, v203
    v_add_u32 v203, 65536, v203
    v_and_b32 v204, 1, v199
    v_mul_u32_u24 v204, 3, v204
    v_lshlrev_b32 v201, 2, v201
    v_xor_b32 v201, v201, v204
    s_lshl_b32 s44, s43, 3
    v_and_b32 v204, 1, v202
    s_lshl_b32 s48, s42, 2
    s_xor_b32 s49, s48, 4
    s_add_u32 s48, s48, s44
    s_add_u32 s49, s49, s44
    v_add_u32 v205, s48, v202
    v_xor_b32 v205, v205, v201
    v_lshl_add_u32 v194, v205, 4, v203
    v_lshl_add_u32 v194, v204, 3, v194
    v_add_u32 v205, s48, v202
    v_xor_b32 v205, v205, v201
    v_lshl_add_u32 v195, v205, 4, v203
    v_xor_b32 v205, 1, v204
    v_lshl_add_u32 v195, v205, 3, v195
    v_add_u32 v205, s49, v202
    v_xor_b32 v205, v205, v201
    v_lshl_add_u32 v196, v205, 4, v203
    v_lshl_add_u32 v196, v204, 3, v196
    v_add_u32 v205, s49, v202
    v_xor_b32 v205, v205, v201
    v_lshl_add_u32 v197, v205, 4, v203
    v_xor_b32 v205, 1, v204
    v_lshl_add_u32 v197, v205, 3, v197
    s_lshl_b32 s46, s42, 8
    s_add_u32 s46, s46, 131072
    s_lshl_b32 s47, s33, 11
    s_add_u32 s47, s47, 139264
    v_lshl_add_u32 v208, v1, 4, s47
    v_xor_b32 v209, 4096, v208
    v_lshlrev_b32 v206, 4, v200
    v_lshl_add_u32 v206, v199, 11, v206
    v_lshl_add_u32 v207, v200, 2, s46
    s_cmp_ge_u32 s62, 5
    s_cselect_b32 s45, 4030464, 0
    s_cselect_b32 s52, s84, s80
    s_cselect_b32 s53, s85, s81
    s_mov_b32 s54, 17825792
    s_cselect_b32 s54, s54, 2621440
    s_mov_b32 s55, 0x20000
    s_mul_i32 s46, s60, 163840
    s_add_u32 s45, s45, s46
    s_lshl_b32 s46, s62, 15
    s_add_u32 s45, s45, s46
    s_lshl_b32 s46, s43, 14
    s_add_u32 s45, s45, s46
    s_lshl_b32 s46, s42, 10
    s_add_u32 s45, s45, s46
    s_lshl_b32 s46, s42, 13
    s_xor_b32 s47, s46, 8192
    s_add_u32 s47, s47, s45
    s_add_u32 s45, s45, s46
    s_cmp_ge_u32 s62, 5
    s_cselect_b32 s46, 1.0, 0x3ea52b5c
    v_mov_b32 v210, 132096
    v_mov_b32 v200, 0x3f803f80
    v_mov_b32 v201, 0x3f803f80
    v_mov_b32 v202, 0x3f803f80
    v_mov_b32 v203, 0x3f803f80
    s_barrier
    ds_read_b64_tr_b16 v[128:129], v194 offset:32768
    ds_read_b64_tr_b16 v[130:131], v194 offset:33792
    ds_read_b128 v[144:147], v192 offset:32768
    ds_read_b64_tr_b16 v[132:133], v195 offset:32768
    ds_read_b64_tr_b16 v[134:135], v195 offset:33792
    ds_read_b64_tr_b16 v[136:137], v196 offset:32768
    ds_read_b64_tr_b16 v[138:139], v196 offset:33792
    ds_read_b64_tr_b16 v[140:141], v197 offset:32768
    ds_read_b64_tr_b16 v[142:143], v197 offset:33792
    ds_read_b128 v[148:151], v192 offset:33792
    ds_read_b128 v[152:155], v192 offset:36864
    ds_read_b128 v[156:159], v192 offset:37888
    buffer_load_dwordx2 v[8:9], v18, s[4:7], s59 offen offset:0
    buffer_load_dwordx2 v[10:11], v18, s[4:7], s59 offen offset:256
    buffer_load_dwordx2 v[12:13], v18, s[4:7], s59 offen offset:512
    buffer_load_dwordx2 v[14:15], v18, s[4:7], s59 offen offset:768
    buffer_load_dwordx2 v[16:17], v18, s[4:7], s59 offen offset:1024
    s_waitcnt lgkmcnt(9)
    v_mfma_f32_16x16x32_bf16 v[64:67], v[128:131], v[144:147], 0
    ds_read_b64_tr_b16 v[160:161], v194 offset:40960
    v_mfma_f32_16x16x32_bf16 v[40:43], v[128:131], v[200:203], 0
    ds_read_b64_tr_b16 v[162:163], v194 offset:41984
    s_waitcnt lgkmcnt(9)
    v_mfma_f32_16x16x32_bf16 v[68:71], v[132:135], v[144:147], 0
    ds_read_b128 v[176:179], v193 offset:32768
    v_mfma_f32_16x16x32_bf16 v[44:47], v[132:135], v[200:203], 0
    ds_read_b64_tr_b16 v[164:165], v195 offset:40960
    s_waitcnt lgkmcnt(9)
    v_mfma_f32_16x16x32_bf16 v[72:75], v[136:139], v[144:147], 0
    ds_read_b64_tr_b16 v[166:167], v195 offset:41984
    s_waitcnt lgkmcnt(8)
    v_mfma_f32_16x16x32_bf16 v[76:79], v[140:143], v[144:147], 0
    ds_read_b64_tr_b16 v[168:169], v196 offset:40960
    s_waitcnt lgkmcnt(8)
    v_mfma_f32_16x16x32_bf16 v[92:95], v[140:143], v[148:151], 0
    ds_read_b64_tr_b16 v[170:171], v196 offset:41984
    v_mfma_f32_16x16x32_bf16 v[88:91], v[136:139], v[148:151], 0
    ds_read_b64_tr_b16 v[172:173], v197 offset:40960
    v_mfma_f32_16x16x32_bf16 v[84:87], v[132:135], v[148:151], 0
    ds_read_b64_tr_b16 v[174:175], v197 offset:41984
    v_mfma_f32_16x16x32_bf16 v[80:83], v[128:131], v[148:151], 0
    ds_read_b128 v[180:183], v193 offset:33792
    s_waitcnt lgkmcnt(11)
    v_mfma_f32_16x16x32_bf16 v[96:99], v[128:131], v[152:155], 0
    ds_read_b128 v[184:187], v193 offset:36864
    v_mfma_f32_16x16x32_bf16 v[100:103], v[132:135], v[152:155], 0
    ds_read_b128 v[188:191], v193 offset:37888
    v_mfma_f32_16x16x32_bf16 v[104:107], v[136:139], v[152:155], 0
    v_mfma_f32_16x16x32_bf16 v[108:111], v[140:143], v[152:155], 0
    s_waitcnt lgkmcnt(12)
    v_mfma_f32_16x16x32_bf16 v[124:127], v[140:143], v[156:159], 0
    v_mfma_f32_16x16x32_bf16 v[120:123], v[136:139], v[156:159], 0
    v_mfma_f32_16x16x32_bf16 v[116:119], v[132:135], v[156:159], 0
    v_mfma_f32_16x16x32_bf16 v[112:115], v[128:131], v[156:159], 0
    s_waitcnt lgkmcnt(9)
    s_barrier
    v_mfma_f32_16x16x32_bf16 v[64:67], v[160:163], v[176:179], v[64:67]
    ds_read_b64_tr_b16 v[128:129], v194 offset:49152
    v_mfma_f32_16x16x32_bf16 v[40:43], v[160:163], v[200:203], v[40:43]
    ds_read_b64_tr_b16 v[130:131], v194 offset:50176
    s_waitcnt lgkmcnt(9)
    v_mfma_f32_16x16x32_bf16 v[68:71], v[164:167], v[176:179], v[68:71]
    ds_read_b128 v[144:147], v192 offset:49152
    v_mfma_f32_16x16x32_bf16 v[44:47], v[164:167], v[200:203], v[44:47]
    ds_read_b64_tr_b16 v[132:133], v195 offset:49152
    s_waitcnt lgkmcnt(9)
    v_mfma_f32_16x16x32_bf16 v[72:75], v[168:171], v[176:179], v[72:75]
    ds_read_b64_tr_b16 v[134:135], v195 offset:50176
    s_waitcnt lgkmcnt(8)
    v_mfma_f32_16x16x32_bf16 v[76:79], v[172:175], v[176:179], v[76:79]
    ds_read_b64_tr_b16 v[136:137], v196 offset:49152
    s_waitcnt lgkmcnt(8)
    v_mfma_f32_16x16x32_bf16 v[92:95], v[172:175], v[180:183], v[92:95]
    ds_read_b64_tr_b16 v[138:139], v196 offset:50176
    v_mfma_f32_16x16x32_bf16 v[88:91], v[168:171], v[180:183], v[88:91]
    ds_read_b64_tr_b16 v[140:141], v197 offset:49152
    v_mfma_f32_16x16x32_bf16 v[84:87], v[164:167], v[180:183], v[84:87]
    ds_read_b64_tr_b16 v[142:143], v197 offset:50176
    v_mfma_f32_16x16x32_bf16 v[80:83], v[160:163], v[180:183], v[80:83]
    ds_read_b128 v[148:151], v192 offset:50176
    s_waitcnt lgkmcnt(11)
    v_mfma_f32_16x16x32_bf16 v[96:99], v[160:163], v[184:187], v[96:99]
    ds_read_b128 v[152:155], v192 offset:53248
    v_mfma_f32_16x16x32_bf16 v[100:103], v[164:167], v[184:187], v[100:103]
    ds_read_b128 v[156:159], v192 offset:54272
    v_mfma_f32_16x16x32_bf16 v[104:107], v[168:171], v[184:187], v[104:107]
    v_mfma_f32_16x16x32_bf16 v[108:111], v[172:175], v[184:187], v[108:111]
    s_waitcnt lgkmcnt(12)
    v_mfma_f32_16x16x32_bf16 v[124:127], v[172:175], v[188:191], v[124:127]
    v_mfma_f32_16x16x32_bf16 v[120:123], v[168:171], v[188:191], v[120:123]
    v_mfma_f32_16x16x32_bf16 v[116:119], v[164:167], v[188:191], v[116:119]
    v_mfma_f32_16x16x32_bf16 v[112:115], v[160:163], v[188:191], v[112:115]
    s_waitcnt lgkmcnt(9)
    v_mfma_f32_16x16x32_bf16 v[64:67], v[128:131], v[144:147], v[64:67]
    ds_read_b64_tr_b16 v[160:161], v194 offset:57344
    v_mfma_f32_16x16x32_bf16 v[40:43], v[128:131], v[200:203], v[40:43]
    ds_read_b64_tr_b16 v[162:163], v194 offset:58368
    s_waitcnt lgkmcnt(9)
    v_mfma_f32_16x16x32_bf16 v[68:71], v[132:135], v[144:147], v[68:71]
    ds_read_b128 v[176:179], v193 offset:49152
    v_mfma_f32_16x16x32_bf16 v[44:47], v[132:135], v[200:203], v[44:47]
    ds_read_b64_tr_b16 v[164:165], v195 offset:57344
    s_waitcnt lgkmcnt(9)
    v_mfma_f32_16x16x32_bf16 v[72:75], v[136:139], v[144:147], v[72:75]
    ds_read_b64_tr_b16 v[166:167], v195 offset:58368
    s_waitcnt lgkmcnt(8)
    v_mfma_f32_16x16x32_bf16 v[76:79], v[140:143], v[144:147], v[76:79]
    ds_read_b64_tr_b16 v[168:169], v196 offset:57344
    s_waitcnt lgkmcnt(8)
    v_mfma_f32_16x16x32_bf16 v[92:95], v[140:143], v[148:151], v[92:95]
    ds_read_b64_tr_b16 v[170:171], v196 offset:58368
    v_mfma_f32_16x16x32_bf16 v[88:91], v[136:139], v[148:151], v[88:91]
    ds_read_b64_tr_b16 v[172:173], v197 offset:57344
    v_mfma_f32_16x16x32_bf16 v[84:87], v[132:135], v[148:151], v[84:87]
    ds_read_b64_tr_b16 v[174:175], v197 offset:58368
    v_mfma_f32_16x16x32_bf16 v[80:83], v[128:131], v[148:151], v[80:83]
    ds_read_b128 v[180:183], v193 offset:50176
    s_waitcnt lgkmcnt(11)
    v_mfma_f32_16x16x32_bf16 v[96:99], v[128:131], v[152:155], v[96:99]
    ds_read_b128 v[184:187], v193 offset:53248
    v_mfma_f32_16x16x32_bf16 v[100:103], v[132:135], v[152:155], v[100:103]
    ds_read_b128 v[188:191], v193 offset:54272
    v_mfma_f32_16x16x32_bf16 v[104:107], v[136:139], v[152:155], v[104:107]
    v_mfma_f32_16x16x32_bf16 v[108:111], v[140:143], v[152:155], v[108:111]
    s_waitcnt lgkmcnt(12)
    v_mfma_f32_16x16x32_bf16 v[124:127], v[140:143], v[156:159], v[124:127]
    v_mfma_f32_16x16x32_bf16 v[120:123], v[136:139], v[156:159], v[120:123]
    v_mfma_f32_16x16x32_bf16 v[116:119], v[132:135], v[156:159], v[116:119]
    v_mfma_f32_16x16x32_bf16 v[112:115], v[128:131], v[156:159], v[112:115]
    s_waitcnt lgkmcnt(9)
    s_barrier
    v_mfma_f32_16x16x32_bf16 v[64:67], v[160:163], v[176:179], v[64:67]
    ds_read_b64_tr_b16 v[128:129], v194 offset:0
    v_mfma_f32_16x16x32_bf16 v[40:43], v[160:163], v[200:203], v[40:43]
    ds_read_b64_tr_b16 v[130:131], v194 offset:1024
    s_waitcnt lgkmcnt(9)
    v_mfma_f32_16x16x32_bf16 v[68:71], v[164:167], v[176:179], v[68:71]
    ds_read_b128 v[144:147], v192 offset:0
    v_mfma_f32_16x16x32_bf16 v[44:47], v[164:167], v[200:203], v[44:47]
    ds_read_b64_tr_b16 v[132:133], v195 offset:0
    s_waitcnt lgkmcnt(9)
    v_mfma_f32_16x16x32_bf16 v[72:75], v[168:171], v[176:179], v[72:75]
    ds_read_b64_tr_b16 v[134:135], v195 offset:1024
    s_waitcnt lgkmcnt(8)
    v_mfma_f32_16x16x32_bf16 v[76:79], v[172:175], v[176:179], v[76:79]
    ds_read_b64_tr_b16 v[136:137], v196 offset:0
    s_waitcnt lgkmcnt(8)
    v_mfma_f32_16x16x32_bf16 v[92:95], v[172:175], v[180:183], v[92:95]
    ds_read_b64_tr_b16 v[138:139], v196 offset:1024
    v_mfma_f32_16x16x32_bf16 v[88:91], v[168:171], v[180:183], v[88:91]
    ds_read_b64_tr_b16 v[140:141], v197 offset:0
    v_mfma_f32_16x16x32_bf16 v[84:87], v[164:167], v[180:183], v[84:87]
    ds_read_b64_tr_b16 v[142:143], v197 offset:1024
    v_mfma_f32_16x16x32_bf16 v[80:83], v[160:163], v[180:183], v[80:83]
    ds_read_b128 v[148:151], v192 offset:1024
    s_waitcnt lgkmcnt(11)
    v_mfma_f32_16x16x32_bf16 v[96:99], v[160:163], v[184:187], v[96:99]
    ds_read_b128 v[152:155], v192 offset:4096
    v_mfma_f32_16x16x32_bf16 v[100:103], v[164:167], v[184:187], v[100:103]
    ds_read_b128 v[156:159], v192 offset:5120
    v_mfma_f32_16x16x32_bf16 v[104:107], v[168:171], v[184:187], v[104:107]
    v_mfma_f32_16x16x32_bf16 v[108:111], v[172:175], v[184:187], v[108:111]
    s_waitcnt lgkmcnt(12)
    v_mfma_f32_16x16x32_bf16 v[124:127], v[172:175], v[188:191], v[124:127]
    v_mfma_f32_16x16x32_bf16 v[120:123], v[168:171], v[188:191], v[120:123]
    v_mfma_f32_16x16x32_bf16 v[116:119], v[164:167], v[188:191], v[116:119]
    v_mfma_f32_16x16x32_bf16 v[112:115], v[160:163], v[188:191], v[112:115]
    s_waitcnt lgkmcnt(9)
    v_mfma_f32_16x16x32_bf16 v[64:67], v[128:131], v[144:147], v[64:67]
    ds_read_b64_tr_b16 v[160:161], v194 offset:8192
    v_mfma_f32_16x16x32_bf16 v[40:43], v[128:131], v[200:203], v[40:43]
    ds_read_b64_tr_b16 v[162:163], v194 offset:9216
    s_waitcnt lgkmcnt(9)
    v_mfma_f32_16x16x32_bf16 v[68:71], v[132:135], v[144:147], v[68:71]
    ds_read_b128 v[176:179], v193 offset:0
    v_mfma_f32_16x16x32_bf16 v[44:47], v[132:135], v[200:203], v[44:47]
    ds_read_b64_tr_b16 v[164:165], v195 offset:8192
    s_waitcnt lgkmcnt(9)
    v_mfma_f32_16x16x32_bf16 v[72:75], v[136:139], v[144:147], v[72:75]
    ds_read_b64_tr_b16 v[166:167], v195 offset:9216
    s_waitcnt lgkmcnt(8)
    v_mfma_f32_16x16x32_bf16 v[76:79], v[140:143], v[144:147], v[76:79]
    ds_read_b64_tr_b16 v[168:169], v196 offset:8192
    s_waitcnt lgkmcnt(8)
    v_mfma_f32_16x16x32_bf16 v[92:95], v[140:143], v[148:151], v[92:95]
    ds_read_b64_tr_b16 v[170:171], v196 offset:9216
    v_mfma_f32_16x16x32_bf16 v[88:91], v[136:139], v[148:151], v[88:91]
    ds_read_b64_tr_b16 v[172:173], v197 offset:8192
    v_mfma_f32_16x16x32_bf16 v[84:87], v[132:135], v[148:151], v[84:87]
    ds_read_b64_tr_b16 v[174:175], v197 offset:9216
    v_mfma_f32_16x16x32_bf16 v[80:83], v[128:131], v[148:151], v[80:83]
    ds_read_b128 v[180:183], v193 offset:1024
    s_waitcnt lgkmcnt(11)
    v_mfma_f32_16x16x32_bf16 v[96:99], v[128:131], v[152:155], v[96:99]
    ds_read_b128 v[184:187], v193 offset:4096
    v_mfma_f32_16x16x32_bf16 v[100:103], v[132:135], v[152:155], v[100:103]
    ds_read_b128 v[188:191], v193 offset:5120
    v_mfma_f32_16x16x32_bf16 v[104:107], v[136:139], v[152:155], v[104:107]
    v_mfma_f32_16x16x32_bf16 v[108:111], v[140:143], v[152:155], v[108:111]
    s_waitcnt lgkmcnt(12)
    v_mfma_f32_16x16x32_bf16 v[124:127], v[140:143], v[156:159], v[124:127]
    v_mfma_f32_16x16x32_bf16 v[120:123], v[136:139], v[156:159], v[120:123]
    v_mfma_f32_16x16x32_bf16 v[116:119], v[132:135], v[156:159], v[116:119]
    v_mfma_f32_16x16x32_bf16 v[112:115], v[128:131], v[156:159], v[112:115]
    s_waitcnt vmcnt(0)
    v_dot2_f32_bf16 v20, v8, v200, 0
    v_dot2_f32_bf16 v21, v8, v8, 0
    v_dot2_f32_bf16 v20, v9, v200, v20
    v_dot2_f32_bf16 v21, v9, v9, v21
    v_dot2_f32_bf16 v20, v10, v200, v20
    v_dot2_f32_bf16 v21, v10, v10, v21
    v_dot2_f32_bf16 v20, v11, v200, v20
    v_dot2_f32_bf16 v21, v11, v11, v21
    v_dot2_f32_bf16 v20, v12, v200, v20
    v_dot2_f32_bf16 v21, v12, v12, v21
    v_dot2_f32_bf16 v20, v13, v200, v20
    v_dot2_f32_bf16 v21, v13, v13, v21
    v_dot2_f32_bf16 v20, v14, v200, v20
    v_dot2_f32_bf16 v21, v14, v14, v21
    v_dot2_f32_bf16 v20, v15, v200, v20
    v_dot2_f32_bf16 v21, v15, v15, v21
    v_dot2_f32_bf16 v20, v16, v200, v20
    v_dot2_f32_bf16 v21, v16, v16, v21
    v_dot2_f32_bf16 v20, v17, v200, v20
    v_dot2_f32_bf16 v21, v17, v17, v21
    s_nop 1
    v_add_f32_dpp v20, v20, v20 row_ror:8 row_mask:0xf bank_mask:0xf
    v_add_f32_dpp v21, v21, v21 row_ror:8 row_mask:0xf bank_mask:0xf
    s_nop 0
    v_add_f32_dpp v20, v20, v20 row_ror:4 row_mask:0xf bank_mask:0xf
    v_add_f32_dpp v21, v21, v21 row_ror:4 row_mask:0xf bank_mask:0xf
    s_nop 0
    v_add_f32_dpp v20, v20, v20 row_ror:2 row_mask:0xf bank_mask:0xf
    v_add_f32_dpp v21, v21, v21 row_ror:2 row_mask:0xf bank_mask:0xf
    s_nop 0
    v_add_f32_dpp v20, v20, v20 row_ror:1 row_mask:0xf bank_mask:0xf
    v_add_f32_dpp v21, v21, v21 row_ror:1 row_mask:0xf bank_mask:0xf
    v_mov_b32 v22, v20
    v_mov_b32 v23, v21
    s_nop 0
    v_permlane16_swap_b32 v20, v22
    v_permlane16_swap_b32 v21, v23
    v_add_f32 v20, v20, v22
    v_add_f32 v21, v21, v23
    v_mul_f32 v24, 0xbacccccd, v20
    v_mov_b32 v22, 0x3727c5ac
    v_fmac_f32 v22, 0x3acccccd, v21
    v_mov_b32 v26, s32
    v_fma_f32 v22, -v24, v24, v22
    v_mov_b32 v27, s32
    v_max_f32 v22, 0x3727c5ac, v22
    v_rsq_f32 v25, v22
    s_mov_b32 s43, 65536
    s_mov_b32 exec_lo, 1
    s_mov_b32 exec_hi, 1
    buffer_store_dwordx4 v[24:27], v19, s[16:19], s43 offen sc1
    s_mov_b64 exec, -1
    s_waitcnt lgkmcnt(9)
    s_barrier
    v_mfma_f32_16x16x32_bf16 v[64:67], v[160:163], v[176:179], v[64:67]
    ds_read_b64_tr_b16 v[128:129], v194 offset:16384
    v_mfma_f32_16x16x32_bf16 v[40:43], v[160:163], v[200:203], v[40:43]
    ds_read_b64_tr_b16 v[130:131], v194 offset:17408
    s_waitcnt lgkmcnt(9)
    v_mfma_f32_16x16x32_bf16 v[68:71], v[164:167], v[176:179], v[68:71]
    ds_read_b128 v[144:147], v192 offset:16384
    v_mfma_f32_16x16x32_bf16 v[44:47], v[164:167], v[200:203], v[44:47]
    ds_read_b64_tr_b16 v[132:133], v195 offset:16384
    s_waitcnt lgkmcnt(9)
    v_mfma_f32_16x16x32_bf16 v[72:75], v[168:171], v[176:179], v[72:75]
    ds_read_b64_tr_b16 v[134:135], v195 offset:17408
    s_waitcnt lgkmcnt(8)
    v_mfma_f32_16x16x32_bf16 v[76:79], v[172:175], v[176:179], v[76:79]
    ds_read_b64_tr_b16 v[136:137], v196 offset:16384
    s_waitcnt lgkmcnt(8)
    v_mfma_f32_16x16x32_bf16 v[92:95], v[172:175], v[180:183], v[92:95]
    ds_read_b64_tr_b16 v[138:139], v196 offset:17408
    v_mfma_f32_16x16x32_bf16 v[88:91], v[168:171], v[180:183], v[88:91]
    ds_read_b64_tr_b16 v[140:141], v197 offset:16384
    v_mfma_f32_16x16x32_bf16 v[84:87], v[164:167], v[180:183], v[84:87]
    ds_read_b64_tr_b16 v[142:143], v197 offset:17408
    v_mfma_f32_16x16x32_bf16 v[80:83], v[160:163], v[180:183], v[80:83]
    ds_read_b128 v[148:151], v192 offset:17408
    s_waitcnt lgkmcnt(11)
    v_mfma_f32_16x16x32_bf16 v[96:99], v[160:163], v[184:187], v[96:99]
    ds_read_b128 v[152:155], v192 offset:20480
    v_mfma_f32_16x16x32_bf16 v[100:103], v[164:167], v[184:187], v[100:103]
    ds_read_b128 v[156:159], v192 offset:21504
    v_mfma_f32_16x16x32_bf16 v[104:107], v[168:171], v[184:187], v[104:107]
    v_mfma_f32_16x16x32_bf16 v[108:111], v[172:175], v[184:187], v[108:111]
    s_waitcnt lgkmcnt(12)
    v_mfma_f32_16x16x32_bf16 v[124:127], v[172:175], v[188:191], v[124:127]
    v_mfma_f32_16x16x32_bf16 v[120:123], v[168:171], v[188:191], v[120:123]
    v_mfma_f32_16x16x32_bf16 v[116:119], v[164:167], v[188:191], v[116:119]
    v_mfma_f32_16x16x32_bf16 v[112:115], v[160:163], v[188:191], v[112:115]
    s_waitcnt lgkmcnt(9)
    v_mfma_f32_16x16x32_bf16 v[64:67], v[128:131], v[144:147], v[64:67]
    ds_read_b64_tr_b16 v[160:161], v194 offset:24576
    v_mfma_f32_16x16x32_bf16 v[40:43], v[128:131], v[200:203], v[40:43]
    ds_read_b64_tr_b16 v[162:163], v194 offset:25600
    s_waitcnt lgkmcnt(9)
    v_mfma_f32_16x16x32_bf16 v[68:71], v[132:135], v[144:147], v[68:71]
    ds_read_b128 v[176:179], v193 offset:16384
    v_mfma_f32_16x16x32_bf16 v[44:47], v[132:135], v[200:203], v[44:47]
    ds_read_b64_tr_b16 v[164:165], v195 offset:24576
    s_waitcnt lgkmcnt(9)
    v_mfma_f32_16x16x32_bf16 v[72:75], v[136:139], v[144:147], v[72:75]
    ds_read_b64_tr_b16 v[166:167], v195 offset:25600
    s_waitcnt lgkmcnt(8)
    v_mfma_f32_16x16x32_bf16 v[76:79], v[140:143], v[144:147], v[76:79]
    ds_read_b64_tr_b16 v[168:169], v196 offset:24576
    s_waitcnt lgkmcnt(8)
    v_mfma_f32_16x16x32_bf16 v[92:95], v[140:143], v[148:151], v[92:95]
    ds_read_b64_tr_b16 v[170:171], v196 offset:25600
    v_mfma_f32_16x16x32_bf16 v[88:91], v[136:139], v[148:151], v[88:91]
    ds_read_b64_tr_b16 v[172:173], v197 offset:24576
    v_mfma_f32_16x16x32_bf16 v[84:87], v[132:135], v[148:151], v[84:87]
    ds_read_b64_tr_b16 v[174:175], v197 offset:25600
    v_mfma_f32_16x16x32_bf16 v[80:83], v[128:131], v[148:151], v[80:83]
    ds_read_b128 v[180:183], v193 offset:17408
    s_waitcnt lgkmcnt(11)
    v_mfma_f32_16x16x32_bf16 v[96:99], v[128:131], v[152:155], v[96:99]
    ds_read_b128 v[184:187], v193 offset:20480
    v_mfma_f32_16x16x32_bf16 v[100:103], v[132:135], v[152:155], v[100:103]
    ds_read_b128 v[188:191], v193 offset:21504
    v_mfma_f32_16x16x32_bf16 v[104:107], v[136:139], v[152:155], v[104:107]
    v_mfma_f32_16x16x32_bf16 v[108:111], v[140:143], v[152:155], v[108:111]
    s_waitcnt lgkmcnt(12)
    v_mfma_f32_16x16x32_bf16 v[124:127], v[140:143], v[156:159], v[124:127]
    v_mfma_f32_16x16x32_bf16 v[120:123], v[136:139], v[156:159], v[120:123]
    v_mfma_f32_16x16x32_bf16 v[116:119], v[132:135], v[156:159], v[116:119]
    v_mfma_f32_16x16x32_bf16 v[112:115], v[128:131], v[156:159], v[112:115]
    s_waitcnt lgkmcnt(9)
    s_barrier
    v_mfma_f32_16x16x32_bf16 v[64:67], v[160:163], v[176:179], v[64:67]
    ds_read_b64_tr_b16 v[128:129], v194 offset:32768
    v_mfma_f32_16x16x32_bf16 v[40:43], v[160:163], v[200:203], v[40:43]
    ds_read_b64_tr_b16 v[130:131], v194 offset:33792
    s_waitcnt lgkmcnt(9)
    v_mfma_f32_16x16x32_bf16 v[68:71], v[164:167], v[176:179], v[68:71]
    ds_read_b128 v[144:147], v192 offset:32768
    v_mfma_f32_16x16x32_bf16 v[44:47], v[164:167], v[200:203], v[44:47]
    ds_read_b64_tr_b16 v[132:133], v195 offset:32768
    s_waitcnt lgkmcnt(9)
    v_mfma_f32_16x16x32_bf16 v[72:75], v[168:171], v[176:179], v[72:75]
    ds_read_b64_tr_b16 v[134:135], v195 offset:33792
    s_waitcnt lgkmcnt(8)
    v_mfma_f32_16x16x32_bf16 v[76:79], v[172:175], v[176:179], v[76:79]
    ds_read_b64_tr_b16 v[136:137], v196 offset:32768
    s_waitcnt lgkmcnt(8)
    v_mfma_f32_16x16x32_bf16 v[92:95], v[172:175], v[180:183], v[92:95]
    ds_read_b64_tr_b16 v[138:139], v196 offset:33792
    v_mfma_f32_16x16x32_bf16 v[88:91], v[168:171], v[180:183], v[88:91]
    ds_read_b64_tr_b16 v[140:141], v197 offset:32768
    v_mfma_f32_16x16x32_bf16 v[84:87], v[164:167], v[180:183], v[84:87]
    ds_read_b64_tr_b16 v[142:143], v197 offset:33792
    v_mfma_f32_16x16x32_bf16 v[80:83], v[160:163], v[180:183], v[80:83]
    ds_read_b128 v[148:151], v192 offset:33792
    s_waitcnt lgkmcnt(11)
    v_mfma_f32_16x16x32_bf16 v[96:99], v[160:163], v[184:187], v[96:99]
    ds_read_b128 v[152:155], v192 offset:36864
    v_mfma_f32_16x16x32_bf16 v[100:103], v[164:167], v[184:187], v[100:103]
    ds_read_b128 v[156:159], v192 offset:37888
    v_mfma_f32_16x16x32_bf16 v[104:107], v[168:171], v[184:187], v[104:107]
    v_mfma_f32_16x16x32_bf16 v[108:111], v[172:175], v[184:187], v[108:111]
    s_waitcnt lgkmcnt(12)
    v_mfma_f32_16x16x32_bf16 v[124:127], v[172:175], v[188:191], v[124:127]
    v_mfma_f32_16x16x32_bf16 v[120:123], v[168:171], v[188:191], v[120:123]
    v_mfma_f32_16x16x32_bf16 v[116:119], v[164:167], v[188:191], v[116:119]
    v_mfma_f32_16x16x32_bf16 v[112:115], v[160:163], v[188:191], v[112:115]
    s_waitcnt lgkmcnt(9)
    v_mfma_f32_16x16x32_bf16 v[64:67], v[128:131], v[144:147], v[64:67]
    ds_read_b64_tr_b16 v[160:161], v194 offset:40960
    v_mfma_f32_16x16x32_bf16 v[40:43], v[128:131], v[200:203], v[40:43]
    ds_read_b64_tr_b16 v[162:163], v194 offset:41984
    s_waitcnt lgkmcnt(9)
    v_mfma_f32_16x16x32_bf16 v[68:71], v[132:135], v[144:147], v[68:71]
    ds_read_b128 v[176:179], v193 offset:32768
    v_mfma_f32_16x16x32_bf16 v[44:47], v[132:135], v[200:203], v[44:47]
    ds_read_b64_tr_b16 v[164:165], v195 offset:40960
    s_waitcnt lgkmcnt(9)
    v_mfma_f32_16x16x32_bf16 v[72:75], v[136:139], v[144:147], v[72:75]
    ds_read_b64_tr_b16 v[166:167], v195 offset:41984
    s_waitcnt lgkmcnt(8)
    v_mfma_f32_16x16x32_bf16 v[76:79], v[140:143], v[144:147], v[76:79]
    ds_read_b64_tr_b16 v[168:169], v196 offset:40960
    s_waitcnt lgkmcnt(8)
    v_mfma_f32_16x16x32_bf16 v[92:95], v[140:143], v[148:151], v[92:95]
    ds_read_b64_tr_b16 v[170:171], v196 offset:41984
    v_mfma_f32_16x16x32_bf16 v[88:91], v[136:139], v[148:151], v[88:91]
    ds_read_b64_tr_b16 v[172:173], v197 offset:40960
    v_mfma_f32_16x16x32_bf16 v[84:87], v[132:135], v[148:151], v[84:87]
    ds_read_b64_tr_b16 v[174:175], v197 offset:41984
    v_mfma_f32_16x16x32_bf16 v[80:83], v[128:131], v[148:151], v[80:83]
    ds_read_b128 v[180:183], v193 offset:33792
    s_waitcnt lgkmcnt(11)
    v_mfma_f32_16x16x32_bf16 v[96:99], v[128:131], v[152:155], v[96:99]
    ds_read_b128 v[184:187], v193 offset:36864
    v_mfma_f32_16x16x32_bf16 v[100:103], v[132:135], v[152:155], v[100:103]
    ds_read_b128 v[188:191], v193 offset:37888
    v_mfma_f32_16x16x32_bf16 v[104:107], v[136:139], v[152:155], v[104:107]
    v_mfma_f32_16x16x32_bf16 v[108:111], v[140:143], v[152:155], v[108:111]
    s_waitcnt lgkmcnt(12)
    v_mfma_f32_16x16x32_bf16 v[124:127], v[140:143], v[156:159], v[124:127]
    v_mfma_f32_16x16x32_bf16 v[120:123], v[136:139], v[156:159], v[120:123]
    v_mfma_f32_16x16x32_bf16 v[116:119], v[132:135], v[156:159], v[116:119]
    v_mfma_f32_16x16x32_bf16 v[112:115], v[128:131], v[156:159], v[112:115]
    s_waitcnt lgkmcnt(9)
    s_barrier
    v_mfma_f32_16x16x32_bf16 v[64:67], v[160:163], v[176:179], v[64:67]
    ds_read_b64_tr_b16 v[128:129], v194 offset:49152
    v_mfma_f32_16x16x32_bf16 v[40:43], v[160:163], v[200:203], v[40:43]
    ds_read_b64_tr_b16 v[130:131], v194 offset:50176
    s_waitcnt lgkmcnt(9)
    v_mfma_f32_16x16x32_bf16 v[68:71], v[164:167], v[176:179], v[68:71]
    ds_read_b128 v[144:147], v192 offset:49152
    v_mfma_f32_16x16x32_bf16 v[44:47], v[164:167], v[200:203], v[44:47]
    ds_read_b64_tr_b16 v[132:133], v195 offset:49152
    s_waitcnt lgkmcnt(9)
    v_mfma_f32_16x16x32_bf16 v[72:75], v[168:171], v[176:179], v[72:75]
    ds_read_b64_tr_b16 v[134:135], v195 offset:50176
    s_waitcnt lgkmcnt(8)
    v_mfma_f32_16x16x32_bf16 v[76:79], v[172:175], v[176:179], v[76:79]
    ds_read_b64_tr_b16 v[136:137], v196 offset:49152
    s_waitcnt lgkmcnt(8)
    v_mfma_f32_16x16x32_bf16 v[92:95], v[172:175], v[180:183], v[92:95]
    ds_read_b64_tr_b16 v[138:139], v196 offset:50176
    v_mfma_f32_16x16x32_bf16 v[88:91], v[168:171], v[180:183], v[88:91]
    ds_read_b64_tr_b16 v[140:141], v197 offset:49152
    v_mfma_f32_16x16x32_bf16 v[84:87], v[164:167], v[180:183], v[84:87]
    ds_read_b64_tr_b16 v[142:143], v197 offset:50176
    v_mfma_f32_16x16x32_bf16 v[80:83], v[160:163], v[180:183], v[80:83]
    ds_read_b128 v[148:151], v192 offset:50176
    s_waitcnt lgkmcnt(11)
    s_branch L_TO0
L_TC0:
    s_branch L_CH_AR
L_TO0:
    v_mfma_f32_16x16x32_bf16 v[96:99], v[160:163], v[184:187], v[96:99]
    ds_read_b128 v[152:155], v192 offset:53248
    v_mfma_f32_16x16x32_bf16 v[100:103], v[164:167], v[184:187], v[100:103]
    ds_read_b128 v[156:159], v192 offset:54272
    v_mfma_f32_16x16x32_bf16 v[104:107], v[168:171], v[184:187], v[104:107]
    v_mfma_f32_16x16x32_bf16 v[108:111], v[172:175], v[184:187], v[108:111]
    s_waitcnt lgkmcnt(12)
    v_mfma_f32_16x16x32_bf16 v[124:127], v[172:175], v[188:191], v[124:127]
    v_mfma_f32_16x16x32_bf16 v[120:123], v[168:171], v[188:191], v[120:123]
    v_mfma_f32_16x16x32_bf16 v[116:119], v[164:167], v[188:191], v[116:119]
    v_mfma_f32_16x16x32_bf16 v[112:115], v[160:163], v[188:191], v[112:115]
    s_waitcnt lgkmcnt(9)
    v_mfma_f32_16x16x32_bf16 v[64:67], v[128:131], v[144:147], v[64:67]
    ds_read_b64_tr_b16 v[160:161], v194 offset:57344
    v_mfma_f32_16x16x32_bf16 v[40:43], v[128:131], v[200:203], v[40:43]
    ds_read_b64_tr_b16 v[162:163], v194 offset:58368
    s_waitcnt lgkmcnt(9)
    v_mfma_f32_16x16x32_bf16 v[68:71], v[132:135], v[144:147], v[68:71]
    ds_read_b128 v[176:179], v193 offset:49152
    v_mfma_f32_16x16x32_bf16 v[44:47], v[132:135], v[200:203], v[44:47]
    ds_read_b64_tr_b16 v[164:165], v195 offset:57344
    s_waitcnt lgkmcnt(9)
    v_mfma_f32_16x16x32_bf16 v[72:75], v[136:139], v[144:147], v[72:75]
    ds_read_b64_tr_b16 v[166:167], v195 offset:58368
    s_waitcnt lgkmcnt(8)
    v_mfma_f32_16x16x32_bf16 v[76:79], v[140:143], v[144:147], v[76:79]
    ds_read_b64_tr_b16 v[168:169], v196 offset:57344
    s_waitcnt lgkmcnt(8)
    v_mfma_f32_16x16x32_bf16 v[92:95], v[140:143], v[148:151], v[92:95]
    ds_read_b64_tr_b16 v[170:171], v196 offset:58368
    v_mfma_f32_16x16x32_bf16 v[88:91], v[136:139], v[148:151], v[88:91]
    ds_read_b64_tr_b16 v[172:173], v197 offset:57344
    v_mfma_f32_16x16x32_bf16 v[84:87], v[132:135], v[148:151], v[84:87]
    ds_read_b64_tr_b16 v[174:175], v197 offset:58368
    v_mfma_f32_16x16x32_bf16 v[80:83], v[128:131], v[148:151], v[80:83]
    ds_read_b128 v[180:183], v193 offset:50176
    s_waitcnt lgkmcnt(11)
    v_mfma_f32_16x16x32_bf16 v[96:99], v[128:131], v[152:155], v[96:99]
    ds_read_b128 v[184:187], v193 offset:53248
    v_mfma_f32_16x16x32_bf16 v[100:103], v[132:135], v[152:155], v[100:103]
    ds_read_b128 v[188:191], v193 offset:54272
    v_mfma_f32_16x16x32_bf16 v[104:107], v[136:139], v[152:155], v[104:107]
    v_mfma_f32_16x16x32_bf16 v[108:111], v[140:143], v[152:155], v[108:111]
    s_waitcnt lgkmcnt(12)
    v_mfma_f32_16x16x32_bf16 v[124:127], v[140:143], v[156:159], v[124:127]
    v_mfma_f32_16x16x32_bf16 v[120:123], v[136:139], v[156:159], v[120:123]
    v_mfma_f32_16x16x32_bf16 v[116:119], v[132:135], v[156:159], v[116:119]
    v_mfma_f32_16x16x32_bf16 v[112:115], v[128:131], v[156:159], v[112:115]
    s_waitcnt lgkmcnt(9)
    s_barrier
    v_mfma_f32_16x16x32_bf16 v[64:67], v[160:163], v[176:179], v[64:67]
    ds_read_b64_tr_b16 v[128:129], v194 offset:0
    v_mfma_f32_16x16x32_bf16 v[40:43], v[160:163], v[200:203], v[40:43]
    ds_read_b64_tr_b16 v[130:131], v194 offset:1024
    s_waitcnt lgkmcnt(9)
    v_mfma_f32_16x16x32_bf16 v[68:71], v[164:167], v[176:179], v[68:71]
    ds_read_b128 v[144:147], v192 offset:0
    v_mfma_f32_16x16x32_bf16 v[44:47], v[164:167], v[200:203], v[44:47]
    ds_read_b64_tr_b16 v[132:133], v195 offset:0
    s_waitcnt lgkmcnt(9)
    v_mfma_f32_16x16x32_bf16 v[72:75], v[168:171], v[176:179], v[72:75]
    ds_read_b64_tr_b16 v[134:135], v195 offset:1024
    s_waitcnt lgkmcnt(8)
    v_mfma_f32_16x16x32_bf16 v[76:79], v[172:175], v[176:179], v[76:79]
    ds_read_b64_tr_b16 v[136:137], v196 offset:0
    s_waitcnt lgkmcnt(8)
    v_mfma_f32_16x16x32_bf16 v[92:95], v[172:175], v[180:183], v[92:95]
    ds_read_b64_tr_b16 v[138:139], v196 offset:1024
    v_mfma_f32_16x16x32_bf16 v[88:91], v[168:171], v[180:183], v[88:91]
    ds_read_b64_tr_b16 v[140:141], v197 offset:0
    v_mfma_f32_16x16x32_bf16 v[84:87], v[164:167], v[180:183], v[84:87]
    ds_read_b64_tr_b16 v[142:143], v197 offset:1024
    v_mfma_f32_16x16x32_bf16 v[80:83], v[160:163], v[180:183], v[80:83]
    ds_read_b128 v[148:151], v192 offset:1024
    s_waitcnt lgkmcnt(11)
    v_mfma_f32_16x16x32_bf16 v[96:99], v[160:163], v[184:187], v[96:99]
    ds_read_b128 v[152:155], v192 offset:4096
    v_mfma_f32_16x16x32_bf16 v[100:103], v[164:167], v[184:187], v[100:103]
    ds_read_b128 v[156:159], v192 offset:5120
    v_mfma_f32_16x16x32_bf16 v[104:107], v[168:171], v[184:187], v[104:107]
    v_mfma_f32_16x16x32_bf16 v[108:111], v[172:175], v[184:187], v[108:111]
    s_waitcnt lgkmcnt(12)
    v_mfma_f32_16x16x32_bf16 v[124:127], v[172:175], v[188:191], v[124:127]
    v_mfma_f32_16x16x32_bf16 v[120:123], v[168:171], v[188:191], v[120:123]
    v_mfma_f32_16x16x32_bf16 v[116:119], v[164:167], v[188:191], v[116:119]
    v_mfma_f32_16x16x32_bf16 v[112:115], v[160:163], v[188:191], v[112:115]
    s_waitcnt lgkmcnt(9)
    v_mfma_f32_16x16x32_bf16 v[64:67], v[128:131], v[144:147], v[64:67]
    ds_read_b64_tr_b16 v[160:161], v194 offset:8192
    v_mfma_f32_16x16x32_bf16 v[40:43], v[128:131], v[200:203], v[40:43]
    ds_read_b64_tr_b16 v[162:163], v194 offset:9216
    s_waitcnt lgkmcnt(9)
    v_mfma_f32_16x16x32_bf16 v[68:71], v[132:135], v[144:147], v[68:71]
    ds_read_b128 v[176:179], v193 offset:0
    v_mfma_f32_16x16x32_bf16 v[44:47], v[132:135], v[200:203], v[44:47]
    ds_read_b64_tr_b16 v[164:165], v195 offset:8192
    s_waitcnt lgkmcnt(9)
    v_mfma_f32_16x16x32_bf16 v[72:75], v[136:139], v[144:147], v[72:75]
    ds_read_b64_tr_b16 v[166:167], v195 offset:9216
    s_waitcnt lgkmcnt(8)
    v_mfma_f32_16x16x32_bf16 v[76:79], v[140:143], v[144:147], v[76:79]
    ds_read_b64_tr_b16 v[168:169], v196 offset:8192
    s_waitcnt lgkmcnt(8)
    v_mfma_f32_16x16x32_bf16 v[92:95], v[140:143], v[148:151], v[92:95]
    ds_read_b64_tr_b16 v[170:171], v196 offset:9216
    v_mfma_f32_16x16x32_bf16 v[88:91], v[136:139], v[148:151], v[88:91]
    ds_read_b64_tr_b16 v[172:173], v197 offset:8192
    v_mfma_f32_16x16x32_bf16 v[84:87], v[132:135], v[148:151], v[84:87]
    ds_read_b64_tr_b16 v[174:175], v197 offset:9216
    v_mfma_f32_16x16x32_bf16 v[80:83], v[128:131], v[148:151], v[80:83]
    ds_read_b128 v[180:183], v193 offset:1024
    s_waitcnt lgkmcnt(11)
    v_mfma_f32_16x16x32_bf16 v[96:99], v[128:131], v[152:155], v[96:99]
    ds_read_b128 v[184:187], v193 offset:4096
    v_mfma_f32_16x16x32_bf16 v[100:103], v[132:135], v[152:155], v[100:103]
    ds_read_b128 v[188:191], v193 offset:5120
    v_mfma_f32_16x16x32_bf16 v[104:107], v[136:139], v[152:155], v[104:107]
    v_mfma_f32_16x16x32_bf16 v[108:111], v[140:143], v[152:155], v[108:111]
    s_waitcnt lgkmcnt(12)
    v_mfma_f32_16x16x32_bf16 v[124:127], v[140:143], v[156:159], v[124:127]
    v_mfma_f32_16x16x32_bf16 v[120:123], v[136:139], v[156:159], v[120:123]
    v_mfma_f32_16x16x32_bf16 v[116:119], v[132:135], v[156:159], v[116:119]
    v_mfma_f32_16x16x32_bf16 v[112:115], v[128:131], v[156:159], v[112:115]
    s_waitcnt lgkmcnt(9)
    s_barrier
    v_mfma_f32_16x16x32_bf16 v[64:67], v[160:163], v[176:179], v[64:67]
    ds_read_b64_tr_b16 v[128:129], v194 offset:16384
    v_mfma_f32_16x16x32_bf16 v[40:43], v[160:163], v[200:203], v[40:43]
    ds_read_b64_tr_b16 v[130:131], v194 offset:17408
    s_waitcnt lgkmcnt(9)
    v_mfma_f32_16x16x32_bf16 v[68:71], v[164:167], v[176:179], v[68:71]
    ds_read_b128 v[144:147], v192 offset:16384
    v_mfma_f32_16x16x32_bf16 v[44:47], v[164:167], v[200:203], v[44:47]
    ds_read_b64_tr_b16 v[132:133], v195 offset:16384
    s_waitcnt lgkmcnt(9)
    v_mfma_f32_16x16x32_bf16 v[72:75], v[168:171], v[176:179], v[72:75]
    ds_read_b64_tr_b16 v[134:135], v195 offset:17408
    s_waitcnt lgkmcnt(8)
    v_mfma_f32_16x16x32_bf16 v[76:79], v[172:175], v[176:179], v[76:79]
    ds_read_b64_tr_b16 v[136:137], v196 offset:16384
    s_waitcnt lgkmcnt(8)
    v_mfma_f32_16x16x32_bf16 v[92:95], v[172:175], v[180:183], v[92:95]
    ds_read_b64_tr_b16 v[138:139], v196 offset:17408
    v_mfma_f32_16x16x32_bf16 v[88:91], v[168:171], v[180:183], v[88:91]
    ds_read_b64_tr_b16 v[140:141], v197 offset:16384
    v_mfma_f32_16x16x32_bf16 v[84:87], v[164:167], v[180:183], v[84:87]
    ds_read_b64_tr_b16 v[142:143], v197 offset:17408
    v_mfma_f32_16x16x32_bf16 v[80:83], v[160:163], v[180:183], v[80:83]
    ds_read_b128 v[148:151], v192 offset:17408
    s_waitcnt lgkmcnt(11)
    v_mfma_f32_16x16x32_bf16 v[96:99], v[160:163], v[184:187], v[96:99]
    ds_read_b128 v[152:155], v192 offset:20480
    v_mfma_f32_16x16x32_bf16 v[100:103], v[164:167], v[184:187], v[100:103]
    ds_read_b128 v[156:159], v192 offset:21504
    v_mfma_f32_16x16x32_bf16 v[104:107], v[168:171], v[184:187], v[104:107]
    v_mfma_f32_16x16x32_bf16 v[108:111], v[172:175], v[184:187], v[108:111]
    s_waitcnt lgkmcnt(12)
    v_mfma_f32_16x16x32_bf16 v[124:127], v[172:175], v[188:191], v[124:127]
    v_mfma_f32_16x16x32_bf16 v[120:123], v[168:171], v[188:191], v[120:123]
    v_mfma_f32_16x16x32_bf16 v[116:119], v[164:167], v[188:191], v[116:119]
    v_mfma_f32_16x16x32_bf16 v[112:115], v[160:163], v[188:191], v[112:115]
    s_waitcnt lgkmcnt(9)
    v_mfma_f32_16x16x32_bf16 v[64:67], v[128:131], v[144:147], v[64:67]
    ds_read_b64_tr_b16 v[160:161], v194 offset:24576
    v_mfma_f32_16x16x32_bf16 v[40:43], v[128:131], v[200:203], v[40:43]
    ds_read_b64_tr_b16 v[162:163], v194 offset:25600
    s_waitcnt lgkmcnt(9)
    v_mfma_f32_16x16x32_bf16 v[68:71], v[132:135], v[144:147], v[68:71]
    ds_read_b128 v[176:179], v193 offset:16384
    v_mfma_f32_16x16x32_bf16 v[44:47], v[132:135], v[200:203], v[44:47]
    ds_read_b64_tr_b16 v[164:165], v195 offset:24576
    s_waitcnt lgkmcnt(9)
    v_mfma_f32_16x16x32_bf16 v[72:75], v[136:139], v[144:147], v[72:75]
    ds_read_b64_tr_b16 v[166:167], v195 offset:25600
    s_waitcnt lgkmcnt(8)
    v_mfma_f32_16x16x32_bf16 v[76:79], v[140:143], v[144:147], v[76:79]
    ds_read_b64_tr_b16 v[168:169], v196 offset:24576
    s_waitcnt lgkmcnt(8)
    v_mfma_f32_16x16x32_bf16 v[92:95], v[140:143], v[148:151], v[92:95]
    ds_read_b64_tr_b16 v[170:171], v196 offset:25600
    v_mfma_f32_16x16x32_bf16 v[88:91], v[136:139], v[148:151], v[88:91]
    ds_read_b64_tr_b16 v[172:173], v197 offset:24576
    v_mfma_f32_16x16x32_bf16 v[84:87], v[132:135], v[148:151], v[84:87]
    ds_read_b64_tr_b16 v[174:175], v197 offset:25600
    v_mfma_f32_16x16x32_bf16 v[80:83], v[128:131], v[148:151], v[80:83]
    ds_read_b128 v[180:183], v193 offset:17408
    s_waitcnt lgkmcnt(11)
    v_mfma_f32_16x16x32_bf16 v[96:99], v[128:131], v[152:155], v[96:99]
    ds_read_b128 v[184:187], v193 offset:20480
    v_mfma_f32_16x16x32_bf16 v[100:103], v[132:135], v[152:155], v[100:103]
    ds_read_b128 v[188:191], v193 offset:21504
    v_mfma_f32_16x16x32_bf16 v[104:107], v[136:139], v[152:155], v[104:107]
    v_mfma_f32_16x16x32_bf16 v[108:111], v[140:143], v[152:155], v[108:111]
    s_waitcnt lgkmcnt(12)
    v_mfma_f32_16x16x32_bf16 v[124:127], v[140:143], v[156:159], v[124:127]
    v_mfma_f32_16x16x32_bf16 v[120:123], v[136:139], v[156:159], v[120:123]
    v_mfma_f32_16x16x32_bf16 v[116:119], v[132:135], v[156:159], v[116:119]
    v_mfma_f32_16x16x32_bf16 v[112:115], v[128:131], v[156:159], v[112:115]
    s_waitcnt lgkmcnt(9)
    s_barrier
    v_mfma_f32_16x16x32_bf16 v[64:67], v[160:163], v[176:179], v[64:67]
    ds_read_b64_tr_b16 v[128:129], v194 offset:32768
    v_mfma_f32_16x16x32_bf16 v[40:43], v[160:163], v[200:203], v[40:43]
    ds_read_b64_tr_b16 v[130:131], v194 offset:33792
    s_waitcnt lgkmcnt(9)
    v_mfma_f32_16x16x32_bf16 v[68:71], v[164:167], v[176:179], v[68:71]
    ds_read_b128 v[144:147], v192 offset:32768
    v_mfma_f32_16x16x32_bf16 v[44:47], v[164:167], v[200:203], v[44:47]
    ds_read_b64_tr_b16 v[132:133], v195 offset:32768
    s_waitcnt lgkmcnt(9)
    v_mfma_f32_16x16x32_bf16 v[72:75], v[168:171], v[176:179], v[72:75]
    ds_read_b64_tr_b16 v[134:135], v195 offset:33792
    s_waitcnt lgkmcnt(8)
    v_mfma_f32_16x16x32_bf16 v[76:79], v[172:175], v[176:179], v[76:79]
    ds_read_b64_tr_b16 v[136:137], v196 offset:32768
    s_waitcnt lgkmcnt(8)
    v_mfma_f32_16x16x32_bf16 v[92:95], v[172:175], v[180:183], v[92:95]
    ds_read_b64_tr_b16 v[138:139], v196 offset:33792
    v_mfma_f32_16x16x32_bf16 v[88:91], v[168:171], v[180:183], v[88:91]
    ds_read_b64_tr_b16 v[140:141], v197 offset:32768
    v_mfma_f32_16x16x32_bf16 v[84:87], v[164:167], v[180:183], v[84:87]
    ds_read_b64_tr_b16 v[142:143], v197 offset:33792
    v_mfma_f32_16x16x32_bf16 v[80:83], v[160:163], v[180:183], v[80:83]
    ds_read_b128 v[148:151], v192 offset:33792
    s_waitcnt lgkmcnt(11)
    v_mfma_f32_16x16x32_bf16 v[96:99], v[160:163], v[184:187], v[96:99]
    ds_read_b128 v[152:155], v192 offset:36864
    v_mfma_f32_16x16x32_bf16 v[100:103], v[164:167], v[184:187], v[100:103]
    ds_read_b128 v[156:159], v192 offset:37888
    v_mfma_f32_16x16x32_bf16 v[104:107], v[168:171], v[184:187], v[104:107]
    v_mfma_f32_16x16x32_bf16 v[108:111], v[172:175], v[184:187], v[108:111]
    s_waitcnt lgkmcnt(12)
    v_mfma_f32_16x16x32_bf16 v[124:127], v[172:175], v[188:191], v[124:127]
    v_mfma_f32_16x16x32_bf16 v[120:123], v[168:171], v[188:191], v[120:123]
    v_mfma_f32_16x16x32_bf16 v[116:119], v[164:167], v[188:191], v[116:119]
    v_mfma_f32_16x16x32_bf16 v[112:115], v[160:163], v[188:191], v[112:115]
    s_waitcnt lgkmcnt(9)
    v_mfma_f32_16x16x32_bf16 v[64:67], v[128:131], v[144:147], v[64:67]
    ds_read_b64_tr_b16 v[160:161], v194 offset:40960
    v_mfma_f32_16x16x32_bf16 v[40:43], v[128:131], v[200:203], v[40:43]
    ds_read_b64_tr_b16 v[162:163], v194 offset:41984
    s_waitcnt lgkmcnt(9)
    v_mfma_f32_16x16x32_bf16 v[68:71], v[132:135], v[144:147], v[68:71]
    ds_read_b128 v[176:179], v193 offset:32768
    v_mfma_f32_16x16x32_bf16 v[44:47], v[132:135], v[200:203], v[44:47]
    ds_read_b64_tr_b16 v[164:165], v195 offset:40960
    s_waitcnt lgkmcnt(9)
    v_mfma_f32_16x16x32_bf16 v[72:75], v[136:139], v[144:147], v[72:75]
    ds_read_b64_tr_b16 v[166:167], v195 offset:41984
    s_waitcnt lgkmcnt(8)
    v_mfma_f32_16x16x32_bf16 v[76:79], v[140:143], v[144:147], v[76:79]
    ds_read_b64_tr_b16 v[168:169], v196 offset:40960
    s_waitcnt lgkmcnt(8)
    v_mfma_f32_16x16x32_bf16 v[92:95], v[140:143], v[148:151], v[92:95]
    ds_read_b64_tr_b16 v[170:171], v196 offset:41984
    v_mfma_f32_16x16x32_bf16 v[88:91], v[136:139], v[148:151], v[88:91]
    ds_read_b64_tr_b16 v[172:173], v197 offset:40960
    v_mfma_f32_16x16x32_bf16 v[84:87], v[132:135], v[148:151], v[84:87]
    ds_read_b64_tr_b16 v[174:175], v197 offset:41984
    v_mfma_f32_16x16x32_bf16 v[80:83], v[128:131], v[148:151], v[80:83]
    ds_read_b128 v[180:183], v193 offset:33792
    s_waitcnt lgkmcnt(11)
    v_mfma_f32_16x16x32_bf16 v[96:99], v[128:131], v[152:155], v[96:99]
    ds_read_b128 v[184:187], v193 offset:36864
    v_mfma_f32_16x16x32_bf16 v[100:103], v[132:135], v[152:155], v[100:103]
    ds_read_b128 v[188:191], v193 offset:37888
    v_mfma_f32_16x16x32_bf16 v[104:107], v[136:139], v[152:155], v[104:107]
    v_mfma_f32_16x16x32_bf16 v[108:111], v[140:143], v[152:155], v[108:111]
    s_waitcnt lgkmcnt(12)
    v_mfma_f32_16x16x32_bf16 v[124:127], v[140:143], v[156:159], v[124:127]
    v_mfma_f32_16x16x32_bf16 v[120:123], v[136:139], v[156:159], v[120:123]
    v_mfma_f32_16x16x32_bf16 v[116:119], v[132:135], v[156:159], v[116:119]
    v_mfma_f32_16x16x32_bf16 v[112:115], v[128:131], v[156:159], v[112:115]
    s_waitcnt lgkmcnt(9)
    s_barrier
    v_mfma_f32_16x16x32_bf16 v[64:67], v[160:163], v[176:179], v[64:67]
    ds_read_b64_tr_b16 v[128:129], v194 offset:49152
    v_mfma_f32_16x16x32_bf16 v[40:43], v[160:163], v[200:203], v[40:43]
    ds_read_b64_tr_b16 v[130:131], v194 offset:50176
    s_waitcnt lgkmcnt(9)
    v_mfma_f32_16x16x32_bf16 v[68:71], v[164:167], v[176:179], v[68:71]
    ds_read_b128 v[144:147], v192 offset:49152
    v_mfma_f32_16x16x32_bf16 v[44:47], v[164:167], v[200:203], v[44:47]
    ds_read_b64_tr_b16 v[132:133], v195 offset:49152
    s_waitcnt lgkmcnt(9)
    v_mfma_f32_16x16x32_bf16 v[72:75], v[168:171], v[176:179], v[72:75]
    ds_read_b64_tr_b16 v[134:135], v195 offset:50176
    s_waitcnt lgkmcnt(8)
    v_mfma_f32_16x16x32_bf16 v[76:79], v[172:175], v[176:179], v[76:79]
    ds_read_b64_tr_b16 v[136:137], v196 offset:49152
    s_waitcnt lgkmcnt(8)
    v_mfma_f32_16x16x32_bf16 v[92:95], v[172:175], v[180:183], v[92:95]
    ds_read_b64_tr_b16 v[138:139], v196 offset:50176
    v_mfma_f32_16x16x32_bf16 v[88:91], v[168:171], v[180:183], v[88:91]
    ds_read_b64_tr_b16 v[140:141], v197 offset:49152
    v_mfma_f32_16x16x32_bf16 v[84:87], v[164:167], v[180:183], v[84:87]
    ds_read_b64_tr_b16 v[142:143], v197 offset:50176
    v_mfma_f32_16x16x32_bf16 v[80:83], v[160:163], v[180:183], v[80:83]
    ds_read_b128 v[148:151], v192 offset:50176
    s_waitcnt lgkmcnt(11)
    v_mfma_f32_16x16x32_bf16 v[96:99], v[160:163], v[184:187], v[96:99]
    ds_read_b128 v[152:155], v192 offset:53248
    v_mfma_f32_16x16x32_bf16 v[100:103], v[164:167], v[184:187], v[100:103]
    ds_read_b128 v[156:159], v192 offset:54272
    v_mfma_f32_16x16x32_bf16 v[104:107], v[168:171], v[184:187], v[104:107]
    v_mfma_f32_16x16x32_bf16 v[108:111], v[172:175], v[184:187], v[108:111]
    s_waitcnt lgkmcnt(12)
    v_mfma_f32_16x16x32_bf16 v[124:127], v[172:175], v[188:191], v[124:127]
    v_mfma_f32_16x16x32_bf16 v[120:123], v[168:171], v[188:191], v[120:123]
    v_mfma_f32_16x16x32_bf16 v[116:119], v[164:167], v[188:191], v[116:119]
    v_mfma_f32_16x16x32_bf16 v[112:115], v[160:163], v[188:191], v[112:115]
    s_waitcnt lgkmcnt(9)
    v_mfma_f32_16x16x32_bf16 v[64:67], v[128:131], v[144:147], v[64:67]
    ds_read_b64_tr_b16 v[160:161], v194 offset:57344
    v_mfma_f32_16x16x32_bf16 v[40:43], v[128:131], v[200:203], v[40:43]
    ds_read_b64_tr_b16 v[162:163], v194 offset:58368
    s_waitcnt lgkmcnt(9)
    v_mfma_f32_16x16x32_bf16 v[68:71], v[132:135], v[144:147], v[68:71]
    ds_read_b64_tr_b16 v[164:165], v195 offset:57344
    v_mfma_f32_16x16x32_bf16 v[44:47], v[132:135], v[200:203], v[44:47]
    ds_read_b64_tr_b16 v[166:167], v195 offset:58368
    s_waitcnt lgkmcnt(9)
    v_mfma_f32_16x16x32_bf16 v[72:75], v[136:139], v[144:147], v[72:75]
    ds_read_b128 v[176:179], v193 offset:49152
    s_waitcnt lgkmcnt(8)
    v_mfma_f32_16x16x32_bf16 v[76:79], v[140:143], v[144:147], v[76:79]
    ds_read_b128 v[180:183], v193 offset:50176
    s_waitcnt lgkmcnt(8)
    v_mfma_f32_16x16x32_bf16 v[92:95], v[140:143], v[148:151], v[92:95]
    ds_read_b128 v[184:187], v193 offset:53248
    v_mfma_f32_16x16x32_bf16 v[88:91], v[136:139], v[148:151], v[88:91]
    ds_read_b128 v[188:191], v193 offset:54272
    v_mfma_f32_16x16x32_bf16 v[84:87], v[132:135], v[148:151], v[84:87]
    ds_read_b64_tr_b16 v[168:169], v196 offset:57344
    v_mfma_f32_16x16x32_bf16 v[80:83], v[128:131], v[148:151], v[80:83]
    ds_read_b64_tr_b16 v[170:171], v196 offset:58368
    s_waitcnt lgkmcnt(11)
    v_mfma_f32_16x16x32_bf16 v[96:99], v[128:131], v[152:155], v[96:99]
    ds_read_b64_tr_b16 v[172:173], v197 offset:57344
    v_mfma_f32_16x16x32_bf16 v[100:103], v[132:135], v[152:155], v[100:103]
    ds_read_b64_tr_b16 v[174:175], v197 offset:58368
    v_mfma_f32_16x16x32_bf16 v[104:107], v[136:139], v[152:155], v[104:107]
    v_mfma_f32_16x16x32_bf16 v[108:111], v[140:143], v[152:155], v[108:111]
    s_waitcnt lgkmcnt(12)
    v_mfma_f32_16x16x32_bf16 v[124:127], v[140:143], v[156:159], v[124:127]
    v_mfma_f32_16x16x32_bf16 v[120:123], v[136:139], v[156:159], v[120:123]
    v_mfma_f32_16x16x32_bf16 v[116:119], v[132:135], v[156:159], v[116:119]
    v_mfma_f32_16x16x32_bf16 v[112:115], v[128:131], v[156:159], v[112:115]
    s_waitcnt lgkmcnt(10)
    v_mfma_f32_16x16x32_bf16 v[40:43], v[160:163], v[200:203], v[40:43]
    s_waitcnt lgkmcnt(8)
    v_mfma_f32_16x16x32_bf16 v[44:47], v[164:167], v[200:203], v[44:47]
    s_waitcnt lgkmcnt(7)
    v_mfma_f32_16x16x32_bf16 v[64:67], v[160:163], v[176:179], v[64:67]
    v_mfma_f32_16x16x32_bf16 v[68:71], v[164:167], v[176:179], v[68:71]
    s_nop 2
    ds_write_b128 v208, v[40:43] offset:0
    s_nop 0
    ds_write_b128 v208, v[44:47] offset:1024
    s_waitcnt lgkmcnt(8)
    v_mfma_f32_16x16x32_bf16 v[84:87], v[164:167], v[180:183], v[84:87]
    v_mfma_f32_16x16x32_bf16 v[80:83], v[160:163], v[180:183], v[80:83]
    s_waitcnt lgkmcnt(7)
    v_mfma_f32_16x16x32_bf16 v[96:99], v[160:163], v[184:187], v[96:99]
    v_mfma_f32_16x16x32_bf16 v[100:103], v[164:167], v[184:187], v[100:103]
    s_waitcnt lgkmcnt(6)
    v_mfma_f32_16x16x32_bf16 v[116:119], v[164:167], v[188:191], v[116:119]
    v_mfma_f32_16x16x32_bf16 v[112:115], v[160:163], v[188:191], v[112:115]
    s_waitcnt lgkmcnt(0)
    s_barrier
    ds_read_b128 v[48:51], v209 offset:0
    ds_read_b128 v[52:55], v209 offset:1024
    ds_read_b32 v8, v207 offset:0
    ds_read_b32 v24, v207 offset:512
    v_mfma_f32_16x16x32_bf16 v[124:127], v[172:175], v[188:191], v[124:127]
    ds_read_b32 v9, v207 offset:32
    v_mfma_f32_16x16x32_bf16 v[120:123], v[168:171], v[188:191], v[120:123]
    ds_read_b32 v25, v207 offset:544
    v_mfma_f32_16x16x32_bf16 v[104:107], v[168:171], v[184:187], v[104:107]
    ds_read_b32 v10, v207 offset:128
    v_mfma_f32_16x16x32_bf16 v[108:111], v[172:175], v[184:187], v[108:111]
    ds_read_b32 v26, v207 offset:640
    v_mfma_f32_16x16x32_bf16 v[92:95], v[172:175], v[180:183], v[92:95]
    ds_read_b32 v11, v207 offset:160
    v_mfma_f32_16x16x32_bf16 v[88:91], v[168:171], v[180:183], v[88:91]
    ds_read_b32 v27, v207 offset:672
    v_mfma_f32_16x16x32_bf16 v[72:75], v[168:171], v[176:179], v[72:75]
    ds_read_b32 v210, v210
    v_mfma_f32_16x16x32_bf16 v[76:79], v[172:175], v[176:179], v[76:79]
    s_waitcnt lgkmcnt(7)
    v_mul_f32 v24, s46, v24
    v_pk_fma_f32 v[64:65], v[40:41], v[8:9], v[64:65] op_sel:[0,0,0] op_sel_hi:[1,0,1]
    v_pk_fma_f32 v[66:67], v[42:43], v[8:9], v[66:67] op_sel:[0,0,0] op_sel_hi:[1,0,1]
    v_pk_mul_f32 v[64:65], v[64:65], v[24:25] op_sel:[0,0] op_sel_hi:[1,0]
    v_pk_mul_f32 v[66:67], v[66:67], v[24:25] op_sel:[0,0] op_sel_hi:[1,0]
    v_pk_fma_f32 v[68:69], v[44:45], v[8:9], v[68:69] op_sel:[0,0,0] op_sel_hi:[1,0,1]
    v_pk_fma_f32 v[70:71], v[46:47], v[8:9], v[70:71] op_sel:[0,0,0] op_sel_hi:[1,0,1]
    v_pk_mul_f32 v[68:69], v[68:69], v[24:25] op_sel:[0,0] op_sel_hi:[1,0]
    v_pk_mul_f32 v[70:71], v[70:71], v[24:25] op_sel:[0,0] op_sel_hi:[1,0]
    v_cvt_pk_bf16_f32 v56, v64, v65
    v_cvt_pk_bf16_f32 v57, v66, v67
    v_cvt_pk_bf16_f32 v58, v68, v69
    v_cvt_pk_bf16_f32 v59, v70, v71
    buffer_store_dwordx4 v[56:59], v206, s[52:55], s45 offen offset:0 sc1
    s_waitcnt lgkmcnt(5)
    v_mul_f32 v25, s46, v25
    v_pk_fma_f32 v[80:81], v[40:41], v[8:9], v[80:81] op_sel:[0,1,0] op_sel_hi:[1,1,1]
    v_pk_fma_f32 v[82:83], v[42:43], v[8:9], v[82:83] op_sel:[0,1,0] op_sel_hi:[1,1,1]
    v_pk_mul_f32 v[80:81], v[80:81], v[24:25] op_sel:[0,1] op_sel_hi:[1,1]
    v_pk_mul_f32 v[82:83], v[82:83], v[24:25] op_sel:[0,1] op_sel_hi:[1,1]
    v_pk_fma_f32 v[84:85], v[44:45], v[8:9], v[84:85] op_sel:[0,1,0] op_sel_hi:[1,1,1]
    v_pk_fma_f32 v[86:87], v[46:47], v[8:9], v[86:87] op_sel:[0,1,0] op_sel_hi:[1,1,1]
    v_pk_mul_f32 v[84:85], v[84:85], v[24:25] op_sel:[0,1] op_sel_hi:[1,1]
    v_pk_mul_f32 v[86:87], v[86:87], v[24:25] op_sel:[0,1] op_sel_hi:[1,1]
    v_cvt_pk_bf16_f32 v60, v80, v81
    v_cvt_pk_bf16_f32 v61, v82, v83
    v_cvt_pk_bf16_f32 v62, v84, v85
    v_cvt_pk_bf16_f32 v63, v86, v87
    buffer_store_dwordx4 v[60:63], v206, s[52:55], s45 offen offset:128 sc1
    s_waitcnt lgkmcnt(3)
    v_mul_f32 v26, s46, v26
    v_pk_fma_f32 v[96:97], v[40:41], v[10:11], v[96:97] op_sel:[0,0,0] op_sel_hi:[1,0,1]
    v_pk_fma_f32 v[98:99], v[42:43], v[10:11], v[98:99] op_sel:[0,0,0] op_sel_hi:[1,0,1]
    v_pk_mul_f32 v[96:97], v[96:97], v[26:27] op_sel:[0,0] op_sel_hi:[1,0]
    v_pk_mul_f32 v[98:99], v[98:99], v[26:27] op_sel:[0,0] op_sel_hi:[1,0]
    v_pk_fma_f32 v[100:101], v[44:45], v[10:11], v[100:101] op_sel:[0,0,0] op_sel_hi:[1,0,1]
    v_pk_fma_f32 v[102:103], v[46:47], v[10:11], v[102:103] op_sel:[0,0,0] op_sel_hi:[1,0,1]
    v_pk_mul_f32 v[100:101], v[100:101], v[26:27] op_sel:[0,0] op_sel_hi:[1,0]
    v_pk_mul_f32 v[102:103], v[102:103], v[26:27] op_sel:[0,0] op_sel_hi:[1,0]
    v_cvt_pk_bf16_f32 v56, v96, v97
    v_cvt_pk_bf16_f32 v57, v98, v99
    v_cvt_pk_bf16_f32 v58, v100, v101
    v_cvt_pk_bf16_f32 v59, v102, v103
    buffer_store_dwordx4 v[56:59], v206, s[52:55], s45 offen offset:512 sc1
    s_waitcnt lgkmcnt(1)
    v_mul_f32 v27, s46, v27
    v_pk_fma_f32 v[112:113], v[40:41], v[10:11], v[112:113] op_sel:[0,1,0] op_sel_hi:[1,1,1]
    v_pk_fma_f32 v[114:115], v[42:43], v[10:11], v[114:115] op_sel:[0,1,0] op_sel_hi:[1,1,1]
    v_pk_mul_f32 v[112:113], v[112:113], v[26:27] op_sel:[0,1] op_sel_hi:[1,1]
    v_pk_mul_f32 v[114:115], v[114:115], v[26:27] op_sel:[0,1] op_sel_hi:[1,1]
    v_pk_fma_f32 v[116:117], v[44:45], v[10:11], v[116:117] op_sel:[0,1,0] op_sel_hi:[1,1,1]
    v_pk_fma_f32 v[118:119], v[46:47], v[10:11], v[118:119] op_sel:[0,1,0] op_sel_hi:[1,1,1]
    v_pk_mul_f32 v[116:117], v[116:117], v[26:27] op_sel:[0,1] op_sel_hi:[1,1]
    v_pk_mul_f32 v[118:119], v[118:119], v[26:27] op_sel:[0,1] op_sel_hi:[1,1]
    v_cvt_pk_bf16_f32 v60, v112, v113
    v_cvt_pk_bf16_f32 v61, v114, v115
    v_cvt_pk_bf16_f32 v62, v116, v117
    v_cvt_pk_bf16_f32 v63, v118, v119
    buffer_store_dwordx4 v[60:63], v206, s[52:55], s45 offen offset:640 sc1
    v_pk_fma_f32 v[120:121], v[48:49], v[10:11], v[120:121] op_sel:[0,1,0] op_sel_hi:[1,1,1]
    v_pk_fma_f32 v[122:123], v[50:51], v[10:11], v[122:123] op_sel:[0,1,0] op_sel_hi:[1,1,1]
    v_pk_mul_f32 v[120:121], v[120:121], v[26:27] op_sel:[0,1] op_sel_hi:[1,1]
    v_pk_mul_f32 v[122:123], v[122:123], v[26:27] op_sel:[0,1] op_sel_hi:[1,1]
    v_pk_fma_f32 v[124:125], v[52:53], v[10:11], v[124:125] op_sel:[0,1,0] op_sel_hi:[1,1,1]
    v_pk_fma_f32 v[126:127], v[54:55], v[10:11], v[126:127] op_sel:[0,1,0] op_sel_hi:[1,1,1]
    v_pk_mul_f32 v[124:125], v[124:125], v[26:27] op_sel:[0,1] op_sel_hi:[1,1]
    v_pk_mul_f32 v[126:127], v[126:127], v[26:27] op_sel:[0,1] op_sel_hi:[1,1]
    v_cvt_pk_bf16_f32 v56, v120, v121
    v_cvt_pk_bf16_f32 v57, v122, v123
    v_cvt_pk_bf16_f32 v58, v124, v125
    v_cvt_pk_bf16_f32 v59, v126, v127
    buffer_store_dwordx4 v[56:59], v206, s[52:55], s47 offen offset:640 sc1
    v_pk_fma_f32 v[104:105], v[48:49], v[10:11], v[104:105] op_sel:[0,0,0] op_sel_hi:[1,0,1]
    v_pk_fma_f32 v[106:107], v[50:51], v[10:11], v[106:107] op_sel:[0,0,0] op_sel_hi:[1,0,1]
    v_pk_mul_f32 v[104:105], v[104:105], v[26:27] op_sel:[0,0] op_sel_hi:[1,0]
    v_pk_mul_f32 v[106:107], v[106:107], v[26:27] op_sel:[0,0] op_sel_hi:[1,0]
    v_pk_fma_f32 v[108:109], v[52:53], v[10:11], v[108:109] op_sel:[0,0,0] op_sel_hi:[1,0,1]
    v_pk_fma_f32 v[110:111], v[54:55], v[10:11], v[110:111] op_sel:[0,0,0] op_sel_hi:[1,0,1]
    v_pk_mul_f32 v[108:109], v[108:109], v[26:27] op_sel:[0,0] op_sel_hi:[1,0]
    v_pk_mul_f32 v[110:111], v[110:111], v[26:27] op_sel:[0,0] op_sel_hi:[1,0]
    v_cvt_pk_bf16_f32 v60, v104, v105
    v_cvt_pk_bf16_f32 v61, v106, v107
    v_cvt_pk_bf16_f32 v62, v108, v109
    v_cvt_pk_bf16_f32 v63, v110, v111
    buffer_store_dwordx4 v[60:63], v206, s[52:55], s47 offen offset:512 sc1
    v_pk_fma_f32 v[88:89], v[48:49], v[8:9], v[88:89] op_sel:[0,1,0] op_sel_hi:[1,1,1]
    v_pk_fma_f32 v[90:91], v[50:51], v[8:9], v[90:91] op_sel:[0,1,0] op_sel_hi:[1,1,1]
    v_pk_mul_f32 v[88:89], v[88:89], v[24:25] op_sel:[0,1] op_sel_hi:[1,1]
    v_pk_mul_f32 v[90:91], v[90:91], v[24:25] op_sel:[0,1] op_sel_hi:[1,1]
    v_pk_fma_f32 v[92:93], v[52:53], v[8:9], v[92:93] op_sel:[0,1,0] op_sel_hi:[1,1,1]
    v_pk_fma_f32 v[94:95], v[54:55], v[8:9], v[94:95] op_sel:[0,1,0] op_sel_hi:[1,1,1]
    v_pk_mul_f32 v[92:93], v[92:93], v[24:25] op_sel:[0,1] op_sel_hi:[1,1]
    v_pk_mul_f32 v[94:95], v[94:95], v[24:25] op_sel:[0,1] op_sel_hi:[1,1]
    v_cvt_pk_bf16_f32 v56, v88, v89
    v_cvt_pk_bf16_f32 v57, v90, v91
    v_cvt_pk_bf16_f32 v58, v92, v93
    v_cvt_pk_bf16_f32 v59, v94, v95
    buffer_store_dwordx4 v[56:59], v206, s[52:55], s47 offen offset:128 sc1
    v_pk_fma_f32 v[72:73], v[48:49], v[8:9], v[72:73] op_sel:[0,0,0] op_sel_hi:[1,0,1]
    v_pk_fma_f32 v[74:75], v[50:51], v[8:9], v[74:75] op_sel:[0,0,0] op_sel_hi:[1,0,1]
    v_pk_mul_f32 v[72:73], v[72:73], v[24:25] op_sel:[0,0] op_sel_hi:[1,0]
    v_pk_mul_f32 v[74:75], v[74:75], v[24:25] op_sel:[0,0] op_sel_hi:[1,0]
    v_pk_fma_f32 v[76:77], v[52:53], v[8:9], v[76:77] op_sel:[0,0,0] op_sel_hi:[1,0,1]
    v_pk_fma_f32 v[78:79], v[54:55], v[8:9], v[78:79] op_sel:[0,0,0] op_sel_hi:[1,0,1]
    v_pk_mul_f32 v[76:77], v[76:77], v[24:25] op_sel:[0,0] op_sel_hi:[1,0]
    v_pk_mul_f32 v[78:79], v[78:79], v[24:25] op_sel:[0,0] op_sel_hi:[1,0]
    v_cvt_pk_bf16_f32 v60, v72, v73
    v_cvt_pk_bf16_f32 v61, v74, v75
    v_cvt_pk_bf16_f32 v62, v76, v77
    v_cvt_pk_bf16_f32 v63, v78, v79
    buffer_store_dwordx4 v[60:63], v206, s[52:55], s47 offen offset:0 sc1
    s_waitcnt lgkmcnt(0)
    v_readfirstlane_b32 s70, v210
    s_branch L_P1_END
L_P1_CDONE:
    s_lshl_b32 s3, s38, 2
    s_add_u32 s3, s3, s33
    s_mul_i32 s3, s3, 20480
    s_mul_i32 s67, s39, 160
    s_add_u32 s66, s3, s67
    v_lshrrev_b32 v193, 4, v1
    v_lshrrev_b32 v194, 5, v1
    v_and_b32 v195, 1, v193
    v_lshlrev_b32 v195, 5, v195
    v_lshl_add_u32 v191, v194, 4, v195
    v_lshlrev_b32 v193, 3, v193
    v_and_b32 v192, 15, v1
    v_mul_u32_u24 v192, 1280, v192
    v_add_u32 v190, v192, v191
    v_add_u32 v192, v192, v193
    v_lshlrev_b32 v194, 4, v1
    v_lshlrev_b32 v195, 2, v1
    buffer_load_dwordx4 v[214:217], v190, s[4:7], s66 offen offset:0
    buffer_load_dwordx4 v[224:227], v191, s[28:31], s67 offen offset:0
    buffer_load_dwordx4 v[218:221], v190, s[4:7], s66 offen offset:64
    buffer_load_dwordx4 v[228:231], v191, s[28:31], s67 offen offset:64
    buffer_load_dwordx2 v[222:223], v192, s[4:7], s66 offen offset:128
    buffer_load_dwordx2 v[232:233], v193, s[28:31], s67 offen offset:128
    buffer_load_dwordx4 v[234:237], v194, s[28:31], 0 offen
    buffer_load_dword v238, v195, s[28:31], 0 offen offset:1024
    s_lshl_b32 s50, s34, 1
    s_and_b32 s42, s35, 1
    s_add_u32 s50, s50, s42
    s_lshl_b32 s50, s50, 2
    s_add_u32 s50, s50, s33
    s_mul_i32 s50, s50, 12800
    v_min_u32 v58, 49, v1
    v_lshlrev_b32 v58, 7, v58
    buffer_load_dword v59, v58, s[12:15], s50 offen
    s_add_u32 s50, s50, 6400
    s_waitcnt vmcnt(1)
    buffer_load_dword v59, v58, s[12:15], s50 offen
    s_add_u32 s50, s50, 6400
    s_waitcnt vmcnt(1)
    s_mov_b32 s52, s74
    s_mov_b32 s53, s75
    s_mov_b32 s54, 1966080
    s_mov_b32 s55, 0x20000
    s_and_b32 s42, s35, 1
    s_cmp_eq_u32 s42, 1
    s_cselect_b32 s52, s76, s52
    s_cselect_b32 s53, s77, s53
    v_min_u32 v58, 62, v1
    v_mul_u32_u24 v60, 86, v58
    v_lshrrev_b32 v60, 8, v60
    v_mul_u32_u24 v61, 3, v60
    v_sub_u32 v58, v58, v61
    v_mul_u32_u24 v60, 3072, v60
    v_lshl_add_u32 v58, v58, 7, v60
    s_mul_i32 s50, s34, 384
    s_mul_i32 s51, s33, 64512
    s_add_u32 s50, s50, s51
    s_lshl_b32 s43, s34, 12
    s_add_u32 s63, s43, 98304
    v_and_b32 v57, 31, v1
    v_lshlrev_b32 v57, 7, v57
    buffer_load_dword v59, v58, s[52:55], s50 offen
    s_add_u32 s50, s50, 258048
    s_waitcnt vmcnt(1)
    buffer_load_dwordx4 v[60:63], v57, s[16:19], s63 offen sc1
    buffer_load_dword v59, v58, s[52:55], s50 offen
    s_add_u32 s50, s50, 258048
    s_mov_b32 s58, 50000
    s_waitcnt vmcnt(1)
    s_branch L_P1_XW
L_P1_XPOLL:
    buffer_load_dwordx4 v[60:63], v57, s[16:19], s63 offen sc1
    s_waitcnt vmcnt(0)
L_P1_XW:
    v_cmp_ne_u32 vcc, s32, v63
    s_cbranch_vccz L_P1_XOK
    s_sub_u32 s58, s58, 1
    s_cmp_lg_u32 s58, 0
    s_cbranch_scc1 L_P1_XPOLL
L_P1_XOK:
    v_cmp_ne_u32 vcc, s71, v60
    s_cmp_eq_u64 vcc, 0
    s_cselect_b32 s70, 1, 0
    v_mov_b32 v61, s70
    v_mov_b32 v62, 132096
    ds_write_b32 v62, v61
    buffer_load_dword v59, v58, s[52:55], s50 offen
    s_add_u32 s50, s50, 258048
    s_waitcnt vmcnt(1)
    buffer_load_dword v59, v58, s[52:55], s50 offen
    s_add_u32 s50, s50, 258048
    s_barrier
    s_waitcnt lgkmcnt(0)
    s_barrier
    s_branch L_P1_END
L_P1_V:
    s_lshl_b32 s43, s36, 7
    s_lshl_b32 s44, s37, 3
    s_add_u32 s43, s43, s44
    s_lshl_b32 s44, s33, 1
    s_add_u32 s50, s43, s44
    s_mul_i32 s59, s50, 1280
    v_lshrrev_b32 v19, 5, v1
    v_and_b32 v20, 31, v1
    v_mul_u32_u24 v18, 1280, v19
    v_lshl_add_u32 v18, v20, 3, v18
    v_add_u32 v19, s50, v19
    v_lshlrev_b32 v19, 4, v19
    s_lshr_b32 s42, s33, 1
    s_and_b32 s43, s33, 1
    v_and_b32 v198, 15, v1
    v_lshrrev_b32 v199, 4, v1
    v_lshrrev_b32 v200, 3, v198
    v_and_b32 v201, 7, v198
    v_lshl_add_u32 v200, v200, 4, v201
    s_lshl_b32 s44, s42, 13
    v_lshl_add_u32 v201, v200, 7, s44
    v_lshrrev_b32 v202, 1, v198
    v_add_u32 v203, 0, v199
    v_xor_b32 v203, v203, v202
    v_lshl_add_u32 v192, v203, 4, v201
    v_add_u32 v203, 4, v199
    v_xor_b32 v203, v203, v202
    v_lshl_add_u32 v193, v203, 4, v201
    v_bfe_u32 v201, v1, 2, 2
    v_and_b32 v202, 3, v1
    v_lshl_add_u32 v203, v199, 3, v201
    v_lshlrev_b32 v203, 8, v203
    v_add_u32 v203, 65536, v203
    v_and_b32 v204, 1, v199
    v_mul_u32_u24 v204, 3, v204
    v_lshlrev_b32 v201, 2, v201
    v_xor_b32 v201, v201, v204
    s_lshl_b32 s44, s43, 3
    v_and_b32 v204, 1, v202
    v_lshrrev_b32 v202, 1, v202
    s_lshl_b32 s48, s42, 2
    s_xor_b32 s49, s48, 4
    s_add_u32 s48, s48, s44
    s_add_u32 s49, s49, s44
    v_add_u32 v205, s48, v202
    v_xor_b32 v205, v205, v201
    v_lshl_add_u32 v194, v205, 4, v203
    v_lshl_add_u32 v194, v204, 3, v194
    v_add_u32 v205, s48, v202
    v_add_u32 v205, 2, v205
    v_xor_b32 v205, v205, v201
    v_lshl_add_u32 v195, v205, 4, v203
    v_lshl_add_u32 v195, v204, 3, v195
    v_add_u32 v205, s49, v202
    v_xor_b32 v205, v205, v201
    v_lshl_add_u32 v196, v205, 4, v203
    v_lshl_add_u32 v196, v204, 3, v196
    v_add_u32 v205, s49, v202
    v_add_u32 v205, 2, v205
    v_xor_b32 v205, v205, v201
    v_lshl_add_u32 v197, v205, 4, v203
    v_lshl_add_u32 v197, v204, 3, v197
    s_lshl_b32 s46, s42, 8
    s_add_u32 s46, s46, 131072
    s_lshl_b32 s47, s33, 11
    s_add_u32 s47, s47, 139264
    v_lshl_add_u32 v208, v1, 3, s47
    v_xor_b32 v209, 4096, v208
    v_mul_u32_u24 v206, 10240, v199
    v_lshl_add_u32 v206, v198, 4, v206
    v_lshrrev_b32 v204, 1, v199
    v_and_b32 v205, 1, v199
    v_lshl_add_u32 v207, v204, 6, s46
    v_lshl_add_u32 v207, v205, 4, v207
    s_lshl_b32 s45, s60, 1
    s_add_u32 s45, s45, s42
    s_mul_i32 s45, s45, 81920
    s_add_u32 s45, s45, 7319552
    s_lshl_b32 s46, s62, 11
    s_add_u32 s45, s45, s46
    s_lshl_b32 s46, s43, 10
    s_add_u32 s45, s45, s46
    s_lshl_b32 s46, s42, 9
    s_xor_b32 s48, s46, 512
    s_add_u32 s48, s48, s45
    s_add_u32 s45, s45, s46
    s_add_u32 s47, s45, 40960
    s_add_u32 s49, s48, 40960
    v_mov_b32 v210, 132096
    v_mov_b32 v200, 0x3f803f80
    v_mov_b32 v201, 0x3f803f80
    v_mov_b32 v202, 0x3f803f80
    v_mov_b32 v203, 0x3f803f80
    s_barrier
    ds_read_b64_tr_b16 v[128:129], v194 offset:32768
    ds_read_b64_tr_b16 v[130:131], v194 offset:33792
    ds_read_b128 v[144:147], v192 offset:32768
    ds_read_b128 v[148:151], v192 offset:33792
    ds_read_b64_tr_b16 v[132:133], v195 offset:32768
    ds_read_b64_tr_b16 v[134:135], v195 offset:33792
    ds_read_b64_tr_b16 v[136:137], v196 offset:32768
    ds_read_b64_tr_b16 v[138:139], v196 offset:33792
    ds_read_b64_tr_b16 v[140:141], v197 offset:32768
    ds_read_b64_tr_b16 v[142:143], v197 offset:33792
    ds_read_b128 v[152:155], v192 offset:36864
    ds_read_b128 v[156:159], v192 offset:37888
    buffer_load_dwordx2 v[8:9], v18, s[4:7], s59 offen offset:0
    buffer_load_dwordx2 v[10:11], v18, s[4:7], s59 offen offset:256
    buffer_load_dwordx2 v[12:13], v18, s[4:7], s59 offen offset:512
    buffer_load_dwordx2 v[14:15], v18, s[4:7], s59 offen offset:768
    buffer_load_dwordx2 v[16:17], v18, s[4:7], s59 offen offset:1024
    s_waitcnt lgkmcnt(9)
    v_mfma_f32_16x16x32_bf16 v[64:67], v[144:147], v[128:131], 0
    ds_read_b64_tr_b16 v[160:161], v194 offset:40960
    v_mfma_f32_16x16x32_bf16 v[40:43], v[200:203], v[128:131], 0
    ds_read_b64_tr_b16 v[162:163], v194 offset:41984
    s_waitcnt lgkmcnt(10)
    v_mfma_f32_16x16x32_bf16 v[80:83], v[148:151], v[128:131], 0
    ds_read_b128 v[176:179], v193 offset:32768
    s_waitcnt lgkmcnt(9)
    v_mfma_f32_16x16x32_bf16 v[44:47], v[200:203], v[132:135], 0
    ds_read_b128 v[180:183], v193 offset:33792
    v_mfma_f32_16x16x32_bf16 v[84:87], v[148:151], v[132:135], 0
    ds_read_b64_tr_b16 v[164:165], v195 offset:40960
    v_mfma_f32_16x16x32_bf16 v[68:71], v[144:147], v[132:135], 0
    ds_read_b64_tr_b16 v[166:167], v195 offset:41984
    s_waitcnt lgkmcnt(10)
    v_mfma_f32_16x16x32_bf16 v[72:75], v[144:147], v[136:139], 0
    ds_read_b64_tr_b16 v[168:169], v196 offset:40960
    v_mfma_f32_16x16x32_bf16 v[88:91], v[148:151], v[136:139], 0
    ds_read_b64_tr_b16 v[170:171], v196 offset:41984
    s_waitcnt lgkmcnt(10)
    v_mfma_f32_16x16x32_bf16 v[92:95], v[148:151], v[140:143], 0
    ds_read_b64_tr_b16 v[172:173], v197 offset:40960
    v_mfma_f32_16x16x32_bf16 v[76:79], v[144:147], v[140:143], 0
    ds_read_b64_tr_b16 v[174:175], v197 offset:41984
    s_waitcnt lgkmcnt(11)
    v_mfma_f32_16x16x32_bf16 v[108:111], v[152:155], v[140:143], 0
    ds_read_b128 v[184:187], v193 offset:36864
    s_waitcnt lgkmcnt(11)
    v_mfma_f32_16x16x32_bf16 v[124:127], v[156:159], v[140:143], 0
    ds_read_b128 v[188:191], v193 offset:37888
    v_mfma_f32_16x16x32_bf16 v[120:123], v[156:159], v[136:139], 0
    v_mfma_f32_16x16x32_bf16 v[104:107], v[152:155], v[136:139], 0
    v_mfma_f32_16x16x32_bf16 v[100:103], v[152:155], v[132:135], 0
    v_mfma_f32_16x16x32_bf16 v[116:119], v[156:159], v[132:135], 0
    v_mfma_f32_16x16x32_bf16 v[112:115], v[156:159], v[128:131], 0
    v_mfma_f32_16x16x32_bf16 v[96:99], v[152:155], v[128:131], 0
    s_waitcnt lgkmcnt(9)
    s_barrier
    v_mfma_f32_16x16x32_bf16 v[64:67], v[176:179], v[160:163], v[64:67]
    ds_read_b64_tr_b16 v[128:129], v194 offset:49152
    v_mfma_f32_16x16x32_bf16 v[40:43], v[200:203], v[160:163], v[40:43]
    ds_read_b64_tr_b16 v[130:131], v194 offset:50176
    s_waitcnt lgkmcnt(10)
    v_mfma_f32_16x16x32_bf16 v[80:83], v[180:183], v[160:163], v[80:83]
    ds_read_b128 v[144:147], v192 offset:49152
    s_waitcnt lgkmcnt(9)
    v_mfma_f32_16x16x32_bf16 v[44:47], v[200:203], v[164:167], v[44:47]
    ds_read_b128 v[148:151], v192 offset:50176
    v_mfma_f32_16x16x32_bf16 v[84:87], v[180:183], v[164:167], v[84:87]
    ds_read_b64_tr_b16 v[132:133], v195 offset:49152
    v_mfma_f32_16x16x32_bf16 v[68:71], v[176:179], v[164:167], v[68:71]
    ds_read_b64_tr_b16 v[134:135], v195 offset:50176
    s_waitcnt lgkmcnt(10)
    v_mfma_f32_16x16x32_bf16 v[72:75], v[176:179], v[168:171], v[72:75]
    ds_read_b64_tr_b16 v[136:137], v196 offset:49152
    v_mfma_f32_16x16x32_bf16 v[88:91], v[180:183], v[168:171], v[88:91]
    ds_read_b64_tr_b16 v[138:139], v196 offset:50176
    s_waitcnt lgkmcnt(10)
    v_mfma_f32_16x16x32_bf16 v[92:95], v[180:183], v[172:175], v[92:95]
    ds_read_b64_tr_b16 v[140:141], v197 offset:49152
    v_mfma_f32_16x16x32_bf16 v[76:79], v[176:179], v[172:175], v[76:79]
    ds_read_b64_tr_b16 v[142:143], v197 offset:50176
    s_waitcnt lgkmcnt(11)
    v_mfma_f32_16x16x32_bf16 v[108:111], v[184:187], v[172:175], v[108:111]
    ds_read_b128 v[152:155], v192 offset:53248
    s_waitcnt lgkmcnt(11)
    v_mfma_f32_16x16x32_bf16 v[124:127], v[188:191], v[172:175], v[124:127]
    ds_read_b128 v[156:159], v192 offset:54272
    v_mfma_f32_16x16x32_bf16 v[120:123], v[188:191], v[168:171], v[120:123]
    v_mfma_f32_16x16x32_bf16 v[104:107], v[184:187], v[168:171], v[104:107]
    v_mfma_f32_16x16x32_bf16 v[100:103], v[184:187], v[164:167], v[100:103]
    v_mfma_f32_16x16x32_bf16 v[116:119], v[188:191], v[164:167], v[116:119]
    v_mfma_f32_16x16x32_bf16 v[112:115], v[188:191], v[160:163], v[112:115]
    v_mfma_f32_16x16x32_bf16 v[96:99], v[184:187], v[160:163], v[96:99]
    s_waitcnt lgkmcnt(9)
    v_mfma_f32_16x16x32_bf16 v[64:67], v[144:147], v[128:131], v[64:67]
    ds_read_b64_tr_b16 v[160:161], v194 offset:57344
    v_mfma_f32_16x16x32_bf16 v[40:43], v[200:203], v[128:131], v[40:43]
    ds_read_b64_tr_b16 v[162:163], v194 offset:58368
    s_waitcnt lgkmcnt(10)
    v_mfma_f32_16x16x32_bf16 v[80:83], v[148:151], v[128:131], v[80:83]
    ds_read_b128 v[176:179], v193 offset:49152
    s_waitcnt lgkmcnt(9)
    v_mfma_f32_16x16x32_bf16 v[44:47], v[200:203], v[132:135], v[44:47]
    ds_read_b128 v[180:183], v193 offset:50176
    v_mfma_f32_16x16x32_bf16 v[84:87], v[148:151], v[132:135], v[84:87]
    ds_read_b64_tr_b16 v[164:165], v195 offset:57344
    v_mfma_f32_16x16x32_bf16 v[68:71], v[144:147], v[132:135], v[68:71]
    ds_read_b64_tr_b16 v[166:167], v195 offset:58368
    s_waitcnt lgkmcnt(10)
    v_mfma_f32_16x16x32_bf16 v[72:75], v[144:147], v[136:139], v[72:75]
    ds_read_b64_tr_b16 v[168:169], v196 offset:57344
    v_mfma_f32_16x16x32_bf16 v[88:91], v[148:151], v[136:139], v[88:91]
    ds_read_b64_tr_b16 v[170:171], v196 offset:58368
    s_waitcnt lgkmcnt(10)
    v_mfma_f32_16x16x32_bf16 v[92:95], v[148:151], v[140:143], v[92:95]
    ds_read_b64_tr_b16 v[172:173], v197 offset:57344
    v_mfma_f32_16x16x32_bf16 v[76:79], v[144:147], v[140:143], v[76:79]
    ds_read_b64_tr_b16 v[174:175], v197 offset:58368
    s_waitcnt lgkmcnt(11)
    v_mfma_f32_16x16x32_bf16 v[108:111], v[152:155], v[140:143], v[108:111]
    ds_read_b128 v[184:187], v193 offset:53248
    s_waitcnt lgkmcnt(11)
    v_mfma_f32_16x16x32_bf16 v[124:127], v[156:159], v[140:143], v[124:127]
    ds_read_b128 v[188:191], v193 offset:54272
    v_mfma_f32_16x16x32_bf16 v[120:123], v[156:159], v[136:139], v[120:123]
    v_mfma_f32_16x16x32_bf16 v[104:107], v[152:155], v[136:139], v[104:107]
    v_mfma_f32_16x16x32_bf16 v[100:103], v[152:155], v[132:135], v[100:103]
    v_mfma_f32_16x16x32_bf16 v[116:119], v[156:159], v[132:135], v[116:119]
    v_mfma_f32_16x16x32_bf16 v[112:115], v[156:159], v[128:131], v[112:115]
    v_mfma_f32_16x16x32_bf16 v[96:99], v[152:155], v[128:131], v[96:99]
    s_waitcnt lgkmcnt(9)
    s_barrier
    v_mfma_f32_16x16x32_bf16 v[64:67], v[176:179], v[160:163], v[64:67]
    ds_read_b64_tr_b16 v[128:129], v194 offset:0
    v_mfma_f32_16x16x32_bf16 v[40:43], v[200:203], v[160:163], v[40:43]
    ds_read_b64_tr_b16 v[130:131], v194 offset:1024
    s_waitcnt lgkmcnt(10)
    v_mfma_f32_16x16x32_bf16 v[80:83], v[180:183], v[160:163], v[80:83]
    ds_read_b128 v[144:147], v192 offset:0
    s_waitcnt lgkmcnt(9)
    v_mfma_f32_16x16x32_bf16 v[44:47], v[200:203], v[164:167], v[44:47]
    ds_read_b128 v[148:151], v192 offset:1024
    v_mfma_f32_16x16x32_bf16 v[84:87], v[180:183], v[164:167], v[84:87]
    ds_read_b64_tr_b16 v[132:133], v195 offset:0
    v_mfma_f32_16x16x32_bf16 v[68:71], v[176:179], v[164:167], v[68:71]
    ds_read_b64_tr_b16 v[134:135], v195 offset:1024
    s_waitcnt lgkmcnt(10)
    v_mfma_f32_16x16x32_bf16 v[72:75], v[176:179], v[168:171], v[72:75]
    ds_read_b64_tr_b16 v[136:137], v196 offset:0
    v_mfma_f32_16x16x32_bf16 v[88:91], v[180:183], v[168:171], v[88:91]
    ds_read_b64_tr_b16 v[138:139], v196 offset:1024
    s_waitcnt lgkmcnt(10)
    v_mfma_f32_16x16x32_bf16 v[92:95], v[180:183], v[172:175], v[92:95]
    ds_read_b64_tr_b16 v[140:141], v197 offset:0
    v_mfma_f32_16x16x32_bf16 v[76:79], v[176:179], v[172:175], v[76:79]
    ds_read_b64_tr_b16 v[142:143], v197 offset:1024
    s_waitcnt lgkmcnt(11)
    v_mfma_f32_16x16x32_bf16 v[108:111], v[184:187], v[172:175], v[108:111]
    ds_read_b128 v[152:155], v192 offset:4096
    s_waitcnt lgkmcnt(11)
    v_mfma_f32_16x16x32_bf16 v[124:127], v[188:191], v[172:175], v[124:127]
    ds_read_b128 v[156:159], v192 offset:5120
    v_mfma_f32_16x16x32_bf16 v[120:123], v[188:191], v[168:171], v[120:123]
    v_mfma_f32_16x16x32_bf16 v[104:107], v[184:187], v[168:171], v[104:107]
    v_mfma_f32_16x16x32_bf16 v[100:103], v[184:187], v[164:167], v[100:103]
    v_mfma_f32_16x16x32_bf16 v[116:119], v[188:191], v[164:167], v[116:119]
    v_mfma_f32_16x16x32_bf16 v[112:115], v[188:191], v[160:163], v[112:115]
    v_mfma_f32_16x16x32_bf16 v[96:99], v[184:187], v[160:163], v[96:99]
    s_waitcnt lgkmcnt(9)
    v_mfma_f32_16x16x32_bf16 v[64:67], v[144:147], v[128:131], v[64:67]
    ds_read_b64_tr_b16 v[160:161], v194 offset:8192
    v_mfma_f32_16x16x32_bf16 v[40:43], v[200:203], v[128:131], v[40:43]
    ds_read_b64_tr_b16 v[162:163], v194 offset:9216
    s_waitcnt lgkmcnt(10)
    v_mfma_f32_16x16x32_bf16 v[80:83], v[148:151], v[128:131], v[80:83]
    ds_read_b128 v[176:179], v193 offset:0
    s_waitcnt lgkmcnt(9)
    v_mfma_f32_16x16x32_bf16 v[44:47], v[200:203], v[132:135], v[44:47]
    ds_read_b128 v[180:183], v193 offset:1024
    v_mfma_f32_16x16x32_bf16 v[84:87], v[148:151], v[132:135], v[84:87]
    ds_read_b64_tr_b16 v[164:165], v195 offset:8192
    v_mfma_f32_16x16x32_bf16 v[68:71], v[144:147], v[132:135], v[68:71]
    ds_read_b64_tr_b16 v[166:167], v195 offset:9216
    s_waitcnt lgkmcnt(10)
    v_mfma_f32_16x16x32_bf16 v[72:75], v[144:147], v[136:139], v[72:75]
    ds_read_b64_tr_b16 v[168:169], v196 offset:8192
    v_mfma_f32_16x16x32_bf16 v[88:91], v[148:151], v[136:139], v[88:91]
    ds_read_b64_tr_b16 v[170:171], v196 offset:9216
    s_waitcnt lgkmcnt(10)
    v_mfma_f32_16x16x32_bf16 v[92:95], v[148:151], v[140:143], v[92:95]
    ds_read_b64_tr_b16 v[172:173], v197 offset:8192
    v_mfma_f32_16x16x32_bf16 v[76:79], v[144:147], v[140:143], v[76:79]
    ds_read_b64_tr_b16 v[174:175], v197 offset:9216
    s_waitcnt lgkmcnt(11)
    v_mfma_f32_16x16x32_bf16 v[108:111], v[152:155], v[140:143], v[108:111]
    ds_read_b128 v[184:187], v193 offset:4096
    s_waitcnt lgkmcnt(11)
    v_mfma_f32_16x16x32_bf16 v[124:127], v[156:159], v[140:143], v[124:127]
    ds_read_b128 v[188:191], v193 offset:5120
    v_mfma_f32_16x16x32_bf16 v[120:123], v[156:159], v[136:139], v[120:123]
    v_mfma_f32_16x16x32_bf16 v[104:107], v[152:155], v[136:139], v[104:107]
    v_mfma_f32_16x16x32_bf16 v[100:103], v[152:155], v[132:135], v[100:103]
    v_mfma_f32_16x16x32_bf16 v[116:119], v[156:159], v[132:135], v[116:119]
    v_mfma_f32_16x16x32_bf16 v[112:115], v[156:159], v[128:131], v[112:115]
    v_mfma_f32_16x16x32_bf16 v[96:99], v[152:155], v[128:131], v[96:99]
    s_waitcnt vmcnt(0)
    v_dot2_f32_bf16 v20, v8, v200, 0
    v_dot2_f32_bf16 v21, v8, v8, 0
    v_dot2_f32_bf16 v20, v9, v200, v20
    v_dot2_f32_bf16 v21, v9, v9, v21
    v_dot2_f32_bf16 v20, v10, v200, v20
    v_dot2_f32_bf16 v21, v10, v10, v21
    v_dot2_f32_bf16 v20, v11, v200, v20
    v_dot2_f32_bf16 v21, v11, v11, v21
    v_dot2_f32_bf16 v20, v12, v200, v20
    v_dot2_f32_bf16 v21, v12, v12, v21
    v_dot2_f32_bf16 v20, v13, v200, v20
    v_dot2_f32_bf16 v21, v13, v13, v21
    v_dot2_f32_bf16 v20, v14, v200, v20
    v_dot2_f32_bf16 v21, v14, v14, v21
    v_dot2_f32_bf16 v20, v15, v200, v20
    v_dot2_f32_bf16 v21, v15, v15, v21
    v_dot2_f32_bf16 v20, v16, v200, v20
    v_dot2_f32_bf16 v21, v16, v16, v21
    v_dot2_f32_bf16 v20, v17, v200, v20
    v_dot2_f32_bf16 v21, v17, v17, v21
    s_nop 1
    v_add_f32_dpp v20, v20, v20 row_ror:8 row_mask:0xf bank_mask:0xf
    v_add_f32_dpp v21, v21, v21 row_ror:8 row_mask:0xf bank_mask:0xf
    s_nop 0
    v_add_f32_dpp v20, v20, v20 row_ror:4 row_mask:0xf bank_mask:0xf
    v_add_f32_dpp v21, v21, v21 row_ror:4 row_mask:0xf bank_mask:0xf
    s_nop 0
    v_add_f32_dpp v20, v20, v20 row_ror:2 row_mask:0xf bank_mask:0xf
    v_add_f32_dpp v21, v21, v21 row_ror:2 row_mask:0xf bank_mask:0xf
    s_nop 0
    v_add_f32_dpp v20, v20, v20 row_ror:1 row_mask:0xf bank_mask:0xf
    v_add_f32_dpp v21, v21, v21 row_ror:1 row_mask:0xf bank_mask:0xf
    v_mov_b32 v22, v20
    v_mov_b32 v23, v21
    s_nop 0
    v_permlane16_swap_b32 v20, v22
    v_permlane16_swap_b32 v21, v23
    v_add_f32 v20, v20, v22
    v_add_f32 v21, v21, v23
    v_mul_f32 v24, 0xbacccccd, v20
    v_mov_b32 v22, 0x3727c5ac
    v_fmac_f32 v22, 0x3acccccd, v21
    v_mov_b32 v26, s32
    v_fma_f32 v22, -v24, v24, v22
    v_mov_b32 v27, s32
    v_max_f32 v22, 0x3727c5ac, v22
    v_rsq_f32 v25, v22
    s_mov_b32 s43, 65536
    s_mov_b32 exec_lo, 1
    s_mov_b32 exec_hi, 1
    buffer_store_dwordx4 v[24:27], v19, s[16:19], s43 offen sc1
    s_mov_b64 exec, -1
    s_waitcnt lgkmcnt(9)
    s_barrier
    v_mfma_f32_16x16x32_bf16 v[64:67], v[176:179], v[160:163], v[64:67]
    ds_read_b64_tr_b16 v[128:129], v194 offset:16384
    v_mfma_f32_16x16x32_bf16 v[40:43], v[200:203], v[160:163], v[40:43]
    ds_read_b64_tr_b16 v[130:131], v194 offset:17408
    s_waitcnt lgkmcnt(10)
    v_mfma_f32_16x16x32_bf16 v[80:83], v[180:183], v[160:163], v[80:83]
    ds_read_b128 v[144:147], v192 offset:16384
    s_waitcnt lgkmcnt(9)
    v_mfma_f32_16x16x32_bf16 v[44:47], v[200:203], v[164:167], v[44:47]
    ds_read_b128 v[148:151], v192 offset:17408
    v_mfma_f32_16x16x32_bf16 v[84:87], v[180:183], v[164:167], v[84:87]
    ds_read_b64_tr_b16 v[132:133], v195 offset:16384
    v_mfma_f32_16x16x32_bf16 v[68:71], v[176:179], v[164:167], v[68:71]
    ds_read_b64_tr_b16 v[134:135], v195 offset:17408
    s_waitcnt lgkmcnt(10)
    v_mfma_f32_16x16x32_bf16 v[72:75], v[176:179], v[168:171], v[72:75]
    ds_read_b64_tr_b16 v[136:137], v196 offset:16384
    v_mfma_f32_16x16x32_bf16 v[88:91], v[180:183], v[168:171], v[88:91]
    ds_read_b64_tr_b16 v[138:139], v196 offset:17408
    s_waitcnt lgkmcnt(10)
    v_mfma_f32_16x16x32_bf16 v[92:95], v[180:183], v[172:175], v[92:95]
    ds_read_b64_tr_b16 v[140:141], v197 offset:16384
    v_mfma_f32_16x16x32_bf16 v[76:79], v[176:179], v[172:175], v[76:79]
    ds_read_b64_tr_b16 v[142:143], v197 offset:17408
    s_waitcnt lgkmcnt(11)
    v_mfma_f32_16x16x32_bf16 v[108:111], v[184:187], v[172:175], v[108:111]
    ds_read_b128 v[152:155], v192 offset:20480
    s_waitcnt lgkmcnt(11)
    v_mfma_f32_16x16x32_bf16 v[124:127], v[188:191], v[172:175], v[124:127]
    ds_read_b128 v[156:159], v192 offset:21504
    v_mfma_f32_16x16x32_bf16 v[120:123], v[188:191], v[168:171], v[120:123]
    v_mfma_f32_16x16x32_bf16 v[104:107], v[184:187], v[168:171], v[104:107]
    v_mfma_f32_16x16x32_bf16 v[100:103], v[184:187], v[164:167], v[100:103]
    v_mfma_f32_16x16x32_bf16 v[116:119], v[188:191], v[164:167], v[116:119]
    v_mfma_f32_16x16x32_bf16 v[112:115], v[188:191], v[160:163], v[112:115]
    v_mfma_f32_16x16x32_bf16 v[96:99], v[184:187], v[160:163], v[96:99]
    s_waitcnt lgkmcnt(9)
    v_mfma_f32_16x16x32_bf16 v[64:67], v[144:147], v[128:131], v[64:67]
    ds_read_b64_tr_b16 v[160:161], v194 offset:24576
    v_mfma_f32_16x16x32_bf16 v[40:43], v[200:203], v[128:131], v[40:43]
    ds_read_b64_tr_b16 v[162:163], v194 offset:25600
    s_waitcnt lgkmcnt(10)
    v_mfma_f32_16x16x32_bf16 v[80:83], v[148:151], v[128:131], v[80:83]
    ds_read_b128 v[176:179], v193 offset:16384
    s_waitcnt lgkmcnt(9)
    v_mfma_f32_16x16x32_bf16 v[44:47], v[200:203], v[132:135], v[44:47]
    ds_read_b128 v[180:183], v193 offset:17408
    v_mfma_f32_16x16x32_bf16 v[84:87], v[148:151], v[132:135], v[84:87]
    ds_read_b64_tr_b16 v[164:165], v195 offset:24576
    v_mfma_f32_16x16x32_bf16 v[68:71], v[144:147], v[132:135], v[68:71]
    ds_read_b64_tr_b16 v[166:167], v195 offset:25600
    s_waitcnt lgkmcnt(10)
    v_mfma_f32_16x16x32_bf16 v[72:75], v[144:147], v[136:139], v[72:75]
    ds_read_b64_tr_b16 v[168:169], v196 offset:24576
    v_mfma_f32_16x16x32_bf16 v[88:91], v[148:151], v[136:139], v[88:91]
    ds_read_b64_tr_b16 v[170:171], v196 offset:25600
    s_waitcnt lgkmcnt(10)
    v_mfma_f32_16x16x32_bf16 v[92:95], v[148:151], v[140:143], v[92:95]
    ds_read_b64_tr_b16 v[172:173], v197 offset:24576
    v_mfma_f32_16x16x32_bf16 v[76:79], v[144:147], v[140:143], v[76:79]
    ds_read_b64_tr_b16 v[174:175], v197 offset:25600
    s_waitcnt lgkmcnt(11)
    v_mfma_f32_16x16x32_bf16 v[108:111], v[152:155], v[140:143], v[108:111]
    ds_read_b128 v[184:187], v193 offset:20480
    s_waitcnt lgkmcnt(11)
    v_mfma_f32_16x16x32_bf16 v[124:127], v[156:159], v[140:143], v[124:127]
    ds_read_b128 v[188:191], v193 offset:21504
    v_mfma_f32_16x16x32_bf16 v[120:123], v[156:159], v[136:139], v[120:123]
    v_mfma_f32_16x16x32_bf16 v[104:107], v[152:155], v[136:139], v[104:107]
    v_mfma_f32_16x16x32_bf16 v[100:103], v[152:155], v[132:135], v[100:103]
    v_mfma_f32_16x16x32_bf16 v[116:119], v[156:159], v[132:135], v[116:119]
    v_mfma_f32_16x16x32_bf16 v[112:115], v[156:159], v[128:131], v[112:115]
    v_mfma_f32_16x16x32_bf16 v[96:99], v[152:155], v[128:131], v[96:99]
    s_waitcnt lgkmcnt(9)
    s_barrier
    v_mfma_f32_16x16x32_bf16 v[64:67], v[176:179], v[160:163], v[64:67]
    ds_read_b64_tr_b16 v[128:129], v194 offset:32768
    v_mfma_f32_16x16x32_bf16 v[40:43], v[200:203], v[160:163], v[40:43]
    ds_read_b64_tr_b16 v[130:131], v194 offset:33792
    s_waitcnt lgkmcnt(10)
    v_mfma_f32_16x16x32_bf16 v[80:83], v[180:183], v[160:163], v[80:83]
    ds_read_b128 v[144:147], v192 offset:32768
    s_waitcnt lgkmcnt(9)
    v_mfma_f32_16x16x32_bf16 v[44:47], v[200:203], v[164:167], v[44:47]
    ds_read_b128 v[148:151], v192 offset:33792
    v_mfma_f32_16x16x32_bf16 v[84:87], v[180:183], v[164:167], v[84:87]
    ds_read_b64_tr_b16 v[132:133], v195 offset:32768
    v_mfma_f32_16x16x32_bf16 v[68:71], v[176:179], v[164:167], v[68:71]
    ds_read_b64_tr_b16 v[134:135], v195 offset:33792
    s_waitcnt lgkmcnt(10)
    v_mfma_f32_16x16x32_bf16 v[72:75], v[176:179], v[168:171], v[72:75]
    ds_read_b64_tr_b16 v[136:137], v196 offset:32768
    v_mfma_f32_16x16x32_bf16 v[88:91], v[180:183], v[168:171], v[88:91]
    ds_read_b64_tr_b16 v[138:139], v196 offset:33792
    s_waitcnt lgkmcnt(10)
    v_mfma_f32_16x16x32_bf16 v[92:95], v[180:183], v[172:175], v[92:95]
    ds_read_b64_tr_b16 v[140:141], v197 offset:32768
    v_mfma_f32_16x16x32_bf16 v[76:79], v[176:179], v[172:175], v[76:79]
    ds_read_b64_tr_b16 v[142:143], v197 offset:33792
    s_waitcnt lgkmcnt(11)
    v_mfma_f32_16x16x32_bf16 v[108:111], v[184:187], v[172:175], v[108:111]
    ds_read_b128 v[152:155], v192 offset:36864
    s_waitcnt lgkmcnt(11)
    v_mfma_f32_16x16x32_bf16 v[124:127], v[188:191], v[172:175], v[124:127]
    ds_read_b128 v[156:159], v192 offset:37888
    v_mfma_f32_16x16x32_bf16 v[120:123], v[188:191], v[168:171], v[120:123]
    v_mfma_f32_16x16x32_bf16 v[104:107], v[184:187], v[168:171], v[104:107]
    v_mfma_f32_16x16x32_bf16 v[100:103], v[184:187], v[164:167], v[100:103]
    v_mfma_f32_16x16x32_bf16 v[116:119], v[188:191], v[164:167], v[116:119]
    v_mfma_f32_16x16x32_bf16 v[112:115], v[188:191], v[160:163], v[112:115]
    v_mfma_f32_16x16x32_bf16 v[96:99], v[184:187], v[160:163], v[96:99]
    s_waitcnt lgkmcnt(9)
    v_mfma_f32_16x16x32_bf16 v[64:67], v[144:147], v[128:131], v[64:67]
    ds_read_b64_tr_b16 v[160:161], v194 offset:40960
    v_mfma_f32_16x16x32_bf16 v[40:43], v[200:203], v[128:131], v[40:43]
    ds_read_b64_tr_b16 v[162:163], v194 offset:41984
    s_waitcnt lgkmcnt(10)
    v_mfma_f32_16x16x32_bf16 v[80:83], v[148:151], v[128:131], v[80:83]
    ds_read_b128 v[176:179], v193 offset:32768
    s_waitcnt lgkmcnt(9)
    v_mfma_f32_16x16x32_bf16 v[44:47], v[200:203], v[132:135], v[44:47]
    ds_read_b128 v[180:183], v193 offset:33792
    v_mfma_f32_16x16x32_bf16 v[84:87], v[148:151], v[132:135], v[84:87]
    ds_read_b64_tr_b16 v[164:165], v195 offset:40960
    v_mfma_f32_16x16x32_bf16 v[68:71], v[144:147], v[132:135], v[68:71]
    ds_read_b64_tr_b16 v[166:167], v195 offset:41984
    s_waitcnt lgkmcnt(10)
    v_mfma_f32_16x16x32_bf16 v[72:75], v[144:147], v[136:139], v[72:75]
    ds_read_b64_tr_b16 v[168:169], v196 offset:40960
    v_mfma_f32_16x16x32_bf16 v[88:91], v[148:151], v[136:139], v[88:91]
    ds_read_b64_tr_b16 v[170:171], v196 offset:41984
    s_waitcnt lgkmcnt(10)
    v_mfma_f32_16x16x32_bf16 v[92:95], v[148:151], v[140:143], v[92:95]
    ds_read_b64_tr_b16 v[172:173], v197 offset:40960
    v_mfma_f32_16x16x32_bf16 v[76:79], v[144:147], v[140:143], v[76:79]
    ds_read_b64_tr_b16 v[174:175], v197 offset:41984
    s_waitcnt lgkmcnt(11)
    v_mfma_f32_16x16x32_bf16 v[108:111], v[152:155], v[140:143], v[108:111]
    ds_read_b128 v[184:187], v193 offset:36864
    s_waitcnt lgkmcnt(11)
    v_mfma_f32_16x16x32_bf16 v[124:127], v[156:159], v[140:143], v[124:127]
    ds_read_b128 v[188:191], v193 offset:37888
    v_mfma_f32_16x16x32_bf16 v[120:123], v[156:159], v[136:139], v[120:123]
    v_mfma_f32_16x16x32_bf16 v[104:107], v[152:155], v[136:139], v[104:107]
    v_mfma_f32_16x16x32_bf16 v[100:103], v[152:155], v[132:135], v[100:103]
    v_mfma_f32_16x16x32_bf16 v[116:119], v[156:159], v[132:135], v[116:119]
    v_mfma_f32_16x16x32_bf16 v[112:115], v[156:159], v[128:131], v[112:115]
    v_mfma_f32_16x16x32_bf16 v[96:99], v[152:155], v[128:131], v[96:99]
    s_waitcnt lgkmcnt(9)
    s_barrier
    v_mfma_f32_16x16x32_bf16 v[64:67], v[176:179], v[160:163], v[64:67]
    ds_read_b64_tr_b16 v[128:129], v194 offset:49152
    v_mfma_f32_16x16x32_bf16 v[40:43], v[200:203], v[160:163], v[40:43]
    ds_read_b64_tr_b16 v[130:131], v194 offset:50176
    s_waitcnt lgkmcnt(10)
    v_mfma_f32_16x16x32_bf16 v[80:83], v[180:183], v[160:163], v[80:83]
    ds_read_b128 v[144:147], v192 offset:49152
    s_waitcnt lgkmcnt(9)
    v_mfma_f32_16x16x32_bf16 v[44:47], v[200:203], v[164:167], v[44:47]
    ds_read_b128 v[148:151], v192 offset:50176
    v_mfma_f32_16x16x32_bf16 v[84:87], v[180:183], v[164:167], v[84:87]
    ds_read_b64_tr_b16 v[132:133], v195 offset:49152
    v_mfma_f32_16x16x32_bf16 v[68:71], v[176:179], v[164:167], v[68:71]
    ds_read_b64_tr_b16 v[134:135], v195 offset:50176
    s_waitcnt lgkmcnt(10)
    v_mfma_f32_16x16x32_bf16 v[72:75], v[176:179], v[168:171], v[72:75]
    ds_read_b64_tr_b16 v[136:137], v196 offset:49152
    v_mfma_f32_16x16x32_bf16 v[88:91], v[180:183], v[168:171], v[88:91]
    ds_read_b64_tr_b16 v[138:139], v196 offset:50176
    s_waitcnt lgkmcnt(10)
    v_mfma_f32_16x16x32_bf16 v[92:95], v[180:183], v[172:175], v[92:95]
    ds_read_b64_tr_b16 v[140:141], v197 offset:49152
    v_mfma_f32_16x16x32_bf16 v[76:79], v[176:179], v[172:175], v[76:79]
    ds_read_b64_tr_b16 v[142:143], v197 offset:50176
    s_waitcnt lgkmcnt(11)
    v_mfma_f32_16x16x32_bf16 v[108:111], v[184:187], v[172:175], v[108:111]
    ds_read_b128 v[152:155], v192 offset:53248
    s_waitcnt lgkmcnt(11)
    v_mfma_f32_16x16x32_bf16 v[124:127], v[188:191], v[172:175], v[124:127]
    ds_read_b128 v[156:159], v192 offset:54272
    v_mfma_f32_16x16x32_bf16 v[120:123], v[188:191], v[168:171], v[120:123]
    v_mfma_f32_16x16x32_bf16 v[104:107], v[184:187], v[168:171], v[104:107]
    v_mfma_f32_16x16x32_bf16 v[100:103], v[184:187], v[164:167], v[100:103]
    v_mfma_f32_16x16x32_bf16 v[116:119], v[188:191], v[164:167], v[116:119]
    v_mfma_f32_16x16x32_bf16 v[112:115], v[188:191], v[160:163], v[112:115]
    v_mfma_f32_16x16x32_bf16 v[96:99], v[184:187], v[160:163], v[96:99]
    s_waitcnt lgkmcnt(9)
    v_mfma_f32_16x16x32_bf16 v[64:67], v[144:147], v[128:131], v[64:67]
    ds_read_b64_tr_b16 v[160:161], v194 offset:57344
    v_mfma_f32_16x16x32_bf16 v[40:43], v[200:203], v[128:131], v[40:43]
    ds_read_b64_tr_b16 v[162:163], v194 offset:58368
    s_waitcnt lgkmcnt(10)
    v_mfma_f32_16x16x32_bf16 v[80:83], v[148:151], v[128:131], v[80:83]
    ds_read_b128 v[176:179], v193 offset:49152
    s_waitcnt lgkmcnt(9)
    v_mfma_f32_16x16x32_bf16 v[44:47], v[200:203], v[132:135], v[44:47]
    ds_read_b128 v[180:183], v193 offset:50176
    v_mfma_f32_16x16x32_bf16 v[84:87], v[148:151], v[132:135], v[84:87]
    ds_read_b64_tr_b16 v[164:165], v195 offset:57344
    v_mfma_f32_16x16x32_bf16 v[68:71], v[144:147], v[132:135], v[68:71]
    ds_read_b64_tr_b16 v[166:167], v195 offset:58368
    s_waitcnt lgkmcnt(10)
    v_mfma_f32_16x16x32_bf16 v[72:75], v[144:147], v[136:139], v[72:75]
    ds_read_b64_tr_b16 v[168:169], v196 offset:57344
    v_mfma_f32_16x16x32_bf16 v[88:91], v[148:151], v[136:139], v[88:91]
    ds_read_b64_tr_b16 v[170:171], v196 offset:58368
    s_waitcnt lgkmcnt(10)
    v_mfma_f32_16x16x32_bf16 v[92:95], v[148:151], v[140:143], v[92:95]
    ds_read_b64_tr_b16 v[172:173], v197 offset:57344
    v_mfma_f32_16x16x32_bf16 v[76:79], v[144:147], v[140:143], v[76:79]
    ds_read_b64_tr_b16 v[174:175], v197 offset:58368
    s_waitcnt lgkmcnt(11)
    v_mfma_f32_16x16x32_bf16 v[108:111], v[152:155], v[140:143], v[108:111]
    ds_read_b128 v[184:187], v193 offset:53248
    s_waitcnt lgkmcnt(11)
    v_mfma_f32_16x16x32_bf16 v[124:127], v[156:159], v[140:143], v[124:127]
    ds_read_b128 v[188:191], v193 offset:54272
    v_mfma_f32_16x16x32_bf16 v[120:123], v[156:159], v[136:139], v[120:123]
    v_mfma_f32_16x16x32_bf16 v[104:107], v[152:155], v[136:139], v[104:107]
    v_mfma_f32_16x16x32_bf16 v[100:103], v[152:155], v[132:135], v[100:103]
    v_mfma_f32_16x16x32_bf16 v[116:119], v[156:159], v[132:135], v[116:119]
    v_mfma_f32_16x16x32_bf16 v[112:115], v[156:159], v[128:131], v[112:115]
    v_mfma_f32_16x16x32_bf16 v[96:99], v[152:155], v[128:131], v[96:99]
    s_waitcnt lgkmcnt(9)
    s_barrier
    v_mfma_f32_16x16x32_bf16 v[64:67], v[176:179], v[160:163], v[64:67]
    s_branch L_TO1
L_TC1:
    s_branch L_CH_AR
L_TO1:
    ds_read_b64_tr_b16 v[128:129], v194 offset:0
    v_mfma_f32_16x16x32_bf16 v[40:43], v[200:203], v[160:163], v[40:43]
    ds_read_b64_tr_b16 v[130:131], v194 offset:1024
    s_waitcnt lgkmcnt(10)
    v_mfma_f32_16x16x32_bf16 v[80:83], v[180:183], v[160:163], v[80:83]
    ds_read_b128 v[144:147], v192 offset:0
    s_waitcnt lgkmcnt(9)
    v_mfma_f32_16x16x32_bf16 v[44:47], v[200:203], v[164:167], v[44:47]
    ds_read_b128 v[148:151], v192 offset:1024
    v_mfma_f32_16x16x32_bf16 v[84:87], v[180:183], v[164:167], v[84:87]
    ds_read_b64_tr_b16 v[132:133], v195 offset:0
    v_mfma_f32_16x16x32_bf16 v[68:71], v[176:179], v[164:167], v[68:71]
    ds_read_b64_tr_b16 v[134:135], v195 offset:1024
    s_waitcnt lgkmcnt(10)
    v_mfma_f32_16x16x32_bf16 v[72:75], v[176:179], v[168:171], v[72:75]
    ds_read_b64_tr_b16 v[136:137], v196 offset:0
    v_mfma_f32_16x16x32_bf16 v[88:91], v[180:183], v[168:171], v[88:91]
    ds_read_b64_tr_b16 v[138:139], v196 offset:1024
    s_waitcnt lgkmcnt(10)
    v_mfma_f32_16x16x32_bf16 v[92:95], v[180:183], v[172:175], v[92:95]
    ds_read_b64_tr_b16 v[140:141], v197 offset:0
    v_mfma_f32_16x16x32_bf16 v[76:79], v[176:179], v[172:175], v[76:79]
    ds_read_b64_tr_b16 v[142:143], v197 offset:1024
    s_waitcnt lgkmcnt(11)
    v_mfma_f32_16x16x32_bf16 v[108:111], v[184:187], v[172:175], v[108:111]
    ds_read_b128 v[152:155], v192 offset:4096
    s_waitcnt lgkmcnt(11)
    v_mfma_f32_16x16x32_bf16 v[124:127], v[188:191], v[172:175], v[124:127]
    ds_read_b128 v[156:159], v192 offset:5120
    v_mfma_f32_16x16x32_bf16 v[120:123], v[188:191], v[168:171], v[120:123]
    v_mfma_f32_16x16x32_bf16 v[104:107], v[184:187], v[168:171], v[104:107]
    v_mfma_f32_16x16x32_bf16 v[100:103], v[184:187], v[164:167], v[100:103]
    v_mfma_f32_16x16x32_bf16 v[116:119], v[188:191], v[164:167], v[116:119]
    v_mfma_f32_16x16x32_bf16 v[112:115], v[188:191], v[160:163], v[112:115]
    v_mfma_f32_16x16x32_bf16 v[96:99], v[184:187], v[160:163], v[96:99]
    s_waitcnt lgkmcnt(9)
    v_mfma_f32_16x16x32_bf16 v[64:67], v[144:147], v[128:131], v[64:67]
    ds_read_b64_tr_b16 v[160:161], v194 offset:8192
    v_mfma_f32_16x16x32_bf16 v[40:43], v[200:203], v[128:131], v[40:43]
    ds_read_b64_tr_b16 v[162:163], v194 offset:9216
    s_waitcnt lgkmcnt(10)
    v_mfma_f32_16x16x32_bf16 v[80:83], v[148:151], v[128:131], v[80:83]
    ds_read_b128 v[176:179], v193 offset:0
    s_waitcnt lgkmcnt(9)
    v_mfma_f32_16x16x32_bf16 v[44:47], v[200:203], v[132:135], v[44:47]
    ds_read_b128 v[180:183], v193 offset:1024
    v_mfma_f32_16x16x32_bf16 v[84:87], v[148:151], v[132:135], v[84:87]
    ds_read_b64_tr_b16 v[164:165], v195 offset:8192
    v_mfma_f32_16x16x32_bf16 v[68:71], v[144:147], v[132:135], v[68:71]
    ds_read_b64_tr_b16 v[166:167], v195 offset:9216
    s_waitcnt lgkmcnt(10)
    v_mfma_f32_16x16x32_bf16 v[72:75], v[144:147], v[136:139], v[72:75]
    ds_read_b64_tr_b16 v[168:169], v196 offset:8192
    v_mfma_f32_16x16x32_bf16 v[88:91], v[148:151], v[136:139], v[88:91]
    ds_read_b64_tr_b16 v[170:171], v196 offset:9216
    s_waitcnt lgkmcnt(10)
    v_mfma_f32_16x16x32_bf16 v[92:95], v[148:151], v[140:143], v[92:95]
    ds_read_b64_tr_b16 v[172:173], v197 offset:8192
    v_mfma_f32_16x16x32_bf16 v[76:79], v[144:147], v[140:143], v[76:79]
    ds_read_b64_tr_b16 v[174:175], v197 offset:9216
    s_waitcnt lgkmcnt(11)
    v_mfma_f32_16x16x32_bf16 v[108:111], v[152:155], v[140:143], v[108:111]
    ds_read_b128 v[184:187], v193 offset:4096
    s_waitcnt lgkmcnt(11)
    v_mfma_f32_16x16x32_bf16 v[124:127], v[156:159], v[140:143], v[124:127]
    ds_read_b128 v[188:191], v193 offset:5120
    v_mfma_f32_16x16x32_bf16 v[120:123], v[156:159], v[136:139], v[120:123]
    v_mfma_f32_16x16x32_bf16 v[104:107], v[152:155], v[136:139], v[104:107]
    v_mfma_f32_16x16x32_bf16 v[100:103], v[152:155], v[132:135], v[100:103]
    v_mfma_f32_16x16x32_bf16 v[116:119], v[156:159], v[132:135], v[116:119]
    v_mfma_f32_16x16x32_bf16 v[112:115], v[156:159], v[128:131], v[112:115]
    v_mfma_f32_16x16x32_bf16 v[96:99], v[152:155], v[128:131], v[96:99]
    s_waitcnt lgkmcnt(9)
    s_barrier
    v_mfma_f32_16x16x32_bf16 v[64:67], v[176:179], v[160:163], v[64:67]
    ds_read_b64_tr_b16 v[128:129], v194 offset:16384
    v_mfma_f32_16x16x32_bf16 v[40:43], v[200:203], v[160:163], v[40:43]
    ds_read_b64_tr_b16 v[130:131], v194 offset:17408
    s_waitcnt lgkmcnt(10)
    v_mfma_f32_16x16x32_bf16 v[80:83], v[180:183], v[160:163], v[80:83]
    ds_read_b128 v[144:147], v192 offset:16384
    s_waitcnt lgkmcnt(9)
    v_mfma_f32_16x16x32_bf16 v[44:47], v[200:203], v[164:167], v[44:47]
    ds_read_b128 v[148:151], v192 offset:17408
    v_mfma_f32_16x16x32_bf16 v[84:87], v[180:183], v[164:167], v[84:87]
    ds_read_b64_tr_b16 v[132:133], v195 offset:16384
    v_mfma_f32_16x16x32_bf16 v[68:71], v[176:179], v[164:167], v[68:71]
    ds_read_b64_tr_b16 v[134:135], v195 offset:17408
    s_waitcnt lgkmcnt(10)
    v_mfma_f32_16x16x32_bf16 v[72:75], v[176:179], v[168:171], v[72:75]
    ds_read_b64_tr_b16 v[136:137], v196 offset:16384
    v_mfma_f32_16x16x32_bf16 v[88:91], v[180:183], v[168:171], v[88:91]
    ds_read_b64_tr_b16 v[138:139], v196 offset:17408
    s_waitcnt lgkmcnt(10)
    v_mfma_f32_16x16x32_bf16 v[92:95], v[180:183], v[172:175], v[92:95]
    ds_read_b64_tr_b16 v[140:141], v197 offset:16384
    v_mfma_f32_16x16x32_bf16 v[76:79], v[176:179], v[172:175], v[76:79]
    ds_read_b64_tr_b16 v[142:143], v197 offset:17408
    s_waitcnt lgkmcnt(11)
    v_mfma_f32_16x16x32_bf16 v[108:111], v[184:187], v[172:175], v[108:111]
    ds_read_b128 v[152:155], v192 offset:20480
    s_waitcnt lgkmcnt(11)
    v_mfma_f32_16x16x32_bf16 v[124:127], v[188:191], v[172:175], v[124:127]
    ds_read_b128 v[156:159], v192 offset:21504
    v_mfma_f32_16x16x32_bf16 v[120:123], v[188:191], v[168:171], v[120:123]
    v_mfma_f32_16x16x32_bf16 v[104:107], v[184:187], v[168:171], v[104:107]
    v_mfma_f32_16x16x32_bf16 v[100:103], v[184:187], v[164:167], v[100:103]
    v_mfma_f32_16x16x32_bf16 v[116:119], v[188:191], v[164:167], v[116:119]
    v_mfma_f32_16x16x32_bf16 v[112:115], v[188:191], v[160:163], v[112:115]
    v_mfma_f32_16x16x32_bf16 v[96:99], v[184:187], v[160:163], v[96:99]
    s_waitcnt lgkmcnt(9)
    v_mfma_f32_16x16x32_bf16 v[64:67], v[144:147], v[128:131], v[64:67]
    ds_read_b64_tr_b16 v[160:161], v194 offset:24576
    v_mfma_f32_16x16x32_bf16 v[40:43], v[200:203], v[128:131], v[40:43]
    ds_read_b64_tr_b16 v[162:163], v194 offset:25600
    s_waitcnt lgkmcnt(10)
    v_mfma_f32_16x16x32_bf16 v[80:83], v[148:151], v[128:131], v[80:83]
    ds_read_b128 v[176:179], v193 offset:16384
    s_waitcnt lgkmcnt(9)
    v_mfma_f32_16x16x32_bf16 v[44:47], v[200:203], v[132:135], v[44:47]
    ds_read_b128 v[180:183], v193 offset:17408
    v_mfma_f32_16x16x32_bf16 v[84:87], v[148:151], v[132:135], v[84:87]
    ds_read_b64_tr_b16 v[164:165], v195 offset:24576
    v_mfma_f32_16x16x32_bf16 v[68:71], v[144:147], v[132:135], v[68:71]
    ds_read_b64_tr_b16 v[166:167], v195 offset:25600
    s_waitcnt lgkmcnt(10)
    v_mfma_f32_16x16x32_bf16 v[72:75], v[144:147], v[136:139], v[72:75]
    ds_read_b64_tr_b16 v[168:169], v196 offset:24576
    v_mfma_f32_16x16x32_bf16 v[88:91], v[148:151], v[136:139], v[88:91]
    ds_read_b64_tr_b16 v[170:171], v196 offset:25600
    s_waitcnt lgkmcnt(10)
    v_mfma_f32_16x16x32_bf16 v[92:95], v[148:151], v[140:143], v[92:95]
    ds_read_b64_tr_b16 v[172:173], v197 offset:24576
    v_mfma_f32_16x16x32_bf16 v[76:79], v[144:147], v[140:143], v[76:79]
    ds_read_b64_tr_b16 v[174:175], v197 offset:25600
    s_waitcnt lgkmcnt(11)
    v_mfma_f32_16x16x32_bf16 v[108:111], v[152:155], v[140:143], v[108:111]
    ds_read_b128 v[184:187], v193 offset:20480
    s_waitcnt lgkmcnt(11)
    v_mfma_f32_16x16x32_bf16 v[124:127], v[156:159], v[140:143], v[124:127]
    ds_read_b128 v[188:191], v193 offset:21504
    v_mfma_f32_16x16x32_bf16 v[120:123], v[156:159], v[136:139], v[120:123]
    v_mfma_f32_16x16x32_bf16 v[104:107], v[152:155], v[136:139], v[104:107]
    v_mfma_f32_16x16x32_bf16 v[100:103], v[152:155], v[132:135], v[100:103]
    v_mfma_f32_16x16x32_bf16 v[116:119], v[156:159], v[132:135], v[116:119]
    v_mfma_f32_16x16x32_bf16 v[112:115], v[156:159], v[128:131], v[112:115]
    v_mfma_f32_16x16x32_bf16 v[96:99], v[152:155], v[128:131], v[96:99]
    s_waitcnt lgkmcnt(9)
    s_barrier
    v_mfma_f32_16x16x32_bf16 v[64:67], v[176:179], v[160:163], v[64:67]
    ds_read_b64_tr_b16 v[128:129], v194 offset:32768
    v_mfma_f32_16x16x32_bf16 v[40:43], v[200:203], v[160:163], v[40:43]
    ds_read_b64_tr_b16 v[130:131], v194 offset:33792
    s_waitcnt lgkmcnt(10)
    v_mfma_f32_16x16x32_bf16 v[80:83], v[180:183], v[160:163], v[80:83]
    ds_read_b128 v[144:147], v192 offset:32768
    s_waitcnt lgkmcnt(9)
    v_mfma_f32_16x16x32_bf16 v[44:47], v[200:203], v[164:167], v[44:47]
    ds_read_b128 v[148:151], v192 offset:33792
    v_mfma_f32_16x16x32_bf16 v[84:87], v[180:183], v[164:167], v[84:87]
    ds_read_b64_tr_b16 v[132:133], v195 offset:32768
    v_mfma_f32_16x16x32_bf16 v[68:71], v[176:179], v[164:167], v[68:71]
    ds_read_b64_tr_b16 v[134:135], v195 offset:33792
    s_waitcnt lgkmcnt(10)
    v_mfma_f32_16x16x32_bf16 v[72:75], v[176:179], v[168:171], v[72:75]
    ds_read_b64_tr_b16 v[136:137], v196 offset:32768
    v_mfma_f32_16x16x32_bf16 v[88:91], v[180:183], v[168:171], v[88:91]
    ds_read_b64_tr_b16 v[138:139], v196 offset:33792
    s_waitcnt lgkmcnt(10)
    v_mfma_f32_16x16x32_bf16 v[92:95], v[180:183], v[172:175], v[92:95]
    ds_read_b64_tr_b16 v[140:141], v197 offset:32768
    v_mfma_f32_16x16x32_bf16 v[76:79], v[176:179], v[172:175], v[76:79]
    ds_read_b64_tr_b16 v[142:143], v197 offset:33792
    s_waitcnt lgkmcnt(11)
    v_mfma_f32_16x16x32_bf16 v[108:111], v[184:187], v[172:175], v[108:111]
    ds_read_b128 v[152:155], v192 offset:36864
    s_waitcnt lgkmcnt(11)
    v_mfma_f32_16x16x32_bf16 v[124:127], v[188:191], v[172:175], v[124:127]
    ds_read_b128 v[156:159], v192 offset:37888
    v_mfma_f32_16x16x32_bf16 v[120:123], v[188:191], v[168:171], v[120:123]
    v_mfma_f32_16x16x32_bf16 v[104:107], v[184:187], v[168:171], v[104:107]
    v_mfma_f32_16x16x32_bf16 v[100:103], v[184:187], v[164:167], v[100:103]
    v_mfma_f32_16x16x32_bf16 v[116:119], v[188:191], v[164:167], v[116:119]
    v_mfma_f32_16x16x32_bf16 v[112:115], v[188:191], v[160:163], v[112:115]
    v_mfma_f32_16x16x32_bf16 v[96:99], v[184:187], v[160:163], v[96:99]
    s_waitcnt lgkmcnt(9)
    v_mfma_f32_16x16x32_bf16 v[64:67], v[144:147], v[128:131], v[64:67]
    ds_read_b64_tr_b16 v[160:161], v194 offset:40960
    v_mfma_f32_16x16x32_bf16 v[40:43], v[200:203], v[128:131], v[40:43]
    ds_read_b64_tr_b16 v[162:163], v194 offset:41984
    s_waitcnt lgkmcnt(10)
    v_mfma_f32_16x16x32_bf16 v[80:83], v[148:151], v[128:131], v[80:83]
    ds_read_b128 v[176:179], v193 offset:32768
    s_waitcnt lgkmcnt(9)
    v_mfma_f32_16x16x32_bf16 v[44:47], v[200:203], v[132:135], v[44:47]
    ds_read_b128 v[180:183], v193 offset:33792
    v_mfma_f32_16x16x32_bf16 v[84:87], v[148:151], v[132:135], v[84:87]
    ds_read_b64_tr_b16 v[164:165], v195 offset:40960
    v_mfma_f32_16x16x32_bf16 v[68:71], v[144:147], v[132:135], v[68:71]
    ds_read_b64_tr_b16 v[166:167], v195 offset:41984
    s_waitcnt lgkmcnt(10)
    v_mfma_f32_16x16x32_bf16 v[72:75], v[144:147], v[136:139], v[72:75]
    ds_read_b64_tr_b16 v[168:169], v196 offset:40960
    v_mfma_f32_16x16x32_bf16 v[88:91], v[148:151], v[136:139], v[88:91]
    ds_read_b64_tr_b16 v[170:171], v196 offset:41984
    s_waitcnt lgkmcnt(10)
    v_mfma_f32_16x16x32_bf16 v[92:95], v[148:151], v[140:143], v[92:95]
    ds_read_b64_tr_b16 v[172:173], v197 offset:40960
    v_mfma_f32_16x16x32_bf16 v[76:79], v[144:147], v[140:143], v[76:79]
    ds_read_b64_tr_b16 v[174:175], v197 offset:41984
    s_waitcnt lgkmcnt(11)
    v_mfma_f32_16x16x32_bf16 v[108:111], v[152:155], v[140:143], v[108:111]
    ds_read_b128 v[184:187], v193 offset:36864
    s_waitcnt lgkmcnt(11)
    v_mfma_f32_16x16x32_bf16 v[124:127], v[156:159], v[140:143], v[124:127]
    ds_read_b128 v[188:191], v193 offset:37888
    v_mfma_f32_16x16x32_bf16 v[120:123], v[156:159], v[136:139], v[120:123]
    v_mfma_f32_16x16x32_bf16 v[104:107], v[152:155], v[136:139], v[104:107]
    v_mfma_f32_16x16x32_bf16 v[100:103], v[152:155], v[132:135], v[100:103]
    v_mfma_f32_16x16x32_bf16 v[116:119], v[156:159], v[132:135], v[116:119]
    v_mfma_f32_16x16x32_bf16 v[112:115], v[156:159], v[128:131], v[112:115]
    v_mfma_f32_16x16x32_bf16 v[96:99], v[152:155], v[128:131], v[96:99]
    s_waitcnt lgkmcnt(9)
    s_barrier
    v_mfma_f32_16x16x32_bf16 v[64:67], v[176:179], v[160:163], v[64:67]
    ds_read_b64_tr_b16 v[128:129], v194 offset:49152
    v_mfma_f32_16x16x32_bf16 v[40:43], v[200:203], v[160:163], v[40:43]
    ds_read_b64_tr_b16 v[130:131], v194 offset:50176
    s_waitcnt lgkmcnt(10)
    v_mfma_f32_16x16x32_bf16 v[80:83], v[180:183], v[160:163], v[80:83]
    ds_read_b128 v[144:147], v192 offset:49152
    s_waitcnt lgkmcnt(9)
    v_mfma_f32_16x16x32_bf16 v[44:47], v[200:203], v[164:167], v[44:47]
    ds_read_b128 v[148:151], v192 offset:50176
    v_mfma_f32_16x16x32_bf16 v[84:87], v[180:183], v[164:167], v[84:87]
    ds_read_b64_tr_b16 v[132:133], v195 offset:49152
    v_mfma_f32_16x16x32_bf16 v[68:71], v[176:179], v[164:167], v[68:71]
    ds_read_b64_tr_b16 v[134:135], v195 offset:50176
    s_waitcnt lgkmcnt(10)
    v_mfma_f32_16x16x32_bf16 v[72:75], v[176:179], v[168:171], v[72:75]
    ds_read_b64_tr_b16 v[136:137], v196 offset:49152
    v_mfma_f32_16x16x32_bf16 v[88:91], v[180:183], v[168:171], v[88:91]
    ds_read_b64_tr_b16 v[138:139], v196 offset:50176
    s_waitcnt lgkmcnt(10)
    v_mfma_f32_16x16x32_bf16 v[92:95], v[180:183], v[172:175], v[92:95]
    ds_read_b64_tr_b16 v[140:141], v197 offset:49152
    v_mfma_f32_16x16x32_bf16 v[76:79], v[176:179], v[172:175], v[76:79]
    ds_read_b64_tr_b16 v[142:143], v197 offset:50176
    s_waitcnt lgkmcnt(11)
    v_mfma_f32_16x16x32_bf16 v[108:111], v[184:187], v[172:175], v[108:111]
    ds_read_b128 v[152:155], v192 offset:53248
    s_waitcnt lgkmcnt(11)
    v_mfma_f32_16x16x32_bf16 v[124:127], v[188:191], v[172:175], v[124:127]
    ds_read_b128 v[156:159], v192 offset:54272
    v_mfma_f32_16x16x32_bf16 v[120:123], v[188:191], v[168:171], v[120:123]
    v_mfma_f32_16x16x32_bf16 v[104:107], v[184:187], v[168:171], v[104:107]
    v_mfma_f32_16x16x32_bf16 v[100:103], v[184:187], v[164:167], v[100:103]
    v_mfma_f32_16x16x32_bf16 v[116:119], v[188:191], v[164:167], v[116:119]
    v_mfma_f32_16x16x32_bf16 v[112:115], v[188:191], v[160:163], v[112:115]
    v_mfma_f32_16x16x32_bf16 v[96:99], v[184:187], v[160:163], v[96:99]
    s_waitcnt lgkmcnt(9)
    v_mfma_f32_16x16x32_bf16 v[64:67], v[144:147], v[128:131], v[64:67]
    ds_read_b64_tr_b16 v[160:161], v194 offset:57344
    v_mfma_f32_16x16x32_bf16 v[40:43], v[200:203], v[128:131], v[40:43]
    ds_read_b64_tr_b16 v[162:163], v194 offset:58368
    s_waitcnt lgkmcnt(10)
    v_mfma_f32_16x16x32_bf16 v[80:83], v[148:151], v[128:131], v[80:83]
    ds_read_b64_tr_b16 v[164:165], v195 offset:57344
    s_waitcnt lgkmcnt(9)
    v_mfma_f32_16x16x32_bf16 v[44:47], v[200:203], v[132:135], v[44:47]
    ds_read_b64_tr_b16 v[166:167], v195 offset:58368
    v_mfma_f32_16x16x32_bf16 v[84:87], v[148:151], v[132:135], v[84:87]
    ds_read_b128 v[176:179], v193 offset:49152
    v_mfma_f32_16x16x32_bf16 v[68:71], v[144:147], v[132:135], v[68:71]
    ds_read_b128 v[180:183], v193 offset:50176
    s_waitcnt lgkmcnt(10)
    v_mfma_f32_16x16x32_bf16 v[72:75], v[144:147], v[136:139], v[72:75]
    ds_read_b128 v[184:187], v193 offset:53248
    v_mfma_f32_16x16x32_bf16 v[88:91], v[148:151], v[136:139], v[88:91]
    ds_read_b128 v[188:191], v193 offset:54272
    s_waitcnt lgkmcnt(10)
    v_mfma_f32_16x16x32_bf16 v[92:95], v[148:151], v[140:143], v[92:95]
    ds_read_b64_tr_b16 v[168:169], v196 offset:57344
    v_mfma_f32_16x16x32_bf16 v[76:79], v[144:147], v[140:143], v[76:79]
    ds_read_b64_tr_b16 v[170:171], v196 offset:58368
    s_waitcnt lgkmcnt(11)
    v_mfma_f32_16x16x32_bf16 v[108:111], v[152:155], v[140:143], v[108:111]
    ds_read_b64_tr_b16 v[172:173], v197 offset:57344
    s_waitcnt lgkmcnt(11)
    v_mfma_f32_16x16x32_bf16 v[124:127], v[156:159], v[140:143], v[124:127]
    ds_read_b64_tr_b16 v[174:175], v197 offset:58368
    v_mfma_f32_16x16x32_bf16 v[120:123], v[156:159], v[136:139], v[120:123]
    v_mfma_f32_16x16x32_bf16 v[104:107], v[152:155], v[136:139], v[104:107]
    v_mfma_f32_16x16x32_bf16 v[100:103], v[152:155], v[132:135], v[100:103]
    v_mfma_f32_16x16x32_bf16 v[116:119], v[156:159], v[132:135], v[116:119]
    v_mfma_f32_16x16x32_bf16 v[112:115], v[156:159], v[128:131], v[112:115]
    v_mfma_f32_16x16x32_bf16 v[96:99], v[152:155], v[128:131], v[96:99]
    s_waitcnt lgkmcnt(10)
    v_mfma_f32_16x16x32_bf16 v[40:43], v[200:203], v[160:163], v[40:43]
    s_waitcnt lgkmcnt(8)
    v_mfma_f32_16x16x32_bf16 v[44:47], v[200:203], v[164:167], v[44:47]
    s_waitcnt lgkmcnt(7)
    v_mfma_f32_16x16x32_bf16 v[64:67], v[176:179], v[160:163], v[64:67]
    s_waitcnt lgkmcnt(6)
    v_mfma_f32_16x16x32_bf16 v[80:83], v[180:183], v[160:163], v[80:83]
    s_nop 1
    ds_write_b64 v208, v[40:41] offset:0
    s_nop 0
    ds_write_b64 v208, v[44:45] offset:1024
    v_mfma_f32_16x16x32_bf16 v[84:87], v[180:183], v[164:167], v[84:87]
    v_mfma_f32_16x16x32_bf16 v[68:71], v[176:179], v[164:167], v[68:71]
    s_waitcnt lgkmcnt(7)
    v_mfma_f32_16x16x32_bf16 v[100:103], v[184:187], v[164:167], v[100:103]
    s_waitcnt lgkmcnt(6)
    v_mfma_f32_16x16x32_bf16 v[116:119], v[188:191], v[164:167], v[116:119]
    v_mfma_f32_16x16x32_bf16 v[112:115], v[188:191], v[160:163], v[112:115]
    v_mfma_f32_16x16x32_bf16 v[96:99], v[184:187], v[160:163], v[96:99]
    s_waitcnt lgkmcnt(0)
    s_barrier
    ds_read_b64 v[48:49], v209 offset:0
    ds_read_b64 v[52:53], v209 offset:1024
    ds_read_b128 v[8:11], v207 offset:0
    ds_read_b128 v[24:27], v207 offset:512
    v_mfma_f32_16x16x32_bf16 v[104:107], v[184:187], v[168:171], v[104:107]
    ds_read_b128 v[12:15], v207 offset:32
    v_mfma_f32_16x16x32_bf16 v[120:123], v[188:191], v[168:171], v[120:123]
    ds_read_b128 v[28:31], v207 offset:544
    v_mfma_f32_16x16x32_bf16 v[124:127], v[188:191], v[172:175], v[124:127]
    ds_read_b128 v[16:19], v207 offset:128
    v_mfma_f32_16x16x32_bf16 v[108:111], v[184:187], v[172:175], v[108:111]
    ds_read_b128 v[32:35], v207 offset:640
    v_mfma_f32_16x16x32_bf16 v[76:79], v[176:179], v[172:175], v[76:79]
    ds_read_b128 v[20:23], v207 offset:160
    v_mfma_f32_16x16x32_bf16 v[92:95], v[180:183], v[172:175], v[92:95]
    ds_read_b128 v[36:39], v207 offset:672
    v_mfma_f32_16x16x32_bf16 v[88:91], v[180:183], v[168:171], v[88:91]
    ds_read_b32 v210, v210
    v_mfma_f32_16x16x32_bf16 v[72:75], v[176:179], v[168:171], v[72:75]
    s_waitcnt lgkmcnt(5)
    v_pk_fma_f32 v[64:65], v[8:9], v[40:41], v[64:65]
    v_pk_fma_f32 v[66:67], v[10:11], v[40:41], v[66:67]
    v_pk_mul_f32 v[64:65], v[64:65], v[24:25]
    v_pk_mul_f32 v[66:67], v[66:67], v[26:27]
    v_pk_fma_f32 v[80:81], v[12:13], v[40:41], v[80:81]
    v_pk_fma_f32 v[82:83], v[14:15], v[40:41], v[82:83]
    v_pk_mul_f32 v[80:81], v[80:81], v[28:29]
    v_pk_mul_f32 v[82:83], v[82:83], v[30:31]
    v_cvt_pk_bf16_f32 v56, v64, v65
    v_cvt_pk_bf16_f32 v57, v66, v67
    v_cvt_pk_bf16_f32 v58, v80, v81
    v_cvt_pk_bf16_f32 v59, v82, v83
    buffer_store_dwordx4 v[56:59], v206, s[16:19], s45 offen offset:0 sc1
    v_pk_fma_f32 v[68:69], v[8:9], v[44:45], v[68:69]
    v_pk_fma_f32 v[70:71], v[10:11], v[44:45], v[70:71]
    v_pk_mul_f32 v[68:69], v[68:69], v[24:25]
    v_pk_mul_f32 v[70:71], v[70:71], v[26:27]
    v_pk_fma_f32 v[84:85], v[12:13], v[44:45], v[84:85]
    v_pk_fma_f32 v[86:87], v[14:15], v[44:45], v[86:87]
    v_pk_mul_f32 v[84:85], v[84:85], v[28:29]
    v_pk_mul_f32 v[86:87], v[86:87], v[30:31]
    v_cvt_pk_bf16_f32 v60, v68, v69
    v_cvt_pk_bf16_f32 v61, v70, v71
    v_cvt_pk_bf16_f32 v62, v84, v85
    v_cvt_pk_bf16_f32 v63, v86, v87
    buffer_store_dwordx4 v[60:63], v206, s[16:19], s45 offen offset:256 sc1
    s_waitcnt lgkmcnt(1)
    v_pk_fma_f32 v[100:101], v[16:17], v[44:45], v[100:101]
    v_pk_fma_f32 v[102:103], v[18:19], v[44:45], v[102:103]
    v_pk_mul_f32 v[100:101], v[100:101], v[32:33]
    v_pk_mul_f32 v[102:103], v[102:103], v[34:35]
    v_pk_fma_f32 v[116:117], v[20:21], v[44:45], v[116:117]
    v_pk_fma_f32 v[118:119], v[22:23], v[44:45], v[118:119]
    v_pk_mul_f32 v[116:117], v[116:117], v[36:37]
    v_pk_mul_f32 v[118:119], v[118:119], v[38:39]
    v_cvt_pk_bf16_f32 v56, v100, v101
    v_cvt_pk_bf16_f32 v57, v102, v103
    v_cvt_pk_bf16_f32 v58, v116, v117
    v_cvt_pk_bf16_f32 v59, v118, v119
    buffer_store_dwordx4 v[56:59], v206, s[16:19], s47 offen offset:256 sc1
    v_pk_fma_f32 v[96:97], v[16:17], v[40:41], v[96:97]
    v_pk_fma_f32 v[98:99], v[18:19], v[40:41], v[98:99]
    v_pk_mul_f32 v[96:97], v[96:97], v[32:33]
    v_pk_mul_f32 v[98:99], v[98:99], v[34:35]
    v_pk_fma_f32 v[112:113], v[20:21], v[40:41], v[112:113]
    v_pk_fma_f32 v[114:115], v[22:23], v[40:41], v[114:115]
    v_pk_mul_f32 v[112:113], v[112:113], v[36:37]
    v_pk_mul_f32 v[114:115], v[114:115], v[38:39]
    v_cvt_pk_bf16_f32 v60, v96, v97
    v_cvt_pk_bf16_f32 v61, v98, v99
    v_cvt_pk_bf16_f32 v62, v112, v113
    v_cvt_pk_bf16_f32 v63, v114, v115
    buffer_store_dwordx4 v[60:63], v206, s[16:19], s47 offen offset:0 sc1
    v_pk_fma_f32 v[104:105], v[16:17], v[48:49], v[104:105]
    v_pk_fma_f32 v[106:107], v[18:19], v[48:49], v[106:107]
    v_pk_mul_f32 v[104:105], v[104:105], v[32:33]
    v_pk_mul_f32 v[106:107], v[106:107], v[34:35]
    v_pk_fma_f32 v[120:121], v[20:21], v[48:49], v[120:121]
    v_pk_fma_f32 v[122:123], v[22:23], v[48:49], v[122:123]
    v_pk_mul_f32 v[120:121], v[120:121], v[36:37]
    v_pk_mul_f32 v[122:123], v[122:123], v[38:39]
    v_cvt_pk_bf16_f32 v56, v104, v105
    v_cvt_pk_bf16_f32 v57, v106, v107
    v_cvt_pk_bf16_f32 v58, v120, v121
    v_cvt_pk_bf16_f32 v59, v122, v123
    buffer_store_dwordx4 v[56:59], v206, s[16:19], s49 offen offset:0 sc1
    v_pk_fma_f32 v[108:109], v[16:17], v[52:53], v[108:109]
    v_pk_fma_f32 v[110:111], v[18:19], v[52:53], v[110:111]
    v_pk_mul_f32 v[108:109], v[108:109], v[32:33]
    v_pk_mul_f32 v[110:111], v[110:111], v[34:35]
    v_pk_fma_f32 v[124:125], v[20:21], v[52:53], v[124:125]
    v_pk_fma_f32 v[126:127], v[22:23], v[52:53], v[126:127]
    v_pk_mul_f32 v[124:125], v[124:125], v[36:37]
    v_pk_mul_f32 v[126:127], v[126:127], v[38:39]
    v_cvt_pk_bf16_f32 v60, v108, v109
    v_cvt_pk_bf16_f32 v61, v110, v111
    v_cvt_pk_bf16_f32 v62, v124, v125
    v_cvt_pk_bf16_f32 v63, v126, v127
    buffer_store_dwordx4 v[60:63], v206, s[16:19], s49 offen offset:256 sc1
    v_pk_fma_f32 v[76:77], v[8:9], v[52:53], v[76:77]
    v_pk_fma_f32 v[78:79], v[10:11], v[52:53], v[78:79]
    v_pk_mul_f32 v[76:77], v[76:77], v[24:25]
    v_pk_mul_f32 v[78:79], v[78:79], v[26:27]
    v_pk_fma_f32 v[92:93], v[12:13], v[52:53], v[92:93]
    v_pk_fma_f32 v[94:95], v[14:15], v[52:53], v[94:95]
    v_pk_mul_f32 v[92:93], v[92:93], v[28:29]
    v_pk_mul_f32 v[94:95], v[94:95], v[30:31]
    v_cvt_pk_bf16_f32 v56, v76, v77
    v_cvt_pk_bf16_f32 v57, v78, v79
    v_cvt_pk_bf16_f32 v58, v92, v93
    v_cvt_pk_bf16_f32 v59, v94, v95
    buffer_store_dwordx4 v[56:59], v206, s[16:19], s48 offen offset:256 sc1
    v_pk_fma_f32 v[72:73], v[8:9], v[48:49], v[72:73]
    v_pk_fma_f32 v[74:75], v[10:11], v[48:49], v[74:75]
    v_pk_mul_f32 v[72:73], v[72:73], v[24:25]
    v_pk_mul_f32 v[74:75], v[74:75], v[26:27]
    v_pk_fma_f32 v[88:89], v[12:13], v[48:49], v[88:89]
    v_pk_fma_f32 v[90:91], v[14:15], v[48:49], v[90:91]
    v_pk_mul_f32 v[88:89], v[88:89], v[28:29]
    v_pk_mul_f32 v[90:91], v[90:91], v[30:31]
    v_cvt_pk_bf16_f32 v60, v72, v73
    v_cvt_pk_bf16_f32 v61, v74, v75
    v_cvt_pk_bf16_f32 v62, v88, v89
    v_cvt_pk_bf16_f32 v63, v90, v91
    buffer_store_dwordx4 v[60:63], v206, s[16:19], s48 offen offset:0 sc1
    s_waitcnt lgkmcnt(0)
    v_readfirstlane_b32 s70, v210
L_P1_END:
    s_and_b32 s42, s33, 3
    s_lshr_b32 s43, s33, 2
    s_mul_i32 s56, s37, 10240
    s_add_u32 s56, s56, 3866624
    s_mul_i32 s57, s36, 163840
    s_add_u32 s56, s56, s57
    s_mul_i32 s58, s37, 640
    s_add_u32 s57, s57, s58
    s_add_u32 s57, s57, 7012352
    s_lshl_b32 s3, s33, 10
    s_add_u32 s58, s56, s3
    s_add_u32 s51, s3, 133120
    s_lshr_b32 s50, s33, 1
    s_mul_i32 s50, s50, 6144
    s_and_b32 s59, s3, 1024
    s_add_u32 s50, s50, s59
    s_add_u32 s50, s50, 102400
    s_add_u32 s44, s58, 0
    s_add_u32 s47, s57, 0
    s_cmp_ge_u32 s36, 2
    s_cselect_b32 s44, s44, 2130706432
    s_cselect_b32 s47, s47, 2130706432
    s_add_u32 s45, s58, 163840
    s_add_u32 s48, s57, 163840
    s_cmp_ge_u32 s36, 1
    s_cselect_b32 s45, s45, 2130706432
    s_cselect_b32 s48, s48, 2130706432
    s_add_u32 s46, s58, 327680
    s_add_u32 s49, s57, 327680
    s_add_u32 s56, s56, s59
    s_add_u32 s56, s56, 172032
    s_add_u32 s57, s57, 163840
    s_add_u32 s58, s59, 129024
    s_add_u32 s59, s59, 151552
    s_cmp_ge_u32 s33, 6
    s_cselect_b32 s52, s57, s56
    s_cselect_b32 s53, s59, s58
    s_cselect_b64 s[64:65], -1, 0
    s_cmp_ge_u32 s36, 1
    s_cselect_b32 s52, s52, 2130706432
    s_cmp_ge_u32 s33, 4
    s_cselect_b32 s54, s57, s56
    s_cselect_b32 s55, s59, s58
    s_cselect_b32 s58, 5, 1
    s_cselect_b64 vcc, -1, 0
    s_bitcmp1_b32 s33, 1
    s_cselect_b32 s56, 1, -1
    s_mul_i32 s58, s58, s56
    s_mul_i32 s56, s56, 163840
    s_add_u32 s54, s54, s56
    s_lshl_b32 s58, s58, 11
    s_add_u32 s55, s55, s58
    s_and_b32 s56, s33, 2
    s_add_u32 s56, s56, s36
    s_cmp_ge_u32 s56, 2
    s_cselect_b32 s54, s54, 2130706432
    s_and_b32 s56, s33, 1
    s_add_u32 s56, s56, 8
    s_lshl_b32 s3, s33, 6
    v_add_u32 v2, s3, v1
    v_mul_u32_u24 v3, 1639, v2
    v_lshrrev_b32 v3, 16, v3
    v_mul_u32_u24 v4, 40, v3
    v_sub_u32 v4, v2, v4
    v_mul_u32_u24 v3, 10240, v3
    v_lshl_add_u32 v141, v4, 4, v3
    s_lshl_b32 s3, s56, 6
    v_add_u32 v2, s3, v1
    v_mul_u32_u24 v3, 1639, v2
    v_lshrrev_b32 v3, 16, v3
    v_mul_u32_u24 v4, 40, v3
    v_sub_u32 v4, v2, v4
    v_mul_u32_u24 v3, 10240, v3
    v_lshl_add_u32 v142, v4, 4, v3
    v_lshlrev_b32 v2, 4, v1
    v_cndmask_b32 v143, v2, v142, s[64:65]
    v_cndmask_b32 v144, v2, v142, vcc
    v_and_b32 v2, 31, v1
    v_lshrrev_b32 v3, 5, v1
    s_lshl_b32 s3, s42, 9
    s_add_u32 s57, s3, 114688
    v_lshl_add_u32 v137, v2, 4, s57
    s_mul_i32 s57, s43, 18432
    s_add_u32 s57, s57, s3
    s_add_u32 s57, s57, 102400
    v_lshl_add_u32 v136, v2, 4, s57
    v_mul_u32_u24 v4, 6144, v3
    v_add_u32 v136, v136, v4
    s_mul_i32 s57, s42, 2560
    s_mul_i32 s58, s43, 320
    s_add_u32 s57, s57, s58
    s_add_u32 s57, s57, 133120
    v_lshl_add_u32 v138, v2, 4, s57
    v_mul_u32_u24 v4, 640, v3
    v_add_u32 v138, v138, v4
    s_lshl_b32 s57, s42, 9
    s_mul_i32 s58, s42, 2560
    v_subrev_u32 v146, s57, v136
    v_subrev_u32 v147, s57, v137
    v_subrev_u32 v148, s58, v138
    s_cmp_ge_u32 s42, 3
    s_cselect_b32 s57, 2048, 0
    s_cselect_b32 s58, 10240, 0
    v_add_u32 v149, s57, v136
    v_add_u32 v150, s57, v137
    v_add_u32 v151, s58, v138
    s_cmp_ge_u32 s42, 2
    s_cselect_b32 s57, 2048, 0
    s_cselect_b32 s58, 10240, 0
    v_add_u32 v152, s57, v136
    v_add_u32 v153, s57, v137
    v_add_u32 v154, s58, v138
    s_cmp_ge_u32 s42, 1
    s_cselect_b32 s57, 2048, 0
    s_cselect_b32 s58, 10240, 0
    v_add_u32 v155, s57, v136
    v_add_u32 v156, s57, v137
    v_add_u32 v157, s58, v138
    v_lshl_add_u32 v4, v3, 2, 0
    v_mov_b32 v5, 0xf149f2ca
    v_add_u32 v6, 0, v4
    v_cmp_le_u32 vcc, v6, v2
    v_mov_b32 v88, 0
    s_nop 0
    v_cndmask_b32 v104, v5, 0, vcc
    v_cndmask_b32 v120, 0, v5, vcc
    v_add_u32 v6, 1, v4
    v_cmp_le_u32 vcc, v6, v2
    v_mov_b32 v89, 0
    s_nop 0
    v_cndmask_b32 v105, v5, 0, vcc
    v_cndmask_b32 v121, 0, v5, vcc
    v_add_u32 v6, 2, v4
    v_cmp_le_u32 vcc, v6, v2
    v_mov_b32 v90, 0
    s_nop 0
    v_cndmask_b32 v106, v5, 0, vcc
    v_cndmask_b32 v122, 0, v5, vcc
    v_add_u32 v6, 3, v4
    v_cmp_le_u32 vcc, v6, v2
    v_mov_b32 v91, 0
    s_nop 0
    v_cndmask_b32 v107, v5, 0, vcc
    v_cndmask_b32 v123, 0, v5, vcc
    v_add_u32 v6, 8, v4
    v_cmp_le_u32 vcc, v6, v2
    v_mov_b32 v92, 0
    s_nop 0
    v_cndmask_b32 v108, v5, 0, vcc
    v_cndmask_b32 v124, 0, v5, vcc
    v_add_u32 v6, 9, v4
    v_cmp_le_u32 vcc, v6, v2
    v_mov_b32 v93, 0
    s_nop 0
    v_cndmask_b32 v109, v5, 0, vcc
    v_cndmask_b32 v125, 0, v5, vcc
    v_add_u32 v6, 10, v4
    v_cmp_le_u32 vcc, v6, v2
    v_mov_b32 v94, 0
    s_nop 0
    v_cndmask_b32 v110, v5, 0, vcc
    v_cndmask_b32 v126, 0, v5, vcc
    v_add_u32 v6, 11, v4
    v_cmp_le_u32 vcc, v6, v2
    v_mov_b32 v95, 0
    s_nop 0
    v_cndmask_b32 v111, v5, 0, vcc
    v_cndmask_b32 v127, 0, v5, vcc
    v_add_u32 v6, 16, v4
    v_cmp_le_u32 vcc, v6, v2
    v_mov_b32 v96, 0
    s_nop 0
    v_cndmask_b32 v112, v5, 0, vcc
    v_cndmask_b32 v128, 0, v5, vcc
    v_add_u32 v6, 17, v4
    v_cmp_le_u32 vcc, v6, v2
    v_mov_b32 v97, 0
    s_nop 0
    v_cndmask_b32 v113, v5, 0, vcc
    v_cndmask_b32 v129, 0, v5, vcc
    v_add_u32 v6, 18, v4
    v_cmp_le_u32 vcc, v6, v2
    v_mov_b32 v98, 0
    s_nop 0
    v_cndmask_b32 v114, v5, 0, vcc
    v_cndmask_b32 v130, 0, v5, vcc
    v_add_u32 v6, 19, v4
    v_cmp_le_u32 vcc, v6, v2
    v_mov_b32 v99, 0
    s_nop 0
    v_cndmask_b32 v115, v5, 0, vcc
    v_cndmask_b32 v131, 0, v5, vcc
    v_add_u32 v6, 24, v4
    v_cmp_le_u32 vcc, v6, v2
    v_mov_b32 v100, 0
    s_nop 0
    v_cndmask_b32 v116, v5, 0, vcc
    v_cndmask_b32 v132, 0, v5, vcc
    v_add_u32 v6, 25, v4
    v_cmp_le_u32 vcc, v6, v2
    v_mov_b32 v101, 0
    s_nop 0
    v_cndmask_b32 v117, v5, 0, vcc
    v_cndmask_b32 v133, 0, v5, vcc
    v_add_u32 v6, 26, v4
    v_cmp_le_u32 vcc, v6, v2
    v_mov_b32 v102, 0
    s_nop 0
    v_cndmask_b32 v118, v5, 0, vcc
    v_cndmask_b32 v134, 0, v5, vcc
    v_add_u32 v6, 27, v4
    v_cmp_le_u32 vcc, v6, v2
    v_mov_b32 v103, 0
    s_nop 0
    v_cndmask_b32 v119, v5, 0, vcc
    v_cndmask_b32 v135, 0, v5, vcc
    v_mov_b32 v24, 0x3f803f80
    v_mov_b32 v25, 0x3f803f80
    v_mov_b32 v26, 0x3f803f80
    v_mov_b32 v27, 0x3f803f80
    v_mov_b32 v28, 0x3f803f80
    v_mov_b32 v29, 0x3f803f80
    v_mov_b32 v30, 0x3f803f80
    v_mov_b32 v31, 0x3f803f80
    s_lshl_b32 s3, s42, 9
    v_lshl_add_u32 v7, v2, 4, s3
    s_mul_i32 s57, s43, 6144
    v_lshl_add_u32 v6, v3, 11, v7
    v_add_u32 v6, s57, v6
    v_lshlrev_b32 v139, 4, v1
    v_lshlrev_b32 v140, 3, v2
    v_lshrrev_b32 v4, 1, v1
    v_mul_u32_u24 v4, 3072, v4
    v_and_b32 v5, 1, v1
    v_lshl_add_u32 v247, v5, 4, v4
    v_lshrrev_b32 v4, 5, v1
    v_mul_u32_u24 v4, 196608, v4
    v_add_u32 v248, v247, v4
    v_mul_u32_u24 v5, 26, v1
    v_lshrrev_b32 v5, 8, v5
    v_mul_u32_u24 v4, 10, v5
    v_sub_u32 v4, v1, v4
    v_mul_u32_u24 v5, 1280, v5
    v_lshl_add_u32 v145, v4, 4, v5
    s_and_b32 s3, s35, 3
    s_mul_i32 s3, s3, 6
    s_and_b32 s3, s3, -4
    s_add_u32 s72, s3, s33
    s_mul_i32 s73, s39, 160
    s_mov_b32 s64, -1
    s_mov_b32 s65, 0x3ffff
    v_mul_u32_u24 v212, 26, v1
    v_lshrrev_b32 v212, 8, v212
    v_mul_u32_u24 v213, 10, v212
    v_sub_u32 v213, v1, v213
    v_mul_u32_u24 v212, 1280, v212
    v_lshl_add_u32 v212, v213, 4, v212
    v_mov_b32 v200, -1
    v_mov_b32 v201, -1
    v_mov_b32 v202, -1
    v_mov_b32 v203, -1
    v_mov_b32 v158, v6
    v_mov_b32 v159, v7
    s_bfe_u32 s42, s33, 65537
    s_and_b32 s43, s33, 1
    v_and_b32 v2, 15, v1
    v_lshrrev_b32 v3, 4, v1
    v_lshrrev_b32 v4, 5, v1
    v_and_b32 v5, 1, v3
    v_bfe_u32 v6, v1, 2, 2
    v_and_b32 v7, 3, v1
    v_lshlrev_b32 v7, 3, v7
    s_mul_i32 s56, s43, 51200
    s_add_u32 s56, s56, 0
    v_add_u32 v7, s56, v7
    v_mul_u32_u24 v168, 20, v4
    v_lshl_add_u32 v168, v5, 2, v168
    v_add_u32 v168, v168, v6
    v_mul_u32_u24 v168, 160, v168
    v_add_u32 v168, v168, v7
    v_lshl_add_u32 v169, v4, 2, v5
    v_mul_u32_u24 v169, 20, v169
    v_add3_u32 v169, v169, 16, v6
    v_mul_u32_u24 v169, 160, v169
    v_add_u32 v169, v169, v7
    v_mul_u32_u24 v170, 1280, v4
    v_lshl_add_u32 v170, v5, 9, v170
    v_lshl_add_u32 v170, v2, 4, v170
    s_lshl_b32 s56, s43, 8
    s_xor_b32 s57, s56, 256
    v_add_u32 v171, s57, v170
    v_add_u32 v170, s56, v170
    v_mul_u32_u24 v172, 20480, v4
    v_mul_u32_u24 v6, 1280, v5
    v_add_u32 v172, v172, v6
    v_lshl_add_u32 v172, v2, 3, v172
    s_lshl_b32 s56, s43, 7
    s_xor_b32 s57, s56, 128
    v_add_u32 v173, s57, v172
    v_add_u32 v172, s56, v172
    s_lshl_b32 s56, s38, 1
    s_add_u32 s56, s56, s42
    s_lshl_b32 s56, s56, 5
    s_lshl_b32 s57, s43, 4
    s_add_u32 s56, s56, s57
    s_lshr_b32 s68, s38, 1
    s_mul_i32 s68, s68, 163840
    s_mul_i32 s57, s43, 81920
    s_add_u32 s68, s68, s57
    s_lshr_b32 s57, s56, 5
    s_and_b32 s57, s57, 3
    s_mul_i32 s57, s57, 2560
    s_add_u32 s68, s68, s57
    s_lshl_b32 s69, s56, 7
    s_add_u32 s69, s69, 262144
    v_lshlrev_b32 v245, 7, v2
    v_mov_b32 v251, s32
    v_mov_b32 v252, 0
    s_mul_i32 s56, s33, 7680
    s_add_u32 s56, s56, 102400
    v_lshl_add_u32 v174, v1, 4, s56
    s_xor_b32 s56, s33, 1
    s_mul_i32 s56, s56, 7680
    s_add_u32 s56, s56, 102400
    v_lshl_add_u32 v175, v1, 4, s56
    v_mul_u32_u24 v6, 1280, v2
    v_lshl_add_u32 v241, v3, 3, v6
    v_lshl_add_u32 v240, v5, 5, v6
    v_lshl_add_u32 v240, v4, 4, v240
    v_lshlrev_b32 v242, 4, v1
    v_mov_b32 v244, 0x3f803f80
    s_and_b32 s56, s33, 3
    s_lshl_b32 s56, s56, 2
    s_add_u32 s56, s56, 163824
    v_mov_b32 v249, s56
    v_mov_b32 v6, v158
    v_mov_b32 v7, v159
    s_cmp_ge_u32 s33, 4
    s_cbranch_scc1 L_P1_NF
    s_cmp_eq_u32 s37, 15
    s_cbranch_scc1 L_P1_NF
    s_lshl_b32 s56, s60, 4
    s_add_u32 s56, s56, s62
    s_lshl_b32 s56, s56, 2
    s_add_u32 s56, s56, s33
    s_lshl_b32 s56, s56, 7
    s_add_u32 s56, s56, 131072
    v_mov_b32 v2, s32
    v_mov_b32 v3, 0
    s_mov_b64 exec, 1
    s_waitcnt vmcnt(0)
    buffer_store_dword v2, v3, s[16:19], s56 offen sc1
    s_mov_b64 exec, -1
    s_lshl_b32 s3, s38, 2
    s_add_u32 s3, s3, s33
    s_mul_i32 s3, s3, 20480
    s_mul_i32 s67, s39, 160
    s_add_u32 s66, s3, s67
    v_lshrrev_b32 v193, 4, v1
    v_lshrrev_b32 v194, 5, v1
    v_and_b32 v195, 1, v193
    v_lshlrev_b32 v195, 5, v195
    v_lshl_add_u32 v191, v194, 4, v195
    v_lshlrev_b32 v193, 3, v193
    v_and_b32 v192, 15, v1
    v_mul_u32_u24 v192, 1280, v192
    v_add_u32 v190, v192, v191
    v_add_u32 v192, v192, v193
    v_lshlrev_b32 v194, 4, v1
    v_lshlrev_b32 v195, 2, v1
    buffer_load_dwordx4 v[214:217], v190, s[4:7], s66 offen offset:0
    buffer_load_dwordx4 v[224:227], v191, s[28:31], s67 offen offset:0
    buffer_load_dwordx4 v[218:221], v190, s[4:7], s66 offen offset:64
    buffer_load_dwordx4 v[228:231], v191, s[28:31], s67 offen offset:64
    buffer_load_dwordx2 v[222:223], v192, s[4:7], s66 offen offset:128
    buffer_load_dwordx2 v[232:233], v193, s[28:31], s67 offen offset:128
    buffer_load_dwordx4 v[234:237], v194, s[28:31], 0 offen
    buffer_load_dword v238, v195, s[28:31], 0 offen offset:1024
L_P1_NF:
    s_mov_b32 s63, 0
    s_mov_b32 s59, 131072
    v_mov_b32 v160, 0
    s_cmp_eq_u32 s37, 15
    s_cselect_b32 s3, 4, 0
    s_cmp_lg_u32 s33, s3
    s_cbranch_scc1 L_P2_J
    v_mov_b32 v210, v6
    v_mov_b32 v211, v7
    v_bfe_u32 v2, v1, 2, 3
    v_cmp_eq_u32 vcc, 7, v2
    s_nop 1
    v_cndmask_b32 v2, v2, 0, vcc
    v_add_u32 v3, 2, v2
    v_mul_u32_u24 v3, 86, v3
    v_lshrrev_b32 v3, 8, v3
    v_mul_u32_u24 v4, 3, v3
    v_sub_u32 v4, v2, v4
    v_add_u32 v4, s36, v4
    v_max_i32 v4, 0, v4
    s_mul_i32 s3, s37, 40
    v_bfe_u32 v5, v1, 1, 1
    v_mul_u32_u24 v5, 39, v5
    v_add_u32 v5, s3, v5
    v_lshrrev_b32 v5, 6, v5
    v_mul_u32_u24 v3, 5, v3
    v_lshrrev_b32 v6, 1, v5
    v_add_u32 v3, v3, v6
    v_lshl_add_u32 v3, v4, 4, v3
    v_and_b32 v5, 1, v5
    v_and_b32 v6, 1, v1
    v_lshl_add_u32 v5, v6, 1, v5
    v_lshl_add_u32 v3, v3, 2, v5
    v_lshlrev_b32 v3, 7, v3
    s_waitcnt vmcnt(0)
    s_mov_b32 s58, 50000
    s_mov_b32 s59, 131072
    s_cmp_eq_u32 s37, 15
    s_cbranch_scc1 L_H1_SP0
L_H1_POLL:
    buffer_load_dword v161, v3, s[16:19], s59 offen sc1
    s_waitcnt vmcnt(0)
    v_cmp_ne_u32 vcc, s32, v161
    s_mov_b32 s63, vcc_lo
    s_and_b32 vcc_lo, vcc_lo, 0xf0f00f0f
    s_cbranch_scc0 L_H1_OK
    s_sub_u32 s58, s58, 1
    s_cmp_lg_u32 s58, 0
    s_cbranch_scc1 L_H1_POLL
L_H1_OK:
    v_mov_b32 v160, v3
    v_mov_b32 v6, v210
    v_mov_b32 v7, v211
L_P2_J:
    s_barrier
    v_lshlrev_b32 v2, 4, v1
    s_mul_i32 s56, s36, 163840
    s_mul_i32 s57, s37, 10240
    s_add_u32 s56, s56, s57
    s_add_u32 s56, s56, 0
    s_add_u32 s57, s56, 4096
    buffer_load_dwordx4 v[8:11], v6, s[20:23], s56 offen sc1
    buffer_load_dwordx4 v[12:15], v7, s[20:23], s57 offen sc1
    s_add_u32 m0, s50, 2048
    s_nop 0
    buffer_load_dwordx4 v2, s[16:19], s45 offen  lds
    s_add_u32 m0, s51, 10240
    s_nop 0
    buffer_load_dwordx4 v141, s[16:19], s48 offen  lds
    s_cmp_lt_u32 s33, 4
    s_cbranch_scc1 L_P2_NX
    s_mov_b32 m0, s53
    s_nop 0
    buffer_load_dwordx4 v143, s[16:19], s52 offen  lds
L_P2_NX:
    s_cmp_eq_u32 s63, 0
    s_cbranch_scc1 L_H1B_OK
    s_mov_b32 s58, 50000
L_H1B_POLL:
    buffer_load_dword v161, v160, s[16:19], s59 offen sc1
    s_waitcnt vmcnt(0)
    v_cmp_ne_u32 vcc, s32, v161
    s_cbranch_vccz L_H1B_OK
    s_sub_u32 s58, s58, 1
    s_cmp_lg_u32 s58, 0
    s_cbranch_scc1 L_H1B_POLL
L_H1B_OK:
    s_barrier
    s_mov_b32 m0, s50
    s_nop 0
    buffer_load_dwordx4 v2, s[16:19], s44 offen  lds
    s_add_u32 m0, s50, 4096
    s_nop 0
    buffer_load_dwordx4 v2, s[16:19], s46 offen  lds
    s_mov_b32 m0, s51
    s_nop 0
    buffer_load_dwordx4 v141, s[16:19], s47 offen  lds
    s_add_u32 m0, s51, 20480
    s_nop 0
    buffer_load_dwordx4 v141, s[16:19], s49 offen  lds
    s_mov_b32 m0, s55
    s_nop 0
    buffer_load_dwordx4 v144, s[16:19], s54 offen  lds
    s_cmp_ge_u32 s36, 2
    s_cbranch_scc1 L_P2_W5
    s_waitcnt vmcnt(0)
L_P2_W5:
    s_waitcnt vmcnt(5)
    s_lshr_b32 s44, s33, 2
    s_xor_b32 s44, s44, s37
    s_and_b32 s44, s44, 1
    s_cselect_b32 s44, 0, -1
    s_cselect_b32 s46, -1, 0
    s_mov_b32 s45, 0
    s_mov_b32 s47, 0
    v_cndmask_b32 v12, 0, v12, s[44:45]
    v_cndmask_b32 v13, 0, v13, s[44:45]
    v_cndmask_b32 v14, 0, v14, s[46:47]
    v_cndmask_b32 v15, 0, v15, s[46:47]
    s_barrier
    s_and_b32 s42, s33, 3
    s_lshl_b32 s50, s36, 2
    s_add_u32 s50, s50, s42
    s_mov_b32 s48, 0xfffff
    s_mov_b32 s49, 0xfffff
    s_mov_b32 s51, 0
    s_cmp_lt_u32 s50, 8
    s_cbranch_scc1 L_AT_OLD
    s_cmp_ge_u32 s33, 4
    s_cbranch_scc1 L_A3_L
    ds_read_b128 v[16:19], v146 offset:2048
    ds_read_b128 v[20:23], v147 offset:2048
    s_mov_b64 exec, s[48:49]
    ds_read_b128 v[24:27], v148 offset:10240
    ds_read_b128 v[28:31], v148 offset:11520
    s_mov_b64 exec, -1
    s_waitcnt lgkmcnt(2)
    v_mfma_f32_32x32x16_bf16 v[40:55], v[16:19], v[8:11], 0
    v_mfma_f32_32x32x16_bf16 v[40:55], v[20:23], v[12:15], v[40:55]
    ds_read_b128 v[16:19], v146 offset:2560
    ds_read_b128 v[20:23], v147 offset:2560
    s_setprio 1
    s_nop 8
    v_exp_f32 v40, v40
    v_exp_f32 v41, v41
    v_exp_f32 v42, v42
    v_cvt_pk_bf16_f32 v32, v40, v41
    v_exp_f32 v43, v43
    s_waitcnt lgkmcnt(0)
    v_mfma_f32_32x32x16_bf16 v[56:71], v[16:19], v[8:11], 0
    v_exp_f32 v44, v44
    v_cvt_pk_bf16_f32 v33, v42, v43
    v_exp_f32 v45, v45
    v_exp_f32 v46, v46
    v_cvt_pk_bf16_f32 v34, v44, v45
    v_mfma_f32_32x32x16_bf16 v[56:71], v[20:23], v[12:15], v[56:71]
    ds_read_b128 v[16:19], v146 offset:3072
    ds_read_b128 v[20:23], v147 offset:3072
    v_exp_f32 v47, v47
    v_exp_f32 v48, v48
    v_cvt_pk_bf16_f32 v35, v46, v47
    v_exp_f32 v49, v49
    v_exp_f32 v50, v50
    s_setprio 0
    v_mfma_f32_32x32x16_bf16 v[72:87], v[24:27], v[32:35], 0
    v_cvt_pk_bf16_f32 v36, v48, v49
    v_exp_f32 v51, v51
    v_exp_f32 v52, v52
    v_cvt_pk_bf16_f32 v37, v50, v51
    v_exp_f32 v53, v53
    v_exp_f32 v54, v54
    v_exp_f32 v55, v55
    v_cvt_pk_bf16_f32 v38, v52, v53
    v_cvt_pk_bf16_f32 v39, v54, v55
    s_nop 1
    v_mfma_f32_32x32x16_bf16 v[72:87], v[28:31], v[36:39], v[72:87]
    s_mov_b64 exec, s[48:49]
    ds_read_b128 v[24:27], v148 offset:12800
    ds_read_b128 v[28:31], v148 offset:14080
    s_mov_b64 exec, -1
    s_setprio 1
    v_exp_f32 v56, v56
    v_exp_f32 v57, v57
    v_exp_f32 v58, v58
    v_cvt_pk_bf16_f32 v32, v56, v57
    v_exp_f32 v59, v59
    s_waitcnt lgkmcnt(2)
    v_mfma_f32_32x32x16_bf16 v[40:55], v[16:19], v[8:11], 0
    v_exp_f32 v60, v60
    v_cvt_pk_bf16_f32 v33, v58, v59
    v_exp_f32 v61, v61
    v_exp_f32 v62, v62
    v_cvt_pk_bf16_f32 v34, v60, v61
    v_mfma_f32_32x32x16_bf16 v[40:55], v[20:23], v[12:15], v[40:55]
    ds_read_b128 v[16:19], v146 offset:3584
    ds_read_b128 v[20:23], v147 offset:3584
    v_exp_f32 v63, v63
    v_exp_f32 v64, v64
    v_cvt_pk_bf16_f32 v35, v62, v63
    v_exp_f32 v65, v65
    v_exp_f32 v66, v66
    s_setprio 0
    s_waitcnt lgkmcnt(2)
    v_mfma_f32_32x32x16_bf16 v[72:87], v[24:27], v[32:35], v[72:87]
    v_cvt_pk_bf16_f32 v36, v64, v65
    v_exp_f32 v67, v67
    v_exp_f32 v68, v68
    v_cvt_pk_bf16_f32 v37, v66, v67
    v_exp_f32 v69, v69
    v_exp_f32 v70, v70
    v_exp_f32 v71, v71
    v_cvt_pk_bf16_f32 v38, v68, v69
    v_cvt_pk_bf16_f32 v39, v70, v71
    s_nop 1
    v_mfma_f32_32x32x16_bf16 v[72:87], v[28:31], v[36:39], v[72:87]
    s_mov_b64 exec, s[48:49]
    ds_read_b128 v[24:27], v148 offset:15360
    ds_read_b128 v[28:31], v148 offset:16640
    s_mov_b64 exec, -1
    s_setprio 1
    v_exp_f32 v40, v40
    v_exp_f32 v41, v41
    v_exp_f32 v42, v42
    v_cvt_pk_bf16_f32 v32, v40, v41
    v_exp_f32 v43, v43
    s_waitcnt lgkmcnt(2)
    v_mfma_f32_32x32x16_bf16 v[56:71], v[16:19], v[8:11], 0
    s_cmp_ge_u32 s72, 17
    s_cselect_b32 s3, 8, 4
    s_add_u32 s3, s3, s72
    s_mul_i32 s62, s3, 3200
    s_lshl_b32 s60, s62, 3
    s_add_u32 s60, s60, s73
    s_add_u32 s72, s72, 4
    s_cmp_ge_u32 s72, 24
    s_cselect_b32 s3, 24, 0
    s_sub_u32 s72, s72, s3
    s_add_u32 m0, s62, 0
    s_add_u32 s3, s60, 0
    s_mov_b64 exec, s[64:65]
    buffer_load_dwordx4 v145, s[12:15], s3 offen lds
    s_mov_b64 exec, -1
    v_exp_f32 v44, v44
    v_cvt_pk_bf16_f32 v33, v42, v43
    v_exp_f32 v45, v45
    v_exp_f32 v46, v46
    v_cvt_pk_bf16_f32 v34, v44, v45
    v_mfma_f32_32x32x16_bf16 v[56:71], v[20:23], v[12:15], v[56:71]
    s_add_u32 m0, s62, 800
    s_add_u32 s3, s60, 6400
    s_mov_b64 exec, s[64:65]
    buffer_load_dwordx4 v145, s[12:15], s3 offen lds
    s_mov_b64 exec, -1
    v_exp_f32 v47, v47
    v_exp_f32 v48, v48
    v_cvt_pk_bf16_f32 v35, v46, v47
    v_exp_f32 v49, v49
    v_exp_f32 v50, v50
    s_setprio 0
    s_waitcnt lgkmcnt(0)
    v_mfma_f32_32x32x16_bf16 v[72:87], v[24:27], v[32:35], v[72:87]
    s_add_u32 m0, s62, 1600
    s_add_u32 s3, s60, 12800
    s_mov_b64 exec, s[64:65]
    buffer_load_dwordx4 v145, s[12:15], s3 offen lds
    s_mov_b64 exec, -1
    v_cvt_pk_bf16_f32 v36, v48, v49
    v_exp_f32 v51, v51
    v_exp_f32 v52, v52
    v_cvt_pk_bf16_f32 v37, v50, v51
    v_exp_f32 v53, v53
    v_exp_f32 v54, v54
    v_exp_f32 v55, v55
    v_cvt_pk_bf16_f32 v38, v52, v53
    v_cvt_pk_bf16_f32 v39, v54, v55
    s_nop 1
    v_mfma_f32_32x32x16_bf16 v[72:87], v[28:31], v[36:39], v[72:87]
    s_mov_b64 exec, s[48:49]
    ds_read_b128 v[24:27], v148 offset:17920
    ds_read_b128 v[28:31], v148 offset:19200
    s_mov_b64 exec, -1
    s_add_u32 m0, s62, 2400
    s_add_u32 s3, s60, 19200
    s_mov_b64 exec, s[64:65]
    buffer_load_dwordx4 v145, s[12:15], s3 offen lds
    s_mov_b64 exec, -1
    s_setprio 1
    v_exp_f32 v56, v56
    v_exp_f32 v57, v57
    v_exp_f32 v58, v58
    v_cvt_pk_bf16_f32 v32, v56, v57
    v_exp_f32 v59, v59
    s_cmp_ge_u32 s72, 17
    s_cselect_b32 s3, 8, 4
    s_add_u32 s3, s3, s72
    s_mul_i32 s62, s3, 3200
    s_lshl_b32 s60, s62, 3
    s_add_u32 s60, s60, s73
    s_add_u32 s72, s72, 4
    s_cmp_ge_u32 s72, 24
    s_cselect_b32 s3, 24, 0
    s_sub_u32 s72, s72, s3
    s_add_u32 m0, s62, 0
    s_add_u32 s3, s60, 0
    s_mov_b64 exec, s[64:65]
    buffer_load_dwordx4 v145, s[12:15], s3 offen lds
    s_mov_b64 exec, -1
    v_exp_f32 v60, v60
    v_cvt_pk_bf16_f32 v33, v58, v59
    v_exp_f32 v61, v61
    v_exp_f32 v62, v62
    v_cvt_pk_bf16_f32 v34, v60, v61
    s_add_u32 m0, s62, 800
    s_add_u32 s3, s60, 6400
    s_mov_b64 exec, s[64:65]
    buffer_load_dwordx4 v145, s[12:15], s3 offen lds
    s_mov_b64 exec, -1
    v_exp_f32 v63, v63
    v_exp_f32 v64, v64
    v_cvt_pk_bf16_f32 v35, v62, v63
    s_waitcnt vmcnt(6)
    s_barrier
    ds_read_b128 v[16:19], v136 offset:0
    ds_read_b128 v[20:23], v137 offset:0
    v_exp_f32 v65, v65
    v_exp_f32 v66, v66
    s_setprio 0
    s_waitcnt lgkmcnt(2)
    v_mfma_f32_32x32x16_bf16 v[72:87], v[24:27], v[32:35], v[72:87]
    s_add_u32 m0, s62, 1600
    s_add_u32 s3, s60, 12800
    s_mov_b64 exec, s[64:65]
    buffer_load_dwordx4 v145, s[12:15], s3 offen lds
    s_mov_b64 exec, -1
    v_cvt_pk_bf16_f32 v36, v64, v65
    v_exp_f32 v67, v67
    v_exp_f32 v68, v68
    v_cvt_pk_bf16_f32 v37, v66, v67
    v_exp_f32 v69, v69
    s_waitcnt lgkmcnt(0)
    v_mfma_f32_32x32x16_bf16 v[40:55], v[16:19], v[8:11], v[120:135]
    v_exp_f32 v70, v70
    v_exp_f32 v71, v71
    v_cvt_pk_bf16_f32 v38, v68, v69
    v_cvt_pk_bf16_f32 v39, v70, v71
    s_nop 1
    v_mfma_f32_32x32x16_bf16 v[72:87], v[28:31], v[36:39], v[72:87]
    s_mov_b64 exec, s[48:49]
    ds_read_b128 v[24:27], v138 offset:0
    ds_read_b128 v[28:31], v138 offset:1280
    s_mov_b64 exec, -1
    v_mfma_f32_32x32x16_bf16 v[40:55], v[20:23], v[12:15], v[40:55]
    ds_read_b128 v[16:19], v149 offset:512
    ds_read_b128 v[20:23], v150 offset:512
    s_add_u32 m0, s62, 2400
    s_add_u32 s3, s60, 19200
    s_mov_b64 exec, s[64:65]
    buffer_load_dwordx4 v145, s[12:15], s3 offen lds
    s_mov_b64 exec, -1
    s_setprio 1
    s_nop 3
    v_exp_f32 v40, v40
    v_exp_f32 v41, v41
    v_exp_f32 v42, v42
    v_cvt_pk_bf16_f32 v32, v40, v41
    v_exp_f32 v43, v43
    s_waitcnt lgkmcnt(0)
    v_mfma_f32_32x32x16_bf16 v[56:71], v[16:19], v[8:11], 0
    s_cmp_ge_u32 s72, 17
    s_cselect_b32 s3, 8, 4
    s_add_u32 s3, s3, s72
    s_mul_i32 s62, s3, 3200
    s_lshl_b32 s60, s62, 3
    s_add_u32 s60, s60, s73
    s_add_u32 s72, s72, 4
    s_cmp_ge_u32 s72, 24
    s_cselect_b32 s3, 24, 0
    s_sub_u32 s72, s72, s3
    s_add_u32 m0, s62, 0
    s_add_u32 s3, s60, 0
    s_mov_b64 exec, s[64:65]
    buffer_load_dwordx4 v145, s[12:15], s3 offen lds
    s_mov_b64 exec, -1
    v_exp_f32 v44, v44
    v_cvt_pk_bf16_f32 v33, v42, v43
    v_exp_f32 v45, v45
    v_exp_f32 v46, v46
    v_cvt_pk_bf16_f32 v34, v44, v45
    v_mfma_f32_32x32x16_bf16 v[56:71], v[20:23], v[12:15], v[56:71]
    ds_read_b128 v[16:19], v152 offset:1024
    ds_read_b128 v[20:23], v153 offset:1024
    s_add_u32 m0, s62, 800
    s_add_u32 s3, s60, 6400
    s_mov_b64 exec, s[64:65]
    buffer_load_dwordx4 v145, s[12:15], s3 offen lds
    s_mov_b64 exec, -1
    v_exp_f32 v47, v47
    v_exp_f32 v48, v48
    v_cvt_pk_bf16_f32 v35, v46, v47
    v_exp_f32 v49, v49
    v_exp_f32 v50, v50
    s_setprio 0
    v_mfma_f32_32x32x16_bf16 v[72:87], v[24:27], v[32:35], v[72:87]
    s_add_u32 m0, s62, 1600
    s_add_u32 s3, s60, 12800
    s_mov_b64 exec, s[64:65]
    buffer_load_dwordx4 v145, s[12:15], s3 offen lds
    s_mov_b64 exec, -1
    v_cvt_pk_bf16_f32 v36, v48, v49
    v_exp_f32 v51, v51
    v_exp_f32 v52, v52
    v_cvt_pk_bf16_f32 v37, v50, v51
    v_exp_f32 v53, v53
    v_exp_f32 v54, v54
    v_exp_f32 v55, v55
    v_cvt_pk_bf16_f32 v38, v52, v53
    v_cvt_pk_bf16_f32 v39, v54, v55
    s_nop 1
    v_mfma_f32_32x32x16_bf16 v[72:87], v[28:31], v[36:39], v[72:87]
    s_mov_b64 exec, s[48:49]
    ds_read_b128 v[24:27], v151 offset:2560
    ds_read_b128 v[28:31], v151 offset:3840
    s_mov_b64 exec, -1
    s_add_u32 m0, s62, 2400
    s_add_u32 s3, s60, 19200
    s_mov_b64 exec, s[64:65]
    buffer_load_dwordx4 v145, s[12:15], s3 offen lds
    s_mov_b64 exec, -1
    s_setprio 1
    v_exp_f32 v56, v56
    v_exp_f32 v57, v57
    v_exp_f32 v58, v58
    v_cvt_pk_bf16_f32 v32, v56, v57
    v_exp_f32 v59, v59
    s_waitcnt lgkmcnt(2)
    v_mfma_f32_32x32x16_bf16 v[40:55], v[16:19], v[8:11], 0
    s_cmp_ge_u32 s72, 17
    s_cselect_b32 s3, 8, 4
    s_add_u32 s3, s3, s72
    s_mul_i32 s62, s3, 3200
    s_lshl_b32 s60, s62, 3
    s_add_u32 s60, s60, s73
    s_add_u32 s72, s72, 4
    s_cmp_ge_u32 s72, 24
    s_cselect_b32 s3, 24, 0
    s_sub_u32 s72, s72, s3
    s_add_u32 m0, s62, 0
    s_add_u32 s3, s60, 0
    s_mov_b64 exec, s[64:65]
    buffer_load_dwordx4 v145, s[12:15], s3 offen lds
    s_mov_b64 exec, -1
    v_exp_f32 v60, v60
    v_cvt_pk_bf16_f32 v33, v58, v59
    v_exp_f32 v61, v61
    v_exp_f32 v62, v62
    v_cvt_pk_bf16_f32 v34, v60, v61
    v_mfma_f32_32x32x16_bf16 v[40:55], v[20:23], v[12:15], v[40:55]
    ds_read_b128 v[16:19], v155 offset:1536
    ds_read_b128 v[20:23], v156 offset:1536
    s_add_u32 m0, s62, 800
    s_add_u32 s3, s60, 6400
    s_mov_b64 exec, s[64:65]
    buffer_load_dwordx4 v145, s[12:15], s3 offen lds
    s_mov_b64 exec, -1
    v_exp_f32 v63, v63
    v_exp_f32 v64, v64
    v_cvt_pk_bf16_f32 v35, v62, v63
    v_exp_f32 v65, v65
    v_exp_f32 v66, v66
    s_setprio 0
    s_waitcnt lgkmcnt(2)
    v_mfma_f32_32x32x16_bf16 v[72:87], v[24:27], v[32:35], v[72:87]
    s_add_u32 m0, s62, 1600
    s_add_u32 s3, s60, 12800
    s_mov_b64 exec, s[64:65]
    buffer_load_dwordx4 v145, s[12:15], s3 offen lds
    s_mov_b64 exec, -1
    v_cvt_pk_bf16_f32 v36, v64, v65
    v_exp_f32 v67, v67
    v_exp_f32 v68, v68
    v_cvt_pk_bf16_f32 v37, v66, v67
    v_exp_f32 v69, v69
    v_exp_f32 v70, v70
    v_exp_f32 v71, v71
    v_cvt_pk_bf16_f32 v38, v68, v69
    v_cvt_pk_bf16_f32 v39, v70, v71
    s_nop 1
    v_mfma_f32_32x32x16_bf16 v[72:87], v[28:31], v[36:39], v[72:87]
    s_mov_b64 exec, s[48:49]
    ds_read_b128 v[24:27], v154 offset:5120
    ds_read_b128 v[28:31], v154 offset:6400
    s_mov_b64 exec, -1
    s_add_u32 m0, s62, 2400
    s_add_u32 s3, s60, 19200
    s_mov_b64 exec, s[64:65]
    buffer_load_dwordx4 v145, s[12:15], s3 offen lds
    s_mov_b64 exec, -1
    s_setprio 1
    v_exp_f32 v40, v40
    v_exp_f32 v41, v41
    v_exp_f32 v42, v42
    v_cvt_pk_bf16_f32 v32, v40, v41
    v_exp_f32 v43, v43
    s_waitcnt lgkmcnt(2)
    v_mfma_f32_32x32x16_bf16 v[56:71], v[16:19], v[8:11], 0
    s_cmp_ge_u32 s72, 17
    s_cselect_b32 s3, 8, 4
    s_add_u32 s3, s3, s72
    s_mul_i32 s62, s3, 3200
    s_lshl_b32 s60, s62, 3
    s_add_u32 s60, s60, s73
    s_add_u32 s72, s72, 4
    s_cmp_ge_u32 s72, 24
    s_cselect_b32 s3, 24, 0
    s_sub_u32 s72, s72, s3
    s_add_u32 m0, s62, 0
    s_add_u32 s3, s60, 0
    s_mov_b64 exec, s[64:65]
    buffer_load_dwordx4 v145, s[12:15], s3 offen lds
    s_mov_b64 exec, -1
    v_exp_f32 v44, v44
    v_cvt_pk_bf16_f32 v33, v42, v43
    v_exp_f32 v45, v45
    v_exp_f32 v46, v46
    v_cvt_pk_bf16_f32 v34, v44, v45
    v_mfma_f32_32x32x16_bf16 v[56:71], v[20:23], v[12:15], v[56:71]
    ds_read_b128 v[16:19], v136 offset:4096
    ds_read_b128 v[20:23], v137 offset:4096
    s_add_u32 m0, s62, 800
    s_add_u32 s3, s60, 6400
    s_mov_b64 exec, s[64:65]
    buffer_load_dwordx4 v145, s[12:15], s3 offen lds
    s_mov_b64 exec, -1
    v_exp_f32 v47, v47
    v_exp_f32 v48, v48
    v_cvt_pk_bf16_f32 v35, v46, v47
    v_exp_f32 v49, v49
    v_exp_f32 v50, v50
    s_setprio 0
    s_waitcnt lgkmcnt(2)
    v_mfma_f32_32x32x16_bf16 v[72:87], v[24:27], v[32:35], v[72:87]
    s_add_u32 m0, s62, 1600
    s_add_u32 s3, s60, 12800
    s_mov_b64 exec, s[64:65]
    buffer_load_dwordx4 v145, s[12:15], s3 offen lds
    s_mov_b64 exec, -1
    v_cvt_pk_bf16_f32 v36, v48, v49
    v_exp_f32 v51, v51
    v_exp_f32 v52, v52
    v_cvt_pk_bf16_f32 v37, v50, v51
    v_exp_f32 v53, v53
    v_exp_f32 v54, v54
    v_exp_f32 v55, v55
    v_cvt_pk_bf16_f32 v38, v52, v53
    v_cvt_pk_bf16_f32 v39, v54, v55
    s_nop 1
    v_mfma_f32_32x32x16_bf16 v[72:87], v[28:31], v[36:39], v[72:87]
    s_mov_b64 exec, s[48:49]
    ds_read_b128 v[24:27], v157 offset:7680
    ds_read_b128 v[28:31], v157 offset:8960
    s_mov_b64 exec, -1
    s_add_u32 m0, s62, 2400
    s_add_u32 s3, s60, 19200
    s_mov_b64 exec, s[64:65]
    buffer_load_dwordx4 v145, s[12:15], s3 offen lds
    s_mov_b64 exec, -1
    s_setprio 1
    v_exp_f32 v56, v56
    v_exp_f32 v57, v57
    v_exp_f32 v58, v58
    v_cvt_pk_bf16_f32 v32, v56, v57
    v_exp_f32 v59, v59
    s_waitcnt lgkmcnt(2)
    v_mfma_f32_32x32x16_bf16 v[40:55], v[16:19], v[8:11], v[104:119]
    s_cmp_ge_u32 s72, 17
    s_cselect_b32 s3, 8, 4
    s_add_u32 s3, s3, s72
    s_mul_i32 s62, s3, 3200
    s_lshl_b32 s60, s62, 3
    s_add_u32 s60, s60, s73
    s_add_u32 s72, s72, 4
    s_cmp_ge_u32 s72, 24
    s_cselect_b32 s3, 24, 0
    s_sub_u32 s72, s72, s3
    s_add_u32 m0, s62, 0
    s_add_u32 s3, s60, 0
    s_mov_b64 exec, s[64:65]
    buffer_load_dwordx4 v145, s[12:15], s3 offen lds
    s_mov_b64 exec, -1
    v_exp_f32 v60, v60
    v_cvt_pk_bf16_f32 v33, v58, v59
    v_exp_f32 v61, v61
    v_exp_f32 v62, v62
    v_cvt_pk_bf16_f32 v34, v60, v61
    v_mfma_f32_32x32x16_bf16 v[40:55], v[20:23], v[12:15], v[40:55]
    s_add_u32 m0, s62, 800
    s_add_u32 s3, s60, 6400
    s_mov_b64 exec, s[64:65]
    buffer_load_dwordx4 v145, s[12:15], s3 offen lds
    s_mov_b64 exec, -1
    v_exp_f32 v63, v63
    v_exp_f32 v64, v64
    v_cvt_pk_bf16_f32 v35, v62, v63
    v_exp_f32 v65, v65
    v_exp_f32 v66, v66
    s_setprio 0
    s_waitcnt lgkmcnt(0)
    v_mfma_f32_32x32x16_bf16 v[72:87], v[24:27], v[32:35], v[72:87]
    s_add_u32 m0, s62, 1600
    s_add_u32 s3, s60, 12800
    s_mov_b64 exec, s[64:65]
    buffer_load_dwordx4 v145, s[12:15], s3 offen lds
    s_mov_b64 exec, -1
    v_cvt_pk_bf16_f32 v36, v64, v65
    v_exp_f32 v67, v67
    v_exp_f32 v68, v68
    v_cvt_pk_bf16_f32 v37, v66, v67
    v_exp_f32 v69, v69
    v_exp_f32 v70, v70
    v_exp_f32 v71, v71
    v_cvt_pk_bf16_f32 v38, v68, v69
    v_cvt_pk_bf16_f32 v39, v70, v71
    s_nop 1
    v_mfma_f32_32x32x16_bf16 v[72:87], v[28:31], v[36:39], v[72:87]
    s_mov_b64 exec, s[48:49]
    ds_read_b128 v[24:27], v138 offset:20480
    ds_read_b128 v[28:31], v138 offset:21760
    s_mov_b64 exec, -1
    s_add_u32 m0, s62, 2400
    s_add_u32 s3, s60, 19200
    s_mov_b64 exec, s[64:65]
    buffer_load_dwordx4 v145, s[12:15], s3 offen lds
    s_mov_b64 exec, -1
    s_setprio 1
    v_exp_f32 v40, v40
    v_exp_f32 v41, v41
    v_exp_f32 v42, v42
    v_cvt_pk_bf16_f32 v32, v40, v41
    v_exp_f32 v43, v43
    v_exp_f32 v44, v44
    v_cvt_pk_bf16_f32 v33, v42, v43
    v_exp_f32 v45, v45
    v_exp_f32 v46, v46
    v_cvt_pk_bf16_f32 v34, v44, v45
    v_exp_f32 v47, v47
    v_exp_f32 v48, v48
    v_cvt_pk_bf16_f32 v35, v46, v47
    v_exp_f32 v49, v49
    v_exp_f32 v50, v50
    s_setprio 0
    s_waitcnt lgkmcnt(0)
    v_mfma_f32_32x32x16_bf16 v[72:87], v[24:27], v[32:35], v[72:87]
    v_cvt_pk_bf16_f32 v36, v48, v49
    v_exp_f32 v51, v51
    v_exp_f32 v52, v52
    v_cvt_pk_bf16_f32 v37, v50, v51
    v_exp_f32 v53, v53
    v_exp_f32 v54, v54
    v_exp_f32 v55, v55
    v_cvt_pk_bf16_f32 v38, v52, v53
    v_cvt_pk_bf16_f32 v39, v54, v55
    s_nop 1
    v_mfma_f32_32x32x16_bf16 v[72:87], v[28:31], v[36:39], v[72:87]
    s_branch L_AT_DONE
L_A3_L:
    ds_read_b128 v[16:19], v146 offset:2048
    ds_read_b128 v[20:23], v147 offset:2048
    s_mov_b64 exec, s[48:49]
    ds_read_b128 v[24:27], v148 offset:10240
    ds_read_b128 v[28:31], v148 offset:11520
    s_mov_b64 exec, -1
    s_cmp_lt_u32 s33, 7
    s_cbranch_scc1 L_AT_NPFB
    s_mov_b32 s52, s74
    s_mov_b32 s53, s75
    s_mov_b32 s54, 1966080
    s_mov_b32 s55, 0x20000
    s_and_b32 s3, s35, 1
    s_cmp_eq_u32 s3, 1
    s_cselect_b32 s52, s76, s52
    s_cselect_b32 s53, s77, s53
    v_min_u32 v2, 56, v1
    v_mul_u32_u24 v3, 86, v2
    v_lshrrev_b32 v3, 8, v3
    v_mul_u32_u24 v4, 3, v3
    v_sub_u32 v2, v2, v4
    v_mul_u32_u24 v3, 3072, v3
    v_lshl_add_u32 v2, v2, 7, v3
    s_lshr_b32 s3, s35, 1
    s_mul_i32 s3, s3, 58368
    s_mul_i32 s56, s34, 384
    s_add_u32 s3, s3, s56
    s_add_u32 s3, s3, 1032192
    buffer_load_dword v249, v2, s[52:55], s3 offen
L_AT_NPFB:
    s_waitcnt lgkmcnt(2)
    v_mfma_f32_32x32x16_bf16 v[40:55], v[16:19], v[8:11], 0
    v_mfma_f32_32x32x16_bf16 v[40:55], v[20:23], v[12:15], v[40:55]
    ds_read_b128 v[16:19], v146 offset:2560
    ds_read_b128 v[20:23], v147 offset:2560
    s_setprio 1
    s_nop 8
    v_exp_f32 v40, v40
    v_exp_f32 v41, v41
    v_exp_f32 v42, v42
    v_cvt_pk_bf16_f32 v32, v40, v41
    v_exp_f32 v43, v43
    s_waitcnt lgkmcnt(0)
    v_mfma_f32_32x32x16_bf16 v[56:71], v[16:19], v[8:11], 0
    v_exp_f32 v44, v44
    v_cvt_pk_bf16_f32 v33, v42, v43
    v_exp_f32 v45, v45
    v_exp_f32 v46, v46
    v_cvt_pk_bf16_f32 v34, v44, v45
    v_mfma_f32_32x32x16_bf16 v[56:71], v[20:23], v[12:15], v[56:71]
    ds_read_b128 v[16:19], v146 offset:3072
    ds_read_b128 v[20:23], v147 offset:3072
    v_exp_f32 v47, v47
    v_exp_f32 v48, v48
    v_cvt_pk_bf16_f32 v35, v46, v47
    v_exp_f32 v49, v49
    v_exp_f32 v50, v50
    s_setprio 0
    v_mfma_f32_32x32x16_bf16 v[72:87], v[24:27], v[32:35], 0
    v_cvt_pk_bf16_f32 v36, v48, v49
    v_exp_f32 v51, v51
    v_exp_f32 v52, v52
    v_cvt_pk_bf16_f32 v37, v50, v51
    v_exp_f32 v53, v53
    v_exp_f32 v54, v54
    v_exp_f32 v55, v55
    v_cvt_pk_bf16_f32 v38, v52, v53
    v_cvt_pk_bf16_f32 v39, v54, v55
    s_nop 1
    v_mfma_f32_32x32x16_bf16 v[72:87], v[28:31], v[36:39], v[72:87]
    s_mov_b64 exec, s[48:49]
    ds_read_b128 v[24:27], v148 offset:12800
    ds_read_b128 v[28:31], v148 offset:14080
    s_mov_b64 exec, -1
    s_setprio 1
    v_exp_f32 v56, v56
    v_exp_f32 v57, v57
    v_exp_f32 v58, v58
    v_cvt_pk_bf16_f32 v32, v56, v57
    v_exp_f32 v59, v59
    s_waitcnt lgkmcnt(2)
    v_mfma_f32_32x32x16_bf16 v[40:55], v[16:19], v[8:11], 0
    v_exp_f32 v60, v60
    v_cvt_pk_bf16_f32 v33, v58, v59
    v_exp_f32 v61, v61
    v_exp_f32 v62, v62
    v_cvt_pk_bf16_f32 v34, v60, v61
    v_mfma_f32_32x32x16_bf16 v[40:55], v[20:23], v[12:15], v[40:55]
    ds_read_b128 v[16:19], v146 offset:3584
    ds_read_b128 v[20:23], v147 offset:3584
    v_exp_f32 v63, v63
    v_exp_f32 v64, v64
    v_cvt_pk_bf16_f32 v35, v62, v63
    v_exp_f32 v65, v65
    v_exp_f32 v66, v66
    s_setprio 0
    s_waitcnt lgkmcnt(2)
    v_mfma_f32_32x32x16_bf16 v[72:87], v[24:27], v[32:35], v[72:87]
    v_cvt_pk_bf16_f32 v36, v64, v65
    v_exp_f32 v67, v67
    v_exp_f32 v68, v68
    v_cvt_pk_bf16_f32 v37, v66, v67
    v_exp_f32 v69, v69
    v_exp_f32 v70, v70
    v_exp_f32 v71, v71
    v_cvt_pk_bf16_f32 v38, v68, v69
    v_cvt_pk_bf16_f32 v39, v70, v71
    s_nop 1
    v_mfma_f32_32x32x16_bf16 v[72:87], v[28:31], v[36:39], v[72:87]
    s_mov_b64 exec, s[48:49]
    ds_read_b128 v[24:27], v148 offset:15360
    ds_read_b128 v[28:31], v148 offset:16640
    s_mov_b64 exec, -1
    s_setprio 1
    v_exp_f32 v40, v40
    v_exp_f32 v41, v41
    v_exp_f32 v42, v42
    v_cvt_pk_bf16_f32 v32, v40, v41
    v_exp_f32 v43, v43
    s_waitcnt lgkmcnt(2)
    v_mfma_f32_32x32x16_bf16 v[56:71], v[16:19], v[8:11], 0
    v_exp_f32 v44, v44
    v_cvt_pk_bf16_f32 v33, v42, v43
    v_exp_f32 v45, v45
    v_exp_f32 v46, v46
    v_cvt_pk_bf16_f32 v34, v44, v45
    v_mfma_f32_32x32x16_bf16 v[56:71], v[20:23], v[12:15], v[56:71]
    v_exp_f32 v47, v47
    v_exp_f32 v48, v48
    v_cvt_pk_bf16_f32 v35, v46, v47
    v_exp_f32 v49, v49
    v_exp_f32 v50, v50
    s_setprio 0
    s_waitcnt lgkmcnt(0)
    v_mfma_f32_32x32x16_bf16 v[72:87], v[24:27], v[32:35], v[72:87]
    v_cvt_pk_bf16_f32 v36, v48, v49
    v_exp_f32 v51, v51
    v_exp_f32 v52, v52
    v_cvt_pk_bf16_f32 v37, v50, v51
    v_exp_f32 v53, v53
    v_exp_f32 v54, v54
    v_exp_f32 v55, v55
    v_cvt_pk_bf16_f32 v38, v52, v53
    v_cvt_pk_bf16_f32 v39, v54, v55
    s_nop 1
    v_mfma_f32_32x32x16_bf16 v[72:87], v[28:31], v[36:39], v[72:87]
    s_mov_b64 exec, s[48:49]
    ds_read_b128 v[24:27], v148 offset:17920
    ds_read_b128 v[28:31], v148 offset:19200
    s_mov_b64 exec, -1
    s_setprio 1
    v_exp_f32 v56, v56
    v_exp_f32 v57, v57
    v_exp_f32 v58, v58
    v_cvt_pk_bf16_f32 v32, v56, v57
    v_exp_f32 v59, v59
    v_exp_f32 v60, v60
    v_cvt_pk_bf16_f32 v33, v58, v59
    v_exp_f32 v61, v61
    v_exp_f32 v62, v62
    v_cvt_pk_bf16_f32 v34, v60, v61
    v_exp_f32 v63, v63
    v_exp_f32 v64, v64
    v_cvt_pk_bf16_f32 v35, v62, v63
    s_cmp_ge_u32 s33, 7
    s_cbranch_scc1 L_A3_W7
    s_waitcnt vmcnt(0)
L_A3_W7:
    s_waitcnt vmcnt(1)
    s_barrier
    ds_read_b128 v[16:19], v136 offset:0
    ds_read_b128 v[20:23], v137 offset:0
    v_exp_f32 v65, v65
    v_exp_f32 v66, v66
    s_setprio 0
    s_waitcnt lgkmcnt(2)
    v_mfma_f32_32x32x16_bf16 v[72:87], v[24:27], v[32:35], v[72:87]
    v_cvt_pk_bf16_f32 v36, v64, v65
    v_exp_f32 v67, v67
    v_exp_f32 v68, v68
    v_cvt_pk_bf16_f32 v37, v66, v67
    v_exp_f32 v69, v69
    s_waitcnt lgkmcnt(0)
    v_mfma_f32_32x32x16_bf16 v[40:55], v[16:19], v[8:11], v[120:135]
    v_exp_f32 v70, v70
    v_exp_f32 v71, v71
    v_cvt_pk_bf16_f32 v38, v68, v69
    v_cvt_pk_bf16_f32 v39, v70, v71
    s_nop 1
    v_mfma_f32_32x32x16_bf16 v[72:87], v[28:31], v[36:39], v[72:87]
    s_mov_b64 exec, s[48:49]
    ds_read_b128 v[24:27], v138 offset:0
    ds_read_b128 v[28:31], v138 offset:1280
    s_mov_b64 exec, -1
    v_mfma_f32_32x32x16_bf16 v[40:55], v[20:23], v[12:15], v[40:55]
    ds_read_b128 v[16:19], v149 offset:512
    ds_read_b128 v[20:23], v150 offset:512
    s_setprio 1
    s_nop 8
    v_exp_f32 v40, v40
    v_exp_f32 v41, v41
    v_exp_f32 v42, v42
    v_cvt_pk_bf16_f32 v32, v40, v41
    v_exp_f32 v43, v43
    s_waitcnt lgkmcnt(0)
    v_mfma_f32_32x32x16_bf16 v[56:71], v[16:19], v[8:11], 0
    v_exp_f32 v44, v44
    v_cvt_pk_bf16_f32 v33, v42, v43
    v_exp_f32 v45, v45
    v_exp_f32 v46, v46
    v_cvt_pk_bf16_f32 v34, v44, v45
    v_mfma_f32_32x32x16_bf16 v[56:71], v[20:23], v[12:15], v[56:71]
    ds_read_b128 v[16:19], v152 offset:1024
    ds_read_b128 v[20:23], v153 offset:1024
    v_exp_f32 v47, v47
    v_exp_f32 v48, v48
    v_cvt_pk_bf16_f32 v35, v46, v47
    v_exp_f32 v49, v49
    v_exp_f32 v50, v50
    s_setprio 0
    v_mfma_f32_32x32x16_bf16 v[72:87], v[24:27], v[32:35], v[72:87]
    v_cvt_pk_bf16_f32 v36, v48, v49
    v_exp_f32 v51, v51
    v_exp_f32 v52, v52
    v_cvt_pk_bf16_f32 v37, v50, v51
    v_exp_f32 v53, v53
    v_exp_f32 v54, v54
    v_exp_f32 v55, v55
    v_cvt_pk_bf16_f32 v38, v52, v53
    v_cvt_pk_bf16_f32 v39, v54, v55
    s_nop 1
    v_mfma_f32_32x32x16_bf16 v[72:87], v[28:31], v[36:39], v[72:87]
    s_mov_b64 exec, s[48:49]
    ds_read_b128 v[24:27], v151 offset:2560
    ds_read_b128 v[28:31], v151 offset:3840
    s_mov_b64 exec, -1
    s_setprio 1
    v_exp_f32 v56, v56
    v_exp_f32 v57, v57
    v_exp_f32 v58, v58
    v_cvt_pk_bf16_f32 v32, v56, v57
    v_exp_f32 v59, v59
    s_waitcnt lgkmcnt(2)
    v_mfma_f32_32x32x16_bf16 v[40:55], v[16:19], v[8:11], 0
    s_lshl_b32 s57, s38, 2
    s_add_u32 s57, s57, s33
    s_mul_i32 s57, s57, 2560
    s_mul_i32 s3, s39, 160
    s_add_u32 s57, s57, s3
    s_add_u32 s57, s57, 1038336
    s_mov_b64 exec, 0xfffff
    buffer_store_dwordx4 v[200:203], v212, s[16:19], s57 offen sc1
    s_mov_b64 exec, -1
    v_exp_f32 v60, v60
    v_cvt_pk_bf16_f32 v33, v58, v59
    v_exp_f32 v61, v61
    v_exp_f32 v62, v62
    v_cvt_pk_bf16_f32 v34, v60, v61
    v_mfma_f32_32x32x16_bf16 v[40:55], v[20:23], v[12:15], v[40:55]
    ds_read_b128 v[16:19], v155 offset:1536
    ds_read_b128 v[20:23], v156 offset:1536
    v_exp_f32 v63, v63
    v_exp_f32 v64, v64
    v_cvt_pk_bf16_f32 v35, v62, v63
    v_exp_f32 v65, v65
    v_exp_f32 v66, v66
    s_setprio 0
    s_waitcnt lgkmcnt(2)
    v_mfma_f32_32x32x16_bf16 v[72:87], v[24:27], v[32:35], v[72:87]
    v_cvt_pk_bf16_f32 v36, v64, v65
    v_exp_f32 v67, v67
    v_exp_f32 v68, v68
    v_cvt_pk_bf16_f32 v37, v66, v67
    v_exp_f32 v69, v69
    v_exp_f32 v70, v70
    v_exp_f32 v71, v71
    v_cvt_pk_bf16_f32 v38, v68, v69
    v_cvt_pk_bf16_f32 v39, v70, v71
    s_nop 1
    v_mfma_f32_32x32x16_bf16 v[72:87], v[28:31], v[36:39], v[72:87]
    s_mov_b64 exec, s[48:49]
    ds_read_b128 v[24:27], v154 offset:5120
    ds_read_b128 v[28:31], v154 offset:6400
    s_mov_b64 exec, -1
    s_setprio 1
    v_exp_f32 v40, v40
    v_exp_f32 v41, v41
    v_exp_f32 v42, v42
    v_cvt_pk_bf16_f32 v32, v40, v41
    v_exp_f32 v43, v43
    s_waitcnt lgkmcnt(2)
    v_mfma_f32_32x32x16_bf16 v[56:71], v[16:19], v[8:11], 0
    v_exp_f32 v44, v44
    v_cvt_pk_bf16_f32 v33, v42, v43
    v_exp_f32 v45, v45
    v_exp_f32 v46, v46
    v_cvt_pk_bf16_f32 v34, v44, v45
    v_mfma_f32_32x32x16_bf16 v[56:71], v[20:23], v[12:15], v[56:71]
    ds_read_b128 v[16:19], v136 offset:4096
    ds_read_b128 v[20:23], v137 offset:4096
    v_exp_f32 v47, v47
    v_exp_f32 v48, v48
    v_cvt_pk_bf16_f32 v35, v46, v47
    v_exp_f32 v49, v49
    v_exp_f32 v50, v50
    s_setprio 0
    s_waitcnt lgkmcnt(2)
    v_mfma_f32_32x32x16_bf16 v[72:87], v[24:27], v[32:35], v[72:87]
    v_cvt_pk_bf16_f32 v36, v48, v49
    v_exp_f32 v51, v51
    v_exp_f32 v52, v52
    v_cvt_pk_bf16_f32 v37, v50, v51
    v_exp_f32 v53, v53
    v_exp_f32 v54, v54
    v_exp_f32 v55, v55
    v_cvt_pk_bf16_f32 v38, v52, v53
    v_cvt_pk_bf16_f32 v39, v54, v55
    s_nop 1
    v_mfma_f32_32x32x16_bf16 v[72:87], v[28:31], v[36:39], v[72:87]
    s_mov_b64 exec, s[48:49]
    ds_read_b128 v[24:27], v157 offset:7680
    ds_read_b128 v[28:31], v157 offset:8960
    s_mov_b64 exec, -1
    s_setprio 1
    v_exp_f32 v56, v56
    v_exp_f32 v57, v57
    v_exp_f32 v58, v58
    v_cvt_pk_bf16_f32 v32, v56, v57
    v_exp_f32 v59, v59
    s_waitcnt lgkmcnt(2)
    v_mfma_f32_32x32x16_bf16 v[40:55], v[16:19], v[8:11], v[104:119]
    v_exp_f32 v60, v60
    v_cvt_pk_bf16_f32 v33, v58, v59
    v_exp_f32 v61, v61
    v_exp_f32 v62, v62
    v_cvt_pk_bf16_f32 v34, v60, v61
    v_mfma_f32_32x32x16_bf16 v[40:55], v[20:23], v[12:15], v[40:55]
    v_exp_f32 v63, v63
    v_exp_f32 v64, v64
    v_cvt_pk_bf16_f32 v35, v62, v63
    v_exp_f32 v65, v65
    v_exp_f32 v66, v66
    s_setprio 0
    s_waitcnt lgkmcnt(0)
    v_mfma_f32_32x32x16_bf16 v[72:87], v[24:27], v[32:35], v[72:87]
    v_cvt_pk_bf16_f32 v36, v64, v65
    v_exp_f32 v67, v67
    v_exp_f32 v68, v68
    v_cvt_pk_bf16_f32 v37, v66, v67
    v_exp_f32 v69, v69
    v_exp_f32 v70, v70
    v_exp_f32 v71, v71
    v_cvt_pk_bf16_f32 v38, v68, v69
    v_cvt_pk_bf16_f32 v39, v70, v71
    s_nop 1
    v_mfma_f32_32x32x16_bf16 v[72:87], v[28:31], v[36:39], v[72:87]
    s_mov_b64 exec, s[48:49]
    ds_read_b128 v[24:27], v138 offset:20480
    ds_read_b128 v[28:31], v138 offset:21760
    s_mov_b64 exec, -1
    s_setprio 1
    v_exp_f32 v40, v40
    v_exp_f32 v41, v41
    v_exp_f32 v42, v42
    v_cvt_pk_bf16_f32 v32, v40, v41
    v_exp_f32 v43, v43
    v_exp_f32 v44, v44
    v_cvt_pk_bf16_f32 v33, v42, v43
    v_exp_f32 v45, v45
    v_exp_f32 v46, v46
    v_cvt_pk_bf16_f32 v34, v44, v45
    v_exp_f32 v47, v47
    v_exp_f32 v48, v48
    v_cvt_pk_bf16_f32 v35, v46, v47
    v_exp_f32 v49, v49
    v_exp_f32 v50, v50
    s_setprio 0
    s_waitcnt lgkmcnt(0)
    v_mfma_f32_32x32x16_bf16 v[72:87], v[24:27], v[32:35], v[72:87]
    v_cvt_pk_bf16_f32 v36, v48, v49
    v_exp_f32 v51, v51
    v_exp_f32 v52, v52
    v_cvt_pk_bf16_f32 v37, v50, v51
    v_exp_f32 v53, v53
    v_exp_f32 v54, v54
    v_exp_f32 v55, v55
    v_cvt_pk_bf16_f32 v38, v52, v53
    v_cvt_pk_bf16_f32 v39, v54, v55
    s_nop 1
    v_mfma_f32_32x32x16_bf16 v[72:87], v[28:31], v[36:39], v[72:87]
    s_branch L_AT_DONE
    .fill 4, 4, 0xbf800000
L_AT_OLD:
    s_cmp_lt_u32 s33, 7
    s_cbranch_scc1 L_AT_NPFA
    s_mov_b32 s52, s74
    s_mov_b32 s53, s75
    s_mov_b32 s54, 1966080
    s_mov_b32 s55, 0x20000
    s_and_b32 s3, s35, 1
    s_cmp_eq_u32 s3, 1
    s_cselect_b32 s52, s76, s52
    s_cselect_b32 s53, s77, s53
    v_min_u32 v2, 56, v1
    v_mul_u32_u24 v3, 86, v2
    v_lshrrev_b32 v3, 8, v3
    v_mul_u32_u24 v4, 3, v3
    v_sub_u32 v2, v2, v4
    v_mul_u32_u24 v3, 3072, v3
    v_lshl_add_u32 v2, v2, 7, v3
    s_lshr_b32 s3, s35, 1
    s_mul_i32 s3, s3, 58368
    s_mul_i32 s56, s34, 384
    s_add_u32 s3, s3, s56
    s_add_u32 s3, s3, 1032192
    buffer_load_dword v249, v2, s[52:55], s3 offen
L_AT_NPFA:
    s_cmp_lt_u32 s33, 4
    s_cbranch_scc1 L_AT_OR
    s_lshl_b32 s57, s38, 2
    s_add_u32 s57, s57, s33
    s_mul_i32 s57, s57, 2560
    s_mul_i32 s3, s39, 160
    s_add_u32 s57, s57, s3
    s_add_u32 s57, s57, 1038336
    s_mov_b64 exec, 0xfffff
    buffer_store_dwordx4 v[200:203], v212, s[16:19], s57 offen sc1
    s_mov_b64 exec, -1
L_AT_OR:
    s_cmp_ge_u32 s33, 4
    s_cbranch_scc1 L_AT_START
    s_cmp_ge_u32 s50, 4
    s_cbranch_scc1 L_AT_START0
    s_mov_b64 exec, s[64:65]
    s_cmp_ge_u32 s72, 17
    s_cselect_b32 s3, 8, 4
    s_add_u32 s3, s3, s72
    s_mul_i32 s62, s3, 3200
    s_lshl_b32 s60, s62, 3
    s_add_u32 s60, s60, s73
    s_add_u32 s72, s72, 4
    s_cmp_ge_u32 s72, 24
    s_cselect_b32 s3, 24, 0
    s_sub_u32 s72, s72, s3
    s_add_u32 m0, s62, 0
    s_add_u32 s3, s60, 0
    buffer_load_dwordx4 v145, s[12:15], s3 offen lds
    s_add_u32 m0, s62, 800
    s_add_u32 s3, s60, 6400
    buffer_load_dwordx4 v145, s[12:15], s3 offen lds
    s_add_u32 m0, s62, 1600
    s_add_u32 s3, s60, 12800
    buffer_load_dwordx4 v145, s[12:15], s3 offen lds
    s_add_u32 m0, s62, 2400
    s_add_u32 s3, s60, 19200
    buffer_load_dwordx4 v145, s[12:15], s3 offen lds
    s_mov_b64 exec, -1
    s_mov_b64 exec, s[64:65]
    s_cmp_ge_u32 s72, 17
    s_cselect_b32 s3, 8, 4
    s_add_u32 s3, s3, s72
    s_mul_i32 s62, s3, 3200
    s_lshl_b32 s60, s62, 3
    s_add_u32 s60, s60, s73
    s_add_u32 s72, s72, 4
    s_cmp_ge_u32 s72, 24
    s_cselect_b32 s3, 24, 0
    s_sub_u32 s72, s72, s3
    s_add_u32 m0, s62, 0
    s_add_u32 s3, s60, 0
    buffer_load_dwordx4 v145, s[12:15], s3 offen lds
    s_add_u32 m0, s62, 800
    s_add_u32 s3, s60, 6400
    buffer_load_dwordx4 v145, s[12:15], s3 offen lds
    s_add_u32 m0, s62, 1600
    s_add_u32 s3, s60, 12800
    buffer_load_dwordx4 v145, s[12:15], s3 offen lds
    s_add_u32 m0, s62, 2400
    s_add_u32 s3, s60, 19200
    buffer_load_dwordx4 v145, s[12:15], s3 offen lds
    s_mov_b64 exec, -1
    s_mov_b64 exec, s[64:65]
    s_cmp_ge_u32 s72, 17
    s_cselect_b32 s3, 8, 4
    s_add_u32 s3, s3, s72
    s_mul_i32 s62, s3, 3200
    s_lshl_b32 s60, s62, 3
    s_add_u32 s60, s60, s73
    s_add_u32 s72, s72, 4
    s_cmp_ge_u32 s72, 24
    s_cselect_b32 s3, 24, 0
    s_sub_u32 s72, s72, s3
    s_add_u32 m0, s62, 0
    s_add_u32 s3, s60, 0
    buffer_load_dwordx4 v145, s[12:15], s3 offen lds
    s_add_u32 m0, s62, 800
    s_add_u32 s3, s60, 6400
    buffer_load_dwordx4 v145, s[12:15], s3 offen lds
    s_add_u32 m0, s62, 1600
    s_add_u32 s3, s60, 12800
    buffer_load_dwordx4 v145, s[12:15], s3 offen lds
    s_add_u32 m0, s62, 2400
    s_add_u32 s3, s60, 19200
    buffer_load_dwordx4 v145, s[12:15], s3 offen lds
    s_mov_b64 exec, -1
    s_mov_b64 exec, s[64:65]
    s_cmp_ge_u32 s72, 17
    s_cselect_b32 s3, 8, 4
    s_add_u32 s3, s3, s72
    s_mul_i32 s62, s3, 3200
    s_lshl_b32 s60, s62, 3
    s_add_u32 s60, s60, s73
    s_add_u32 s72, s72, 4
    s_cmp_ge_u32 s72, 24
    s_cselect_b32 s3, 24, 0
    s_sub_u32 s72, s72, s3
    s_add_u32 m0, s62, 0
    s_add_u32 s3, s60, 0
    buffer_load_dwordx4 v145, s[12:15], s3 offen lds
    s_add_u32 m0, s62, 800
    s_add_u32 s3, s60, 6400
    buffer_load_dwordx4 v145, s[12:15], s3 offen lds
    s_add_u32 m0, s62, 1600
    s_add_u32 s3, s60, 12800
    buffer_load_dwordx4 v145, s[12:15], s3 offen lds
    s_add_u32 m0, s62, 2400
    s_add_u32 s3, s60, 19200
    buffer_load_dwordx4 v145, s[12:15], s3 offen lds
    s_mov_b64 exec, -1
    s_mov_b64 exec, s[64:65]
    s_cmp_ge_u32 s72, 17
    s_cselect_b32 s3, 8, 4
    s_add_u32 s3, s3, s72
    s_mul_i32 s62, s3, 3200
    s_lshl_b32 s60, s62, 3
    s_add_u32 s60, s60, s73
    s_add_u32 s72, s72, 4
    s_cmp_ge_u32 s72, 24
    s_cselect_b32 s3, 24, 0
    s_sub_u32 s72, s72, s3
    s_add_u32 m0, s62, 0
    s_add_u32 s3, s60, 0
    buffer_load_dwordx4 v145, s[12:15], s3 offen lds
    s_add_u32 m0, s62, 800
    s_add_u32 s3, s60, 6400
    buffer_load_dwordx4 v145, s[12:15], s3 offen lds
    s_add_u32 m0, s62, 1600
    s_add_u32 s3, s60, 12800
    buffer_load_dwordx4 v145, s[12:15], s3 offen lds
    s_add_u32 m0, s62, 2400
    s_add_u32 s3, s60, 19200
    buffer_load_dwordx4 v145, s[12:15], s3 offen lds
    s_mov_b64 exec, -1
    s_mov_b64 exec, s[64:65]
    s_cmp_ge_u32 s72, 17
    s_cselect_b32 s3, 8, 4
    s_add_u32 s3, s3, s72
    s_mul_i32 s62, s3, 3200
    s_lshl_b32 s60, s62, 3
    s_add_u32 s60, s60, s73
    s_add_u32 s72, s72, 4
    s_cmp_ge_u32 s72, 24
    s_cselect_b32 s3, 24, 0
    s_sub_u32 s72, s72, s3
    s_add_u32 m0, s62, 0
    s_add_u32 s3, s60, 0
    buffer_load_dwordx4 v145, s[12:15], s3 offen lds
    s_add_u32 m0, s62, 800
    s_add_u32 s3, s60, 6400
    buffer_load_dwordx4 v145, s[12:15], s3 offen lds
    s_add_u32 m0, s62, 1600
    s_add_u32 s3, s60, 12800
    buffer_load_dwordx4 v145, s[12:15], s3 offen lds
    s_add_u32 m0, s62, 2400
    s_add_u32 s3, s60, 19200
    buffer_load_dwordx4 v145, s[12:15], s3 offen lds
    s_mov_b64 exec, -1
L_AT_START:
    s_mov_b32 s63, 1
    s_branch L_AT_GO
L_AT_START0:
    s_mov_b32 s63, 0
L_AT_GO:
    ds_read_b128 v[16:19], v136 offset:4096
    ds_read_b128 v[20:23], v137 offset:4096
    s_mov_b64 exec, s[48:49]
    ds_read_b128 v[24:27], v138 offset:20480
    ds_read_b128 v[28:31], v138 offset:21760
    s_mov_b64 exec, -1
    s_waitcnt lgkmcnt(2)
    v_mfma_f32_32x32x16_bf16 v[40:55], v[16:19], v[8:11], v[104:119]
    v_mfma_f32_32x32x16_bf16 v[40:55], v[20:23], v[12:15], v[40:55]
    ds_read_b128 v[16:19], v136 offset:3584
    ds_read_b128 v[20:23], v137 offset:3584
    s_cmp_lt_u32 s50, 1
    s_cbranch_scc1 L_AT_TAIL1
    s_waitcnt lgkmcnt(0)
    v_mfma_f32_32x32x16_bf16 v[56:71], v[16:19], v[8:11], v[88:103]
    v_mfma_f32_32x32x16_bf16 v[56:71], v[20:23], v[12:15], v[56:71]
    ds_read_b128 v[16:19], v136 offset:3072
    ds_read_b128 v[20:23], v137 offset:3072
    s_cmp_lg_u32 s63, 0
    s_cbranch_scc1 L_AT_NB1
    s_mov_b64 exec, s[64:65]
    s_cmp_ge_u32 s72, 17
    s_cselect_b32 s3, 8, 4
    s_add_u32 s3, s3, s72
    s_mul_i32 s62, s3, 3200
    s_lshl_b32 s60, s62, 3
    s_add_u32 s60, s60, s73
    s_add_u32 s72, s72, 4
    s_cmp_ge_u32 s72, 24
    s_cselect_b32 s3, 24, 0
    s_sub_u32 s72, s72, s3
    s_add_u32 m0, s62, 0
    s_add_u32 s3, s60, 0
    buffer_load_dwordx4 v145, s[12:15], s3 offen lds
    s_add_u32 m0, s62, 800
    s_add_u32 s3, s60, 6400
    buffer_load_dwordx4 v145, s[12:15], s3 offen lds
    s_add_u32 m0, s62, 1600
    s_add_u32 s3, s60, 12800
    buffer_load_dwordx4 v145, s[12:15], s3 offen lds
    s_add_u32 m0, s62, 2400
    s_add_u32 s3, s60, 19200
    buffer_load_dwordx4 v145, s[12:15], s3 offen lds
    s_cmp_ge_u32 s72, 17
    s_cselect_b32 s3, 8, 4
    s_add_u32 s3, s3, s72
    s_mul_i32 s62, s3, 3200
    s_lshl_b32 s60, s62, 3
    s_add_u32 s60, s60, s73
    s_add_u32 s72, s72, 4
    s_cmp_ge_u32 s72, 24
    s_cselect_b32 s3, 24, 0
    s_sub_u32 s72, s72, s3
    s_add_u32 m0, s62, 0
    s_add_u32 s3, s60, 0
    buffer_load_dwordx4 v145, s[12:15], s3 offen lds
    s_add_u32 m0, s62, 800
    s_add_u32 s3, s60, 6400
    buffer_load_dwordx4 v145, s[12:15], s3 offen lds
    s_mov_b64 exec, -1
L_AT_NB1:
    s_nop 0
    v_exp_f32 v40, v40
    v_exp_f32 v41, v41
    v_exp_f32 v42, v42
    v_cvt_pk_bf16_f32 v32, v40, v41
    v_exp_f32 v43, v43
    v_exp_f32 v44, v44
    v_cvt_pk_bf16_f32 v33, v42, v43
    v_exp_f32 v45, v45
    v_exp_f32 v46, v46
    v_cvt_pk_bf16_f32 v34, v44, v45
    v_exp_f32 v47, v47
    v_exp_f32 v48, v48
    v_cvt_pk_bf16_f32 v35, v46, v47
    v_exp_f32 v49, v49
    v_exp_f32 v50, v50
    s_waitcnt lgkmcnt(2)
    v_mfma_f32_32x32x16_bf16 v[72:87], v[24:27], v[32:35], 0
    v_cvt_pk_bf16_f32 v36, v48, v49
    v_exp_f32 v51, v51
    v_exp_f32 v52, v52
    v_cvt_pk_bf16_f32 v37, v50, v51
    v_exp_f32 v53, v53
    v_exp_f32 v54, v54
    v_exp_f32 v55, v55
    v_cvt_pk_bf16_f32 v38, v52, v53
    v_cvt_pk_bf16_f32 v39, v54, v55
    s_nop 1
    v_mfma_f32_32x32x16_bf16 v[72:87], v[28:31], v[36:39], v[72:87]
    s_mov_b64 exec, s[48:49]
    ds_read_b128 v[24:27], v138 offset:17920
    ds_read_b128 v[28:31], v138 offset:19200
    s_mov_b64 exec, -1
    s_cmp_lt_u32 s50, 2
    s_cbranch_scc1 L_AT_TAIL2
    s_waitcnt lgkmcnt(2)
    v_mfma_f32_32x32x16_bf16 v[40:55], v[16:19], v[8:11], v[88:103]
    v_mfma_f32_32x32x16_bf16 v[40:55], v[20:23], v[12:15], v[40:55]
    ds_read_b128 v[16:19], v136 offset:2560
    ds_read_b128 v[20:23], v137 offset:2560
    s_cmp_lg_u32 s63, 0
    s_cbranch_scc1 L_AT_NB2
    s_mov_b64 exec, s[64:65]
    s_add_u32 m0, s62, 1600
    s_add_u32 s3, s60, 12800
    buffer_load_dwordx4 v145, s[12:15], s3 offen lds
    s_add_u32 m0, s62, 2400
    s_add_u32 s3, s60, 19200
    buffer_load_dwordx4 v145, s[12:15], s3 offen lds
    s_cmp_ge_u32 s72, 17
    s_cselect_b32 s3, 8, 4
    s_add_u32 s3, s3, s72
    s_mul_i32 s62, s3, 3200
    s_lshl_b32 s60, s62, 3
    s_add_u32 s60, s60, s73
    s_add_u32 s72, s72, 4
    s_cmp_ge_u32 s72, 24
    s_cselect_b32 s3, 24, 0
    s_sub_u32 s72, s72, s3
    s_add_u32 m0, s62, 0
    s_add_u32 s3, s60, 0
    buffer_load_dwordx4 v145, s[12:15], s3 offen lds
    s_add_u32 m0, s62, 800
    s_add_u32 s3, s60, 6400
    buffer_load_dwordx4 v145, s[12:15], s3 offen lds
    s_add_u32 m0, s62, 1600
    s_add_u32 s3, s60, 12800
    buffer_load_dwordx4 v145, s[12:15], s3 offen lds
    s_add_u32 m0, s62, 2400
    s_add_u32 s3, s60, 19200
    buffer_load_dwordx4 v145, s[12:15], s3 offen lds
    s_mov_b64 exec, -1
L_AT_NB2:
    v_exp_f32 v56, v56
    v_exp_f32 v57, v57
    v_exp_f32 v58, v58
    v_cvt_pk_bf16_f32 v32, v56, v57
    v_exp_f32 v59, v59
    v_exp_f32 v60, v60
    v_cvt_pk_bf16_f32 v33, v58, v59
    v_exp_f32 v61, v61
    v_exp_f32 v62, v62
    v_cvt_pk_bf16_f32 v34, v60, v61
    v_exp_f32 v63, v63
    v_exp_f32 v64, v64
    v_cvt_pk_bf16_f32 v35, v62, v63
    v_exp_f32 v65, v65
    v_exp_f32 v66, v66
    s_waitcnt lgkmcnt(2)
    v_mfma_f32_32x32x16_bf16 v[72:87], v[24:27], v[32:35], v[72:87]
    v_cvt_pk_bf16_f32 v36, v64, v65
    v_exp_f32 v67, v67
    v_exp_f32 v68, v68
    v_cvt_pk_bf16_f32 v37, v66, v67
    v_exp_f32 v69, v69
    v_exp_f32 v70, v70
    v_exp_f32 v71, v71
    v_cvt_pk_bf16_f32 v38, v68, v69
    v_cvt_pk_bf16_f32 v39, v70, v71
    s_nop 1
    v_mfma_f32_32x32x16_bf16 v[72:87], v[28:31], v[36:39], v[72:87]
    s_mov_b64 exec, s[48:49]
    ds_read_b128 v[24:27], v138 offset:15360
    ds_read_b128 v[28:31], v138 offset:16640
    s_mov_b64 exec, -1
    s_cmp_lt_u32 s50, 3
    s_cbranch_scc1 L_AT_TAIL3
    s_waitcnt lgkmcnt(2)
    v_mfma_f32_32x32x16_bf16 v[56:71], v[16:19], v[8:11], v[88:103]
    v_mfma_f32_32x32x16_bf16 v[56:71], v[20:23], v[12:15], v[56:71]
    ds_read_b128 v[16:19], v136 offset:2048
    ds_read_b128 v[20:23], v137 offset:2048
    s_cmp_lg_u32 s63, 0
    s_cbranch_scc1 L_AT_NB3
    s_mov_b64 exec, s[64:65]
    s_cmp_ge_u32 s72, 17
    s_cselect_b32 s3, 8, 4
    s_add_u32 s3, s3, s72
    s_mul_i32 s62, s3, 3200
    s_lshl_b32 s60, s62, 3
    s_add_u32 s60, s60, s73
    s_add_u32 s72, s72, 4
    s_cmp_ge_u32 s72, 24
    s_cselect_b32 s3, 24, 0
    s_sub_u32 s72, s72, s3
    s_add_u32 m0, s62, 0
    s_add_u32 s3, s60, 0
    buffer_load_dwordx4 v145, s[12:15], s3 offen lds
    s_add_u32 m0, s62, 800
    s_add_u32 s3, s60, 6400
    buffer_load_dwordx4 v145, s[12:15], s3 offen lds
    s_add_u32 m0, s62, 1600
    s_add_u32 s3, s60, 12800
    buffer_load_dwordx4 v145, s[12:15], s3 offen lds
    s_add_u32 m0, s62, 2400
    s_add_u32 s3, s60, 19200
    buffer_load_dwordx4 v145, s[12:15], s3 offen lds
    s_cmp_ge_u32 s72, 17
    s_cselect_b32 s3, 8, 4
    s_add_u32 s3, s3, s72
    s_mul_i32 s62, s3, 3200
    s_lshl_b32 s60, s62, 3
    s_add_u32 s60, s60, s73
    s_add_u32 s72, s72, 4
    s_cmp_ge_u32 s72, 24
    s_cselect_b32 s3, 24, 0
    s_sub_u32 s72, s72, s3
    s_add_u32 m0, s62, 0
    s_add_u32 s3, s60, 0
    buffer_load_dwordx4 v145, s[12:15], s3 offen lds
    s_add_u32 m0, s62, 800
    s_add_u32 s3, s60, 6400
    buffer_load_dwordx4 v145, s[12:15], s3 offen lds
    s_mov_b64 exec, -1
L_AT_NB3:
    v_exp_f32 v40, v40
    v_exp_f32 v41, v41
    v_exp_f32 v42, v42
    v_cvt_pk_bf16_f32 v32, v40, v41
    v_exp_f32 v43, v43
    v_exp_f32 v44, v44
    v_cvt_pk_bf16_f32 v33, v42, v43
    v_exp_f32 v45, v45
    v_exp_f32 v46, v46
    v_cvt_pk_bf16_f32 v34, v44, v45
    v_exp_f32 v47, v47
    v_exp_f32 v48, v48
    v_cvt_pk_bf16_f32 v35, v46, v47
    v_exp_f32 v49, v49
    v_exp_f32 v50, v50
    s_waitcnt lgkmcnt(2)
    v_mfma_f32_32x32x16_bf16 v[72:87], v[24:27], v[32:35], v[72:87]
    v_cvt_pk_bf16_f32 v36, v48, v49
    v_exp_f32 v51, v51
    v_exp_f32 v52, v52
    v_cvt_pk_bf16_f32 v37, v50, v51
    v_exp_f32 v53, v53
    v_exp_f32 v54, v54
    v_exp_f32 v55, v55
    v_cvt_pk_bf16_f32 v38, v52, v53
    v_cvt_pk_bf16_f32 v39, v54, v55
    s_nop 1
    v_mfma_f32_32x32x16_bf16 v[72:87], v[28:31], v[36:39], v[72:87]
    s_mov_b64 exec, s[48:49]
    ds_read_b128 v[24:27], v138 offset:12800
    ds_read_b128 v[28:31], v138 offset:14080
    s_mov_b64 exec, -1
    s_cmp_lt_u32 s50, 4
    s_cbranch_scc1 L_AT_TAIL4
    s_waitcnt lgkmcnt(2)
    v_mfma_f32_32x32x16_bf16 v[40:55], v[16:19], v[8:11], v[88:103]
    v_mfma_f32_32x32x16_bf16 v[40:55], v[20:23], v[12:15], v[40:55]
    ds_read_b128 v[16:19], v136 offset:1536
    ds_read_b128 v[20:23], v137 offset:1536
    s_cmp_lg_u32 s63, 0
    s_cbranch_scc1 L_AT_NB4
    s_mov_b64 exec, s[64:65]
    s_add_u32 m0, s62, 1600
    s_add_u32 s3, s60, 12800
    buffer_load_dwordx4 v145, s[12:15], s3 offen lds
    s_add_u32 m0, s62, 2400
    s_add_u32 s3, s60, 19200
    buffer_load_dwordx4 v145, s[12:15], s3 offen lds
    s_cmp_ge_u32 s72, 17
    s_cselect_b32 s3, 8, 4
    s_add_u32 s3, s3, s72
    s_mul_i32 s62, s3, 3200
    s_lshl_b32 s60, s62, 3
    s_add_u32 s60, s60, s73
    s_add_u32 s72, s72, 4
    s_cmp_ge_u32 s72, 24
    s_cselect_b32 s3, 24, 0
    s_sub_u32 s72, s72, s3
    s_add_u32 m0, s62, 0
    s_add_u32 s3, s60, 0
    buffer_load_dwordx4 v145, s[12:15], s3 offen lds
    s_add_u32 m0, s62, 800
    s_add_u32 s3, s60, 6400
    buffer_load_dwordx4 v145, s[12:15], s3 offen lds
    s_add_u32 m0, s62, 1600
    s_add_u32 s3, s60, 12800
    buffer_load_dwordx4 v145, s[12:15], s3 offen lds
    s_add_u32 m0, s62, 2400
    s_add_u32 s3, s60, 19200
    buffer_load_dwordx4 v145, s[12:15], s3 offen lds
    s_mov_b64 exec, -1
L_AT_NB4:
    v_exp_f32 v56, v56
    v_exp_f32 v57, v57
    v_exp_f32 v58, v58
    v_cvt_pk_bf16_f32 v32, v56, v57
    v_exp_f32 v59, v59
    v_exp_f32 v60, v60
    v_cvt_pk_bf16_f32 v33, v58, v59
    v_exp_f32 v61, v61
    v_exp_f32 v62, v62
    v_cvt_pk_bf16_f32 v34, v60, v61
    v_exp_f32 v63, v63
    v_exp_f32 v64, v64
    v_cvt_pk_bf16_f32 v35, v62, v63
    v_exp_f32 v65, v65
    v_exp_f32 v66, v66
    s_waitcnt lgkmcnt(2)
    v_mfma_f32_32x32x16_bf16 v[72:87], v[24:27], v[32:35], v[72:87]
    v_cvt_pk_bf16_f32 v36, v64, v65
    v_exp_f32 v67, v67
    v_exp_f32 v68, v68
    v_cvt_pk_bf16_f32 v37, v66, v67
    v_exp_f32 v69, v69
    v_exp_f32 v70, v70
    v_exp_f32 v71, v71
    v_cvt_pk_bf16_f32 v38, v68, v69
    v_cvt_pk_bf16_f32 v39, v70, v71
    s_nop 1
    v_mfma_f32_32x32x16_bf16 v[72:87], v[28:31], v[36:39], v[72:87]
    s_mov_b64 exec, s[48:49]
    ds_read_b128 v[24:27], v138 offset:10240
    ds_read_b128 v[28:31], v138 offset:11520
    s_mov_b64 exec, -1
    s_cmp_lt_u32 s50, 5
    s_cbranch_scc1 L_AT_TAIL5
    s_waitcnt lgkmcnt(2)
    v_mfma_f32_32x32x16_bf16 v[56:71], v[16:19], v[8:11], v[88:103]
    v_mfma_f32_32x32x16_bf16 v[56:71], v[20:23], v[12:15], v[56:71]
    ds_read_b128 v[16:19], v136 offset:1024
    ds_read_b128 v[20:23], v137 offset:1024
    v_exp_f32 v40, v40
    v_exp_f32 v41, v41
    v_exp_f32 v42, v42
    v_cvt_pk_bf16_f32 v32, v40, v41
    v_exp_f32 v43, v43
    v_exp_f32 v44, v44
    v_cvt_pk_bf16_f32 v33, v42, v43
    v_exp_f32 v45, v45
    v_exp_f32 v46, v46
    v_cvt_pk_bf16_f32 v34, v44, v45
    v_exp_f32 v47, v47
    v_exp_f32 v48, v48
    v_cvt_pk_bf16_f32 v35, v46, v47
    v_exp_f32 v49, v49
    v_exp_f32 v50, v50
    s_waitcnt lgkmcnt(2)
    v_mfma_f32_32x32x16_bf16 v[72:87], v[24:27], v[32:35], v[72:87]
    v_cvt_pk_bf16_f32 v36, v48, v49
    v_exp_f32 v51, v51
    v_exp_f32 v52, v52
    v_cvt_pk_bf16_f32 v37, v50, v51
    v_exp_f32 v53, v53
    v_exp_f32 v54, v54
    v_exp_f32 v55, v55
    v_cvt_pk_bf16_f32 v38, v52, v53
    v_cvt_pk_bf16_f32 v39, v54, v55
    s_nop 1
    v_mfma_f32_32x32x16_bf16 v[72:87], v[28:31], v[36:39], v[72:87]
    s_mov_b64 exec, s[48:49]
    ds_read_b128 v[24:27], v138 offset:7680
    ds_read_b128 v[28:31], v138 offset:8960
    s_mov_b64 exec, -1
    s_cmp_lt_u32 s50, 6
    s_cbranch_scc1 L_AT_TAIL6
    s_waitcnt lgkmcnt(2)
    v_mfma_f32_32x32x16_bf16 v[40:55], v[16:19], v[8:11], v[88:103]
    v_mfma_f32_32x32x16_bf16 v[40:55], v[20:23], v[12:15], v[40:55]
    ds_read_b128 v[16:19], v136 offset:512
    ds_read_b128 v[20:23], v137 offset:512
    v_exp_f32 v56, v56
    v_exp_f32 v57, v57
    v_exp_f32 v58, v58
    v_cvt_pk_bf16_f32 v32, v56, v57
    v_exp_f32 v59, v59
    v_exp_f32 v60, v60
    v_cvt_pk_bf16_f32 v33, v58, v59
    v_exp_f32 v61, v61
    v_exp_f32 v62, v62
    v_cvt_pk_bf16_f32 v34, v60, v61
    v_exp_f32 v63, v63
    v_exp_f32 v64, v64
    v_cvt_pk_bf16_f32 v35, v62, v63
    v_exp_f32 v65, v65
    v_exp_f32 v66, v66
    s_waitcnt lgkmcnt(2)
    v_mfma_f32_32x32x16_bf16 v[72:87], v[24:27], v[32:35], v[72:87]
    v_cvt_pk_bf16_f32 v36, v64, v65
    v_exp_f32 v67, v67
    v_exp_f32 v68, v68
    v_cvt_pk_bf16_f32 v37, v66, v67
    v_exp_f32 v69, v69
    v_exp_f32 v70, v70
    v_exp_f32 v71, v71
    v_cvt_pk_bf16_f32 v38, v68, v69
    v_cvt_pk_bf16_f32 v39, v70, v71
    s_nop 1
    v_mfma_f32_32x32x16_bf16 v[72:87], v[28:31], v[36:39], v[72:87]
    s_mov_b64 exec, s[48:49]
    ds_read_b128 v[24:27], v138 offset:5120
    ds_read_b128 v[28:31], v138 offset:6400
    s_mov_b64 exec, -1
    s_cmp_lt_u32 s50, 7
    s_cbranch_scc1 L_AT_TAIL7
    s_waitcnt lgkmcnt(2)
    v_mfma_f32_32x32x16_bf16 v[56:71], v[16:19], v[8:11], v[88:103]
    v_mfma_f32_32x32x16_bf16 v[56:71], v[20:23], v[12:15], v[56:71]
    ds_read_b128 v[16:19], v136 offset:0
    ds_read_b128 v[20:23], v137 offset:0
    v_exp_f32 v40, v40
    v_exp_f32 v41, v41
    v_exp_f32 v42, v42
    v_cvt_pk_bf16_f32 v32, v40, v41
    v_exp_f32 v43, v43
    v_exp_f32 v44, v44
    v_cvt_pk_bf16_f32 v33, v42, v43
    v_exp_f32 v45, v45
    v_exp_f32 v46, v46
    v_cvt_pk_bf16_f32 v34, v44, v45
    v_exp_f32 v47, v47
    v_exp_f32 v48, v48
    v_cvt_pk_bf16_f32 v35, v46, v47
    v_exp_f32 v49, v49
    v_exp_f32 v50, v50
    s_waitcnt lgkmcnt(2)
    v_mfma_f32_32x32x16_bf16 v[72:87], v[24:27], v[32:35], v[72:87]
    v_cvt_pk_bf16_f32 v36, v48, v49
    v_exp_f32 v51, v51
    v_exp_f32 v52, v52
    v_cvt_pk_bf16_f32 v37, v50, v51
    v_exp_f32 v53, v53
    v_exp_f32 v54, v54
    v_exp_f32 v55, v55
    v_cvt_pk_bf16_f32 v38, v52, v53
    v_cvt_pk_bf16_f32 v39, v54, v55
    s_nop 1
    v_mfma_f32_32x32x16_bf16 v[72:87], v[28:31], v[36:39], v[72:87]
    s_mov_b64 exec, s[48:49]
    ds_read_b128 v[24:27], v138 offset:2560
    ds_read_b128 v[28:31], v138 offset:3840
    s_mov_b64 exec, -1
    s_cmp_lt_u32 s50, 8
    s_cbranch_scc1 L_AT_TAIL8
    s_waitcnt lgkmcnt(2)
    v_mfma_f32_32x32x16_bf16 v[40:55], v[16:19], v[8:11], v[120:135]
    v_mfma_f32_32x32x16_bf16 v[40:55], v[20:23], v[12:15], v[40:55]
    v_exp_f32 v56, v56
    v_exp_f32 v57, v57
    v_exp_f32 v58, v58
    v_cvt_pk_bf16_f32 v32, v56, v57
    v_exp_f32 v59, v59
    v_exp_f32 v60, v60
    v_cvt_pk_bf16_f32 v33, v58, v59
    v_exp_f32 v61, v61
    v_exp_f32 v62, v62
    v_cvt_pk_bf16_f32 v34, v60, v61
    v_exp_f32 v63, v63
    v_exp_f32 v64, v64
    v_cvt_pk_bf16_f32 v35, v62, v63
    v_exp_f32 v65, v65
    v_exp_f32 v66, v66
    s_waitcnt lgkmcnt(0)
    v_mfma_f32_32x32x16_bf16 v[72:87], v[24:27], v[32:35], v[72:87]
    v_cvt_pk_bf16_f32 v36, v64, v65
    v_exp_f32 v67, v67
    v_exp_f32 v68, v68
    v_cvt_pk_bf16_f32 v37, v66, v67
    v_exp_f32 v69, v69
    v_exp_f32 v70, v70
    v_exp_f32 v71, v71
    v_cvt_pk_bf16_f32 v38, v68, v69
    v_cvt_pk_bf16_f32 v39, v70, v71
    s_nop 1
    v_mfma_f32_32x32x16_bf16 v[72:87], v[28:31], v[36:39], v[72:87]
    s_mov_b64 exec, s[48:49]
    ds_read_b128 v[24:27], v138 offset:0
    ds_read_b128 v[28:31], v138 offset:1280
    s_mov_b64 exec, -1
L_AT_TAIL3:
L_AT_TAIL5:
L_AT_TAIL7:
    v_exp_f32 v40, v40
    v_exp_f32 v41, v41
    v_exp_f32 v42, v42
    v_cvt_pk_bf16_f32 v32, v40, v41
    v_exp_f32 v43, v43
    v_exp_f32 v44, v44
    v_cvt_pk_bf16_f32 v33, v42, v43
    v_exp_f32 v45, v45
    v_exp_f32 v46, v46
    v_cvt_pk_bf16_f32 v34, v44, v45
    v_exp_f32 v47, v47
    v_exp_f32 v48, v48
    v_cvt_pk_bf16_f32 v35, v46, v47
    v_exp_f32 v49, v49
    v_exp_f32 v50, v50
    s_waitcnt lgkmcnt(0)
    v_mfma_f32_32x32x16_bf16 v[72:87], v[24:27], v[32:35], v[72:87]
    v_cvt_pk_bf16_f32 v36, v48, v49
    v_exp_f32 v51, v51
    v_exp_f32 v52, v52
    v_cvt_pk_bf16_f32 v37, v50, v51
    v_exp_f32 v53, v53
    v_exp_f32 v54, v54
    v_exp_f32 v55, v55
    v_cvt_pk_bf16_f32 v38, v52, v53
    v_cvt_pk_bf16_f32 v39, v54, v55
    s_nop 1
    v_mfma_f32_32x32x16_bf16 v[72:87], v[28:31], v[36:39], v[72:87]
    s_branch L_AT_DONE
L_AT_TAIL1:
    s_nop 7
    v_exp_f32 v40, v40
    v_exp_f32 v41, v41
    v_exp_f32 v42, v42
    v_cvt_pk_bf16_f32 v32, v40, v41
    v_exp_f32 v43, v43
    v_exp_f32 v44, v44
    v_cvt_pk_bf16_f32 v33, v42, v43
    v_exp_f32 v45, v45
    v_exp_f32 v46, v46
    v_cvt_pk_bf16_f32 v34, v44, v45
    v_exp_f32 v47, v47
    v_exp_f32 v48, v48
    v_cvt_pk_bf16_f32 v35, v46, v47
    v_exp_f32 v49, v49
    v_exp_f32 v50, v50
    s_waitcnt lgkmcnt(0)
    v_mfma_f32_32x32x16_bf16 v[72:87], v[24:27], v[32:35], 0
    v_cvt_pk_bf16_f32 v36, v48, v49
    v_exp_f32 v51, v51
    v_exp_f32 v52, v52
    v_cvt_pk_bf16_f32 v37, v50, v51
    v_exp_f32 v53, v53
    v_exp_f32 v54, v54
    v_exp_f32 v55, v55
    v_cvt_pk_bf16_f32 v38, v52, v53
    v_cvt_pk_bf16_f32 v39, v54, v55
    s_nop 1
    v_mfma_f32_32x32x16_bf16 v[72:87], v[28:31], v[36:39], v[72:87]
    s_branch L_AT_DONE
L_AT_TAIL2:
L_AT_TAIL4:
L_AT_TAIL6:
L_AT_TAIL8:
    v_exp_f32 v56, v56
    v_exp_f32 v57, v57
    v_exp_f32 v58, v58
    v_cvt_pk_bf16_f32 v32, v56, v57
    v_exp_f32 v59, v59
    v_exp_f32 v60, v60
    v_cvt_pk_bf16_f32 v33, v58, v59
    v_exp_f32 v61, v61
    v_exp_f32 v62, v62
    v_cvt_pk_bf16_f32 v34, v60, v61
    v_exp_f32 v63, v63
    v_exp_f32 v64, v64
    v_cvt_pk_bf16_f32 v35, v62, v63
    v_exp_f32 v65, v65
    v_exp_f32 v66, v66
    s_waitcnt lgkmcnt(0)
    v_mfma_f32_32x32x16_bf16 v[72:87], v[24:27], v[32:35], v[72:87]
    v_cvt_pk_bf16_f32 v36, v64, v65
    v_exp_f32 v67, v67
    v_exp_f32 v68, v68
    v_cvt_pk_bf16_f32 v37, v66, v67
    v_exp_f32 v69, v69
    v_exp_f32 v70, v70
    v_exp_f32 v71, v71
    v_cvt_pk_bf16_f32 v38, v68, v69
    v_cvt_pk_bf16_f32 v39, v70, v71
    s_nop 1
    v_mfma_f32_32x32x16_bf16 v[72:87], v[28:31], v[36:39], v[72:87]
L_AT_DONE:
    s_mov_b32 s52, 0x21800000
    s_mov_b32 s53, 0x5d800000
    s_nop 9
    v_cmp_le_f32 vcc, s52, v84
    v_cmp_ge_f32 s[54:55], s53, v84
    v_rcp_f32 v2, v84
    s_and_b64 vcc, vcc, s[54:55]
    s_cmp_eq_u64 vcc, -1
    s_cbranch_scc1 L_AT_OK
    s_cmp_lg_u32 s51, 0
    s_cbranch_scc1 L_AT_OK
    s_mov_b32 s51, 1
    s_mov_b32 s52, 0
    s_min_u32 s53, s50, 8
    v_mov_b32 v3, 0xf149f2ca
    v_add_u32 v4, 4096, v136
    v_add_u32 v5, 4096, v137
L_AT_MX:
    ds_read_b128 v[16:19], v4
    ds_read_b128 v[20:23], v5
    s_waitcnt lgkmcnt(0)
    s_cmp_eq_u32 s52, 0
    s_cbranch_scc1 L_AT_MXD
    s_cmp_eq_u32 s52, 8
    s_cbranch_scc1 L_AT_MXF
    v_mfma_f32_32x32x16_bf16 v[40:55], v[16:19], v[8:11], v[88:103]
    v_mfma_f32_32x32x16_bf16 v[40:55], v[20:23], v[12:15], v[40:55]
    s_branch L_AT_MXC
L_AT_MXD:
    v_mfma_f32_32x32x16_bf16 v[40:55], v[16:19], v[8:11], v[104:119]
    v_mfma_f32_32x32x16_bf16 v[40:55], v[20:23], v[12:15], v[40:55]
    s_branch L_AT_MXC
L_AT_MXF:
    v_mfma_f32_32x32x16_bf16 v[40:55], v[16:19], v[8:11], v[120:135]
    v_mfma_f32_32x32x16_bf16 v[40:55], v[20:23], v[12:15], v[40:55]
L_AT_MXC:
    s_nop 11
    v_max3_f32 v3, v3, v40, v41
    v_max3_f32 v3, v3, v42, v43
    v_max3_f32 v3, v3, v44, v45
    v_max3_f32 v3, v3, v46, v47
    v_max3_f32 v3, v3, v48, v49
    v_max3_f32 v3, v3, v50, v51
    v_max3_f32 v3, v3, v52, v53
    v_max3_f32 v3, v3, v54, v55
    v_subrev_u32 v4, 512, v4
    v_subrev_u32 v5, 512, v5
    s_add_u32 s52, s52, 1
    s_cmp_le_u32 s52, s53
    s_cbranch_scc1 L_AT_MX
    v_mov_b32 v4, v3
    s_nop 1
    v_permlane32_swap_b32 v3, v4
    v_max_f32 v3, v3, v4
    v_sub_f32 v88, v88, v3
    v_sub_f32 v89, v89, v3
    v_sub_f32 v90, v90, v3
    v_sub_f32 v91, v91, v3
    v_sub_f32 v92, v92, v3
    v_sub_f32 v93, v93, v3
    v_sub_f32 v94, v94, v3
    v_sub_f32 v95, v95, v3
    v_sub_f32 v96, v96, v3
    v_sub_f32 v97, v97, v3
    v_sub_f32 v98, v98, v3
    v_sub_f32 v99, v99, v3
    v_sub_f32 v100, v100, v3
    v_sub_f32 v101, v101, v3
    v_sub_f32 v102, v102, v3
    v_sub_f32 v103, v103, v3
    v_sub_f32 v104, v104, v3
    v_sub_f32 v105, v105, v3
    v_sub_f32 v106, v106, v3
    v_sub_f32 v107, v107, v3
    v_sub_f32 v108, v108, v3
    v_sub_f32 v109, v109, v3
    v_sub_f32 v110, v110, v3
    v_sub_f32 v111, v111, v3
    v_sub_f32 v112, v112, v3
    v_sub_f32 v113, v113, v3
    v_sub_f32 v114, v114, v3
    v_sub_f32 v115, v115, v3
    v_sub_f32 v116, v116, v3
    v_sub_f32 v117, v117, v3
    v_sub_f32 v118, v118, v3
    v_sub_f32 v119, v119, v3
    v_sub_f32 v120, v120, v3
    v_sub_f32 v121, v121, v3
    v_sub_f32 v122, v122, v3
    v_sub_f32 v123, v123, v3
    v_sub_f32 v124, v124, v3
    v_sub_f32 v125, v125, v3
    v_sub_f32 v126, v126, v3
    v_sub_f32 v127, v127, v3
    v_sub_f32 v128, v128, v3
    v_sub_f32 v129, v129, v3
    v_sub_f32 v130, v130, v3
    v_sub_f32 v131, v131, v3
    v_sub_f32 v132, v132, v3
    v_sub_f32 v133, v133, v3
    v_sub_f32 v134, v134, v3
    v_sub_f32 v135, v135, v3
    s_branch L_AT_START
L_AT_OK:
    s_cmp_ge_u32 s33, 4
    s_cbranch_scc1 L_AT_EPO
    buffer_load_dword v250, v245, s[16:19], s69 offen sc1
L_AT_EPO:
L_AT_NEP:
    v_mul_f32 v72, v72, v2
    v_mul_f32 v73, v73, v2
    v_mul_f32 v74, v74, v2
    v_mul_f32 v75, v75, v2
    v_mul_f32 v76, v76, v2
    v_mul_f32 v77, v77, v2
    v_mul_f32 v78, v78, v2
    v_mul_f32 v79, v79, v2
    v_mul_f32 v80, v80, v2
    v_mul_f32 v81, v81, v2
    v_mul_f32 v82, v82, v2
    v_mul_f32 v83, v83, v2
    v_cvt_pk_bf16_f32 v32, v72, v73
    v_cvt_pk_bf16_f32 v33, v74, v75
    v_cvt_pk_bf16_f32 v34, v76, v77
    v_cvt_pk_bf16_f32 v35, v78, v79
    v_cvt_pk_bf16_f32 v36, v80, v81
    v_cvt_pk_bf16_f32 v37, v82, v83
    s_lshl_b32 s52, s50, 5
    s_lshl_b32 s53, s37, 1
    s_add_u32 s52, s52, s53
    s_lshr_b32 s53, s33, 2
    s_add_u32 s52, s52, s53
    s_mul_i32 s54, s36, 163840
    s_mul_i32 s55, s37, 10240
    s_add_u32 s54, s54, s55
    s_mul_i32 s53, s53, 1280
    s_add_u32 s53, s53, s54
    s_mul_i32 s54, s42, 2560
    s_add_u32 s53, s53, s54
    s_add_u32 s53, s53, 0
    s_cmp_eq_u32 s70, 0
    s_cbranch_scc1 LS_4_S
    buffer_store_dwordx4 v[32:35], v139, s[20:23], s53 offen
    s_mov_b32 exec_hi, 0
    buffer_store_dwordx2 v[36:37], v140, s[20:23], s53 offen offset:1024
    s_mov_b64 exec, -1
LS_4_D:
    s_cmp_ge_u32 s33, 4
    s_cbranch_scc1 L_P3_K
    s_lshl_b32 s63, s52, 7
    s_add_u32 s63, s63, 262144
    s_movk_i32 s45, 0x5555
    s_mov_b32 s58, 50000
    s_lshl_b32 s43, s38, 2
    s_add_u32 s59, s43, s33
    s_mul_i32 s62, s59, 20480
    s_mul_i32 s43, s39, 160
    s_add_u32 s62, s62, s43
    s_lshl_b32 s56, s59, 11
    s_add_u32 s56, s56, 524288
    s_lshl_b32 s57, s39, 8
    s_add_u32 s57, s57, s56
    v_permlane16_swap_b32 v214, v216
    v_permlane16_swap_b32 v215, v217
    v_permlane16_swap_b32 v218, v220
    v_permlane16_swap_b32 v219, v221
    v_permlane16_swap_b32 v224, v226
    v_permlane16_swap_b32 v225, v227
    v_permlane16_swap_b32 v228, v230
    v_permlane16_swap_b32 v229, v231
    v_lshlrev_b32 v88, 16, v214
    v_and_b32 v89, 0xffff0000, v214
    v_lshlrev_b32 v90, 16, v215
    v_and_b32 v91, 0xffff0000, v215
    v_lshlrev_b32 v92, 16, v216
    v_and_b32 v93, 0xffff0000, v216
    v_lshlrev_b32 v94, 16, v217
    v_and_b32 v95, 0xffff0000, v217
    v_lshlrev_b32 v96, 16, v218
    v_and_b32 v97, 0xffff0000, v218
    v_lshlrev_b32 v98, 16, v219
    v_and_b32 v99, 0xffff0000, v219
    v_lshlrev_b32 v100, 16, v220
    v_and_b32 v101, 0xffff0000, v220
    v_lshlrev_b32 v102, 16, v221
    v_and_b32 v103, 0xffff0000, v221
    v_lshlrev_b32 v104, 16, v222
    v_and_b32 v105, 0xffff0000, v222
    v_lshlrev_b32 v106, 16, v223
    v_and_b32 v107, 0xffff0000, v223
    v_dot2_f32_bf16 v243, v234, v244, 0
    v_dot2_f32_bf16 v243, v235, v244, v243
    v_dot2_f32_bf16 v243, v236, v244, v243
    v_dot2_f32_bf16 v243, v237, v244, v243
    v_dot2_f32_bf16 v243, v238, v244, v243
    s_nop 2
    v_add_f32_dpp v243, v243, v243 row_ror:8 row_mask:0xf bank_mask:0xf
    s_nop 1
    v_add_f32_dpp v243, v243, v243 row_ror:4 row_mask:0xf bank_mask:0xf
    s_nop 1
    v_add_f32_dpp v243, v243, v243 row_ror:2 row_mask:0xf bank_mask:0xf
    s_nop 1
    v_add_f32_dpp v243, v243, v243 row_ror:1 row_mask:0xf bank_mask:0xf
    v_mov_b32 v2, v243
    s_nop 1
    v_permlane16_swap_b32 v243, v2
    v_add_f32 v243, v243, v2
    v_mov_b32 v2, v243
    s_nop 1
    v_permlane32_swap_b32 v243, v2
    v_add_f32 v243, v243, v2
    s_waitcnt vmcnt(0)
    s_mov_b64 exec, 1
    s_cmp_eq_u32 s70, 0
    s_cbranch_scc1 LS_5_S
    buffer_store_dword v251, v252, s[16:19], s63 offen
LS_5_D:
    s_mov_b64 exec, -1
    s_barrier
    v_cmp_eq_u32 vcc, s32, v250
    s_lshr_b32 s44, vcc_lo, 1
    s_and_b32 s44, s44, vcc_lo
    s_and_b32 s44, s44, s45
    s_cmp_eq_u32 s44, 0
    s_cbranch_scc1 L_DY_ST0
L_DY_TK0:
    s_ff1_i32_b32 s3, s44
    s_bitset0_b32 s44, s3
    s_bitset0_b32 s45, s3
    s_mul_i32 s48, s3, 3200
    s_mul_i32 s3, s3, 5120
    s_add_u32 s3, s3, s68
    buffer_load_dwordx4 v[8:11], v170, s[20:23], s3 offen sc1
    buffer_load_dwordx4 v[12:15], v171, s[20:23], s3 offen sc1
    s_cmp_eq_u32 s44, 0
    s_cbranch_scc1 L_DY_ST1
L_DY_TK1:
    s_ff1_i32_b32 s3, s44
    s_bitset0_b32 s44, s3
    s_bitset0_b32 s45, s3
    s_mul_i32 s49, s3, 3200
    s_mul_i32 s3, s3, 5120
    s_add_u32 s3, s3, s68
    buffer_load_dwordx4 v[16:19], v170, s[20:23], s3 offen sc1
    buffer_load_dwordx4 v[20:23], v171, s[20:23], s3 offen sc1
    v_add_u32 v253, s48, v168
    v_add_u32 v254, s49, v168
    v_mov_b32 v2, 0
    ds_write_b32 v174, v2 offset:5120
    ds_read_b64_tr_b16 v[128:129], v253 offset:0
    ds_read_b64_tr_b16 v[130:131], v253 offset:1280
    ds_read_b64_tr_b16 v[132:133], v253 offset:32
    ds_read_b64_tr_b16 v[134:135], v253 offset:1312
    ds_read_b64_tr_b16 v[136:137], v253 offset:64
    ds_read_b64_tr_b16 v[138:139], v253 offset:1344
    ds_read_b64_tr_b16 v[140:141], v253 offset:96
    ds_read_b64_tr_b16 v[142:143], v253 offset:1376
    ds_read_b64_tr_b16 v[144:145], v253 offset:128
    ds_read_b64_tr_b16 v[146:147], v253 offset:1408
    ds_read_b64_tr_b16 v[148:149], v254 offset:0
    ds_read_b64_tr_b16 v[150:151], v254 offset:1280
    ds_read_b64_tr_b16 v[152:153], v254 offset:32
    ds_read_b64_tr_b16 v[154:155], v254 offset:1312
    ds_read_b64_tr_b16 v[156:157], v254 offset:64
    ds_read_b64_tr_b16 v[158:159], v254 offset:1344
    ds_read_b64_tr_b16 v[160:161], v254 offset:96
    ds_read_b64_tr_b16 v[162:163], v254 offset:1376
    ds_read_b64_tr_b16 v[164:165], v254 offset:128
    ds_read_b64_tr_b16 v[166:167], v254 offset:1408
    s_cmp_eq_u32 s44, 0
    s_cbranch_scc1 L_DY_ST2
L_DY_TK2:
    s_ff1_i32_b32 s3, s44
    s_bitset0_b32 s44, s3
    s_bitset0_b32 s45, s3
    s_mul_i32 s50, s3, 3200
    s_mul_i32 s3, s3, 5120
    s_add_u32 s3, s3, s68
    buffer_load_dwordx4 v[24:27], v170, s[20:23], s3 offen sc1
    buffer_load_dwordx4 v[28:31], v171, s[20:23], s3 offen sc1
    s_cmp_eq_u32 s44, 0
    s_cbranch_scc1 L_DY_ST3
L_DY_TK3:
    s_ff1_i32_b32 s3, s44
    s_bitset0_b32 s44, s3
    s_bitset0_b32 s45, s3
    s_mul_i32 s51, s3, 3200
    s_mul_i32 s3, s3, 5120
    s_add_u32 s3, s3, s68
    buffer_load_dwordx4 v[32:35], v170, s[20:23], s3 offen sc1
    buffer_load_dwordx4 v[36:39], v171, s[20:23], s3 offen sc1
    s_waitcnt vmcnt(6) lgkmcnt(14)
    v_add_u32 v253, s50, v168
    v_mfma_f32_16x16x32_bf16 v[88:91], v[128:131], v[8:11], v[88:91]
    v_mfma_f32_16x16x32_bf16 v[108:111], v[128:131], v[12:15], 0
    ds_read_b64_tr_b16 v[128:129], v253 offset:0
    ds_read_b64_tr_b16 v[130:131], v253 offset:1280
    s_cmp_eq_u32 s44, 0
    s_cbranch_scc1 L_DY_ST4
L_DY_TK4:
    s_ff1_i32_b32 s3, s44
    s_bitset0_b32 s44, s3
    s_bitset0_b32 s45, s3
    s_mul_i32 s52, s3, 3200
    s_mul_i32 s3, s3, 5120
    s_add_u32 s3, s3, s68
    buffer_load_dwordx4 v[40:43], v170, s[20:23], s3 offen sc1
    buffer_load_dwordx4 v[44:47], v171, s[20:23], s3 offen sc1
    s_waitcnt lgkmcnt(14)
    v_mfma_f32_16x16x32_bf16 v[92:95], v[132:135], v[8:11], v[92:95]
    v_mfma_f32_16x16x32_bf16 v[112:115], v[132:135], v[12:15], 0
    ds_read_b64_tr_b16 v[132:133], v253 offset:32
    ds_read_b64_tr_b16 v[134:135], v253 offset:1312
    s_waitcnt lgkmcnt(14)
    v_mfma_f32_16x16x32_bf16 v[96:99], v[136:139], v[8:11], v[96:99]
    v_mfma_f32_16x16x32_bf16 v[116:119], v[136:139], v[12:15], 0
    ds_read_b64_tr_b16 v[136:137], v253 offset:64
    ds_read_b64_tr_b16 v[138:139], v253 offset:1344
    s_cmp_eq_u32 s44, 0
    s_cbranch_scc1 L_DY_ST5
L_DY_TK5:
    s_ff1_i32_b32 s3, s44
    s_bitset0_b32 s44, s3
    s_bitset0_b32 s45, s3
    s_mul_i32 s53, s3, 3200
    s_mul_i32 s3, s3, 5120
    s_add_u32 s3, s3, s68
    buffer_load_dwordx4 v[48:51], v170, s[20:23], s3 offen sc1
    buffer_load_dwordx4 v[52:55], v171, s[20:23], s3 offen sc1
    s_waitcnt lgkmcnt(14)
    v_mfma_f32_16x16x32_bf16 v[100:103], v[140:143], v[8:11], v[100:103]
    v_mfma_f32_16x16x32_bf16 v[120:123], v[140:143], v[12:15], 0
    ds_read_b64_tr_b16 v[140:141], v253 offset:96
    ds_read_b64_tr_b16 v[142:143], v253 offset:1376
    s_waitcnt lgkmcnt(14)
    v_mfma_f32_16x16x32_bf16 v[104:107], v[144:147], v[8:11], v[104:107]
    v_mfma_f32_16x16x32_bf16 v[124:127], v[144:147], v[12:15], 0
    ds_read_b64_tr_b16 v[144:145], v253 offset:128
    ds_read_b64_tr_b16 v[146:147], v253 offset:1408
    s_waitcnt vmcnt(8) lgkmcnt(14)
    v_add_u32 v254, s51, v168
    v_mfma_f32_16x16x32_bf16 v[88:91], v[148:151], v[16:19], v[88:91]
    v_mfma_f32_16x16x32_bf16 v[108:111], v[148:151], v[20:23], v[108:111]
    ds_read_b64_tr_b16 v[148:149], v254 offset:0
    ds_read_b64_tr_b16 v[150:151], v254 offset:1280
    s_cmp_eq_u32 s44, 0
    s_cbranch_scc1 L_DY_ST6
L_DY_TK6:
    s_ff1_i32_b32 s3, s44
    s_bitset0_b32 s44, s3
    s_bitset0_b32 s45, s3
    s_mul_i32 s54, s3, 3200
    s_mul_i32 s3, s3, 5120
    s_add_u32 s3, s3, s68
    buffer_load_dwordx4 v[56:59], v170, s[20:23], s3 offen sc1
    buffer_load_dwordx4 v[60:63], v171, s[20:23], s3 offen sc1
    s_waitcnt lgkmcnt(14)
    v_mfma_f32_16x16x32_bf16 v[92:95], v[152:155], v[16:19], v[92:95]
    v_mfma_f32_16x16x32_bf16 v[112:115], v[152:155], v[20:23], v[112:115]
    ds_read_b64_tr_b16 v[152:153], v254 offset:32
    ds_read_b64_tr_b16 v[154:155], v254 offset:1312
    s_waitcnt lgkmcnt(14)
    v_mfma_f32_16x16x32_bf16 v[96:99], v[156:159], v[16:19], v[96:99]
    v_mfma_f32_16x16x32_bf16 v[116:119], v[156:159], v[20:23], v[116:119]
    ds_read_b64_tr_b16 v[156:157], v254 offset:64
    ds_read_b64_tr_b16 v[158:159], v254 offset:1344
    s_cmp_eq_u32 s44, 0
    s_cbranch_scc1 L_DY_ST7
L_DY_TK7:
    s_ff1_i32_b32 s3, s44
    s_bitset0_b32 s44, s3
    s_bitset0_b32 s45, s3
    s_mul_i32 s55, s3, 3200
    s_mul_i32 s3, s3, 5120
    s_add_u32 s3, s3, s68
    buffer_load_dwordx4 v[64:67], v170, s[20:23], s3 offen sc1
    buffer_load_dwordx4 v[68:71], v171, s[20:23], s3 offen sc1
    s_waitcnt lgkmcnt(14)
    v_mfma_f32_16x16x32_bf16 v[100:103], v[160:163], v[16:19], v[100:103]
    v_mfma_f32_16x16x32_bf16 v[120:123], v[160:163], v[20:23], v[120:123]
    ds_read_b64_tr_b16 v[160:161], v254 offset:96
    ds_read_b64_tr_b16 v[162:163], v254 offset:1376
    s_waitcnt lgkmcnt(14)
    v_mfma_f32_16x16x32_bf16 v[104:107], v[164:167], v[16:19], v[104:107]
    v_mfma_f32_16x16x32_bf16 v[124:127], v[164:167], v[20:23], v[124:127]
    ds_read_b64_tr_b16 v[164:165], v254 offset:128
    ds_read_b64_tr_b16 v[166:167], v254 offset:1408
    s_waitcnt vmcnt(10) lgkmcnt(14)
    v_add_u32 v253, s52, v168
    v_mfma_f32_16x16x32_bf16 v[88:91], v[128:131], v[24:27], v[88:91]
    v_mfma_f32_16x16x32_bf16 v[108:111], v[128:131], v[28:31], v[108:111]
    ds_read_b64_tr_b16 v[128:129], v253 offset:0
    ds_read_b64_tr_b16 v[130:131], v253 offset:1280
    buffer_load_dwordx2 v[72:73], v172, s[20:23], s68 offen offset:1024 sc1
    buffer_load_dwordx2 v[76:77], v173, s[20:23], s68 offen offset:1024 sc1
    s_waitcnt lgkmcnt(14)
    v_mfma_f32_16x16x32_bf16 v[92:95], v[132:135], v[24:27], v[92:95]
    v_mfma_f32_16x16x32_bf16 v[112:115], v[132:135], v[28:31], v[112:115]
    ds_read_b64_tr_b16 v[132:133], v253 offset:32
    ds_read_b64_tr_b16 v[134:135], v253 offset:1312
    s_waitcnt lgkmcnt(14)
    v_mfma_f32_16x16x32_bf16 v[96:99], v[136:139], v[24:27], v[96:99]
    v_mfma_f32_16x16x32_bf16 v[116:119], v[136:139], v[28:31], v[116:119]
    ds_read_b64_tr_b16 v[136:137], v253 offset:64
    ds_read_b64_tr_b16 v[138:139], v253 offset:1344
    s_add_u32 s3, s68, 10240
    buffer_load_dwordx2 v[74:75], v172, s[20:23], s3 offen offset:1024 sc1
    buffer_load_dwordx2 v[78:79], v173, s[20:23], s3 offen offset:1024 sc1
    s_waitcnt lgkmcnt(14)
    v_mfma_f32_16x16x32_bf16 v[100:103], v[140:143], v[24:27], v[100:103]
    v_mfma_f32_16x16x32_bf16 v[120:123], v[140:143], v[28:31], v[120:123]
    ds_read_b64_tr_b16 v[140:141], v253 offset:96
    ds_read_b64_tr_b16 v[142:143], v253 offset:1376
    s_waitcnt lgkmcnt(14)
    v_mfma_f32_16x16x32_bf16 v[104:107], v[144:147], v[24:27], v[104:107]
    v_mfma_f32_16x16x32_bf16 v[124:127], v[144:147], v[28:31], v[124:127]
    ds_read_b64_tr_b16 v[144:145], v253 offset:128
    ds_read_b64_tr_b16 v[146:147], v253 offset:1408
    s_waitcnt vmcnt(12) lgkmcnt(14)
    v_add_u32 v254, s53, v168
    v_mfma_f32_16x16x32_bf16 v[88:91], v[148:151], v[32:35], v[88:91]
    v_mfma_f32_16x16x32_bf16 v[108:111], v[148:151], v[36:39], v[108:111]
    ds_read_b64_tr_b16 v[148:149], v254 offset:0
    ds_read_b64_tr_b16 v[150:151], v254 offset:1280
    s_add_u32 s3, s68, 40960
    buffer_load_dwordx2 v[80:81], v172, s[20:23], s3 offen offset:1024 sc1
    buffer_load_dwordx2 v[84:85], v173, s[20:23], s3 offen offset:1024 sc1
    s_waitcnt lgkmcnt(14)
    v_mfma_f32_16x16x32_bf16 v[92:95], v[152:155], v[32:35], v[92:95]
    v_mfma_f32_16x16x32_bf16 v[112:115], v[152:155], v[36:39], v[112:115]
    ds_read_b64_tr_b16 v[152:153], v254 offset:32
    ds_read_b64_tr_b16 v[154:155], v254 offset:1312
    s_waitcnt lgkmcnt(14)
    v_mfma_f32_16x16x32_bf16 v[96:99], v[156:159], v[32:35], v[96:99]
    v_mfma_f32_16x16x32_bf16 v[116:119], v[156:159], v[36:39], v[116:119]
    ds_read_b64_tr_b16 v[156:157], v254 offset:64
    ds_read_b64_tr_b16 v[158:159], v254 offset:1344
    s_add_u32 s3, s68, 51200
    buffer_load_dwordx2 v[82:83], v172, s[20:23], s3 offen offset:1024 sc1
    buffer_load_dwordx2 v[86:87], v173, s[20:23], s3 offen offset:1024 sc1
    s_barrier
    s_waitcnt lgkmcnt(14)
    v_mfma_f32_16x16x32_bf16 v[100:103], v[160:163], v[32:35], v[100:103]
    v_mfma_f32_16x16x32_bf16 v[120:123], v[160:163], v[36:39], v[120:123]
    ds_read_b64_tr_b16 v[160:161], v254 offset:96
    ds_read_b64_tr_b16 v[162:163], v254 offset:1376
    s_waitcnt lgkmcnt(14)
    v_mfma_f32_16x16x32_bf16 v[104:107], v[164:167], v[32:35], v[104:107]
    v_mfma_f32_16x16x32_bf16 v[124:127], v[164:167], v[36:39], v[124:127]
    ds_read_b64_tr_b16 v[164:165], v254 offset:128
    ds_read_b64_tr_b16 v[166:167], v254 offset:1408
    s_waitcnt vmcnt(14) lgkmcnt(14)
    v_add_u32 v253, s54, v168
    v_mfma_f32_16x16x32_bf16 v[88:91], v[128:131], v[40:43], v[88:91]
    v_mfma_f32_16x16x32_bf16 v[108:111], v[128:131], v[44:47], v[108:111]
    ds_read_b64_tr_b16 v[128:129], v253 offset:0
    ds_read_b64_tr_b16 v[130:131], v253 offset:1280
    s_waitcnt lgkmcnt(14)
    v_mfma_f32_16x16x32_bf16 v[92:95], v[132:135], v[40:43], v[92:95]
    v_mfma_f32_16x16x32_bf16 v[112:115], v[132:135], v[44:47], v[112:115]
    ds_read_b64_tr_b16 v[132:133], v253 offset:32
    ds_read_b64_tr_b16 v[134:135], v253 offset:1312
    s_waitcnt lgkmcnt(14)
    v_mfma_f32_16x16x32_bf16 v[96:99], v[136:139], v[40:43], v[96:99]
    v_mfma_f32_16x16x32_bf16 v[116:119], v[136:139], v[44:47], v[116:119]
    ds_read_b64_tr_b16 v[136:137], v253 offset:64
    ds_read_b64_tr_b16 v[138:139], v253 offset:1344
    s_waitcnt lgkmcnt(14)
    v_mfma_f32_16x16x32_bf16 v[100:103], v[140:143], v[40:43], v[100:103]
    v_mfma_f32_16x16x32_bf16 v[120:123], v[140:143], v[44:47], v[120:123]
    ds_read_b64_tr_b16 v[140:141], v253 offset:96
    ds_read_b64_tr_b16 v[142:143], v253 offset:1376
    s_waitcnt lgkmcnt(14)
    v_mfma_f32_16x16x32_bf16 v[104:107], v[144:147], v[40:43], v[104:107]
    v_mfma_f32_16x16x32_bf16 v[124:127], v[144:147], v[44:47], v[124:127]
    ds_read_b64_tr_b16 v[144:145], v253 offset:128
    ds_read_b64_tr_b16 v[146:147], v253 offset:1408
    s_waitcnt vmcnt(12) lgkmcnt(14)
    v_add_u32 v254, s55, v168
    v_mfma_f32_16x16x32_bf16 v[88:91], v[148:151], v[48:51], v[88:91]
    v_mfma_f32_16x16x32_bf16 v[108:111], v[148:151], v[52:55], v[108:111]
    ds_read_b64_tr_b16 v[148:149], v254 offset:0
    ds_read_b64_tr_b16 v[150:151], v254 offset:1280
    s_waitcnt lgkmcnt(14)
    v_mfma_f32_16x16x32_bf16 v[92:95], v[152:155], v[48:51], v[92:95]
    v_mfma_f32_16x16x32_bf16 v[112:115], v[152:155], v[52:55], v[112:115]
    ds_read_b64_tr_b16 v[152:153], v254 offset:32
    ds_read_b64_tr_b16 v[154:155], v254 offset:1312
    s_waitcnt lgkmcnt(14)
    v_mfma_f32_16x16x32_bf16 v[96:99], v[156:159], v[48:51], v[96:99]
    v_mfma_f32_16x16x32_bf16 v[116:119], v[156:159], v[52:55], v[116:119]
    ds_read_b64_tr_b16 v[156:157], v254 offset:64
    ds_read_b64_tr_b16 v[158:159], v254 offset:1344
    s_waitcnt lgkmcnt(14)
    v_mfma_f32_16x16x32_bf16 v[100:103], v[160:163], v[48:51], v[100:103]
    v_mfma_f32_16x16x32_bf16 v[120:123], v[160:163], v[52:55], v[120:123]
    ds_read_b64_tr_b16 v[160:161], v254 offset:96
    ds_read_b64_tr_b16 v[162:163], v254 offset:1376
    s_waitcnt lgkmcnt(14)
    v_mfma_f32_16x16x32_bf16 v[104:107], v[164:167], v[48:51], v[104:107]
    v_mfma_f32_16x16x32_bf16 v[124:127], v[164:167], v[52:55], v[124:127]
    ds_read_b64_tr_b16 v[164:165], v254 offset:128
    ds_read_b64_tr_b16 v[166:167], v254 offset:1408
    s_waitcnt vmcnt(10) lgkmcnt(14)
    v_mfma_f32_16x16x32_bf16 v[88:91], v[128:131], v[56:59], v[88:91]
    v_mfma_f32_16x16x32_bf16 v[108:111], v[128:131], v[60:63], v[108:111]
    ds_read_b64_tr_b16 v[128:129], v169 offset:0
    ds_read_b64_tr_b16 v[130:131], v169 offset:6400
    s_waitcnt lgkmcnt(14)
    v_mfma_f32_16x16x32_bf16 v[92:95], v[132:135], v[56:59], v[92:95]
    v_mfma_f32_16x16x32_bf16 v[112:115], v[132:135], v[60:63], v[112:115]
    ds_read_b64_tr_b16 v[132:133], v169 offset:32
    ds_read_b64_tr_b16 v[134:135], v169 offset:6432
    s_waitcnt lgkmcnt(14)
    v_mfma_f32_16x16x32_bf16 v[96:99], v[136:139], v[56:59], v[96:99]
    v_mfma_f32_16x16x32_bf16 v[116:119], v[136:139], v[60:63], v[116:119]
    ds_read_b64_tr_b16 v[136:137], v169 offset:64
    ds_read_b64_tr_b16 v[138:139], v169 offset:6464
    s_waitcnt lgkmcnt(14)
    v_mfma_f32_16x16x32_bf16 v[100:103], v[140:143], v[56:59], v[100:103]
    v_mfma_f32_16x16x32_bf16 v[120:123], v[140:143], v[60:63], v[120:123]
    ds_read_b64_tr_b16 v[140:141], v169 offset:96
    ds_read_b64_tr_b16 v[142:143], v169 offset:6496
    s_waitcnt lgkmcnt(14)
    v_mfma_f32_16x16x32_bf16 v[104:107], v[144:147], v[56:59], v[104:107]
    v_mfma_f32_16x16x32_bf16 v[124:127], v[144:147], v[60:63], v[124:127]
    ds_read_b64_tr_b16 v[144:145], v169 offset:128
    ds_read_b64_tr_b16 v[146:147], v169 offset:6528
    s_waitcnt vmcnt(8) lgkmcnt(14)
    v_mfma_f32_16x16x32_bf16 v[88:91], v[148:151], v[64:67], v[88:91]
    v_mfma_f32_16x16x32_bf16 v[108:111], v[148:151], v[68:71], v[108:111]
    ds_read_b64_tr_b16 v[148:149], v169 offset:25600
    ds_read_b64_tr_b16 v[150:151], v169 offset:32000
    s_waitcnt lgkmcnt(14)
    v_mfma_f32_16x16x32_bf16 v[92:95], v[152:155], v[64:67], v[92:95]
    v_mfma_f32_16x16x32_bf16 v[112:115], v[152:155], v[68:71], v[112:115]
    ds_read_b64_tr_b16 v[152:153], v169 offset:25632
    ds_read_b64_tr_b16 v[154:155], v169 offset:32032
    s_waitcnt lgkmcnt(14)
    v_mfma_f32_16x16x32_bf16 v[96:99], v[156:159], v[64:67], v[96:99]
    v_mfma_f32_16x16x32_bf16 v[116:119], v[156:159], v[68:71], v[116:119]
    ds_read_b64_tr_b16 v[156:157], v169 offset:25664
    ds_read_b64_tr_b16 v[158:159], v169 offset:32064
    s_waitcnt lgkmcnt(14)
    v_mfma_f32_16x16x32_bf16 v[100:103], v[160:163], v[64:67], v[100:103]
    v_mfma_f32_16x16x32_bf16 v[120:123], v[160:163], v[68:71], v[120:123]
    ds_read_b64_tr_b16 v[160:161], v169 offset:25696
    ds_read_b64_tr_b16 v[162:163], v169 offset:32096
    s_waitcnt lgkmcnt(14)
    v_mfma_f32_16x16x32_bf16 v[104:107], v[164:167], v[64:67], v[104:107]
    v_mfma_f32_16x16x32_bf16 v[124:127], v[164:167], v[68:71], v[124:127]
    ds_read_b64_tr_b16 v[164:165], v169 offset:25728
    ds_read_b64_tr_b16 v[166:167], v169 offset:32128
    s_waitcnt vmcnt(4) lgkmcnt(14)
    v_mfma_f32_16x16x32_bf16 v[88:91], v[128:131], v[72:75], v[88:91]
    v_mfma_f32_16x16x32_bf16 v[108:111], v[128:131], v[76:79], v[108:111]
    s_waitcnt lgkmcnt(14)
    v_mfma_f32_16x16x32_bf16 v[92:95], v[132:135], v[72:75], v[92:95]
    v_mfma_f32_16x16x32_bf16 v[112:115], v[132:135], v[76:79], v[112:115]
    s_waitcnt lgkmcnt(14)
    v_mfma_f32_16x16x32_bf16 v[96:99], v[136:139], v[72:75], v[96:99]
    v_mfma_f32_16x16x32_bf16 v[116:119], v[136:139], v[76:79], v[116:119]
    s_waitcnt lgkmcnt(12)
    v_mfma_f32_16x16x32_bf16 v[100:103], v[140:143], v[72:75], v[100:103]
    v_mfma_f32_16x16x32_bf16 v[120:123], v[140:143], v[76:79], v[120:123]
    s_waitcnt lgkmcnt(10)
    v_mfma_f32_16x16x32_bf16 v[104:107], v[144:147], v[72:75], v[104:107]
    v_mfma_f32_16x16x32_bf16 v[124:127], v[144:147], v[76:79], v[124:127]
    s_waitcnt vmcnt(0) lgkmcnt(0)
    v_mfma_f32_16x16x32_bf16 v[108:111], v[148:151], v[84:87], v[108:111]
    v_mfma_f32_16x16x32_bf16 v[112:115], v[152:155], v[84:87], v[112:115]
    v_mfma_f32_16x16x32_bf16 v[116:119], v[156:159], v[84:87], v[116:119]
    v_mfma_f32_16x16x32_bf16 v[120:123], v[160:163], v[84:87], v[120:123]
    v_mfma_f32_16x16x32_bf16 v[124:127], v[164:167], v[84:87], v[124:127]
    v_mfma_f32_16x16x32_bf16 v[88:91], v[148:151], v[80:83], v[88:91]
    v_mfma_f32_16x16x32_bf16 v[92:95], v[152:155], v[80:83], v[92:95]
    s_nop 1
    ds_write_b128 v174, v[108:111] offset:0
    v_mfma_f32_16x16x32_bf16 v[96:99], v[156:159], v[80:83], v[96:99]
    ds_write_b128 v174, v[112:115] offset:1024
    v_mfma_f32_16x16x32_bf16 v[100:103], v[160:163], v[80:83], v[100:103]
    ds_write_b128 v174, v[116:119] offset:2048
    v_mfma_f32_16x16x32_bf16 v[104:107], v[164:167], v[80:83], v[104:107]
    ds_write_b128 v174, v[120:123] offset:3072
    ds_write_b128 v174, v[124:127] offset:4096
    ds_write_b32 v174, v244 offset:5120
    s_mov_b32 s58, 50000
L_PR:
    ds_read_b32 v2, v175 offset:5120
    ds_read_b128 v[108:111], v175 offset:0
    ds_read_b128 v[112:115], v175 offset:1024
    ds_read_b128 v[116:119], v175 offset:2048
    ds_read_b128 v[120:123], v175 offset:3072
    ds_read_b128 v[124:127], v175 offset:4096
    s_waitcnt lgkmcnt(5)
    v_cmp_eq_u32 vcc, 0, v2
    s_cbranch_vccz L_PR_OK
    s_sub_u32 s58, s58, 1
    s_cmp_lg_u32 s58, 0
    s_cbranch_scc1 L_PR
L_PR_OK:
    v_mov_b32 v43, s32
    s_waitcnt lgkmcnt(4)
    v_pk_add_f32 v[88:89], v[88:89], v[108:109]
    v_pk_add_f32 v[90:91], v[90:91], v[110:111]
    v_cvt_pk_bf16_f32 v8, v88, v89
    v_cvt_pk_bf16_f32 v9, v90, v91
    s_waitcnt lgkmcnt(3)
    v_pk_add_f32 v[92:93], v[92:93], v[112:113]
    v_pk_add_f32 v[94:95], v[94:95], v[114:115]
    v_cvt_pk_bf16_f32 v10, v92, v93
    v_cvt_pk_bf16_f32 v11, v94, v95
    s_waitcnt lgkmcnt(2)
    v_pk_add_f32 v[96:97], v[96:97], v[116:117]
    v_pk_add_f32 v[98:99], v[98:99], v[118:119]
    v_cvt_pk_bf16_f32 v12, v96, v97
    v_cvt_pk_bf16_f32 v13, v98, v99
    s_waitcnt lgkmcnt(1)
    v_pk_add_f32 v[100:101], v[100:101], v[120:121]
    v_pk_add_f32 v[102:103], v[102:103], v[122:123]
    v_cvt_pk_bf16_f32 v14, v100, v101
    v_cvt_pk_bf16_f32 v15, v102, v103
    s_waitcnt lgkmcnt(0)
    v_pk_add_f32 v[104:105], v[104:105], v[124:125]
    v_pk_add_f32 v[106:107], v[106:107], v[126:127]
    v_cvt_pk_bf16_f32 v16, v104, v105
    v_cvt_pk_bf16_f32 v17, v106, v107
    v_dot2_f32_bf16 v40, v8, v244, 0
    v_dot2_f32_bf16 v41, v8, v8, 0
    v_dot2_f32_bf16 v42, v8, v224, 0
    v_dot2_f32_bf16 v40, v9, v244, v40
    v_dot2_f32_bf16 v41, v9, v9, v41
    v_dot2_f32_bf16 v42, v9, v225, v42
    v_dot2_f32_bf16 v40, v10, v244, v40
    v_dot2_f32_bf16 v41, v10, v10, v41
    v_dot2_f32_bf16 v42, v10, v226, v42
    v_dot2_f32_bf16 v40, v11, v244, v40
    v_dot2_f32_bf16 v41, v11, v11, v41
    v_dot2_f32_bf16 v42, v11, v227, v42
    v_dot2_f32_bf16 v40, v12, v244, v40
    v_dot2_f32_bf16 v41, v12, v12, v41
    v_dot2_f32_bf16 v42, v12, v228, v42
    v_dot2_f32_bf16 v40, v13, v244, v40
    v_dot2_f32_bf16 v41, v13, v13, v41
    v_dot2_f32_bf16 v42, v13, v229, v42
    v_dot2_f32_bf16 v40, v14, v244, v40
    v_dot2_f32_bf16 v41, v14, v14, v41
    v_dot2_f32_bf16 v42, v14, v230, v42
    v_dot2_f32_bf16 v40, v15, v244, v40
    v_dot2_f32_bf16 v41, v15, v15, v41
    v_dot2_f32_bf16 v42, v15, v231, v42
    v_dot2_f32_bf16 v40, v16, v244, v40
    v_dot2_f32_bf16 v41, v16, v16, v41
    v_dot2_f32_bf16 v42, v16, v232, v42
    v_dot2_f32_bf16 v40, v17, v244, v40
    v_dot2_f32_bf16 v41, v17, v17, v41
    v_dot2_f32_bf16 v42, v17, v233, v42
    s_nop 0
    v_mov_b32 v2, v40
    v_mov_b32 v3, v41
    v_mov_b32 v4, v42
    v_permlane32_swap_b32 v40, v2
    v_permlane32_swap_b32 v41, v3
    v_permlane32_swap_b32 v42, v4
    v_add_f32 v40, v40, v2
    v_add_f32 v41, v41, v3
    v_add_f32 v42, v42, v4
    v_mov_b32 v2, v40
    v_mov_b32 v3, v41
    v_mov_b32 v4, v42
    v_permlane16_swap_b32 v40, v2
    v_permlane16_swap_b32 v41, v3
    v_permlane16_swap_b32 v42, v4
    v_add_f32 v40, v40, v2
    v_add_f32 v41, v41, v3
    v_add_f32 v42, v42, v4
    s_mov_b64 exec, 0xffff
    s_cmp_eq_u32 s70, 0
    s_cbranch_scc1 LS_6_S
    buffer_store_dwordx4 v[40:43], v242, s[16:19], s57 offen
LS_6_D:
    s_mov_b64 exec, -1
    buffer_load_dwordx4 v[44:47], v242, s[16:19], s56 offen sc1
    buffer_load_dwordx4 v[48:51], v242, s[16:19], s56 offen offset:1024 sc1
    v_permlane16_swap_b32 v8, v10
    v_permlane16_swap_b32 v9, v11
    v_permlane16_swap_b32 v12, v14
    v_permlane16_swap_b32 v13, v15
    v_lshlrev_b32 v20, 16, v8
    v_and_b32 v21, 0xffff0000, v8
    v_lshlrev_b32 v22, 16, v9
    v_and_b32 v23, 0xffff0000, v9
    v_lshlrev_b32 v24, 16, v10
    v_and_b32 v25, 0xffff0000, v10
    v_lshlrev_b32 v26, 16, v11
    v_and_b32 v27, 0xffff0000, v11
    v_lshlrev_b32 v28, 16, v12
    v_and_b32 v29, 0xffff0000, v12
    v_lshlrev_b32 v30, 16, v13
    v_and_b32 v31, 0xffff0000, v13
    v_lshlrev_b32 v32, 16, v14
    v_and_b32 v33, 0xffff0000, v14
    v_lshlrev_b32 v34, 16, v15
    v_and_b32 v35, 0xffff0000, v15
    v_lshlrev_b32 v36, 16, v16
    v_and_b32 v37, 0xffff0000, v16
    v_lshlrev_b32 v38, 16, v17
    v_and_b32 v39, 0xffff0000, v17
    s_and_b32 s44, s39, 1
    s_lshl_b32 s44, s44, 3
    s_lshl_b32 s52, 0x11, s44
    s_mov_b32 s53, 0
    s_lshl_b32 s50, s59, 6
    s_add_u32 s50, s50, 786432
    s_lshl_b32 s51, s59, 4
    s_sub_u32 s51, 2047, s51
    s_mov_b32 s48, 0xffff
    v_lshlrev_b32 v7, 2, v1
    v_mov_b32 v58, s32
    v_mov_b32 v59, s32
    v_and_b32 v76, 15, v1
    v_sub_u32 v76, s51, v76
    s_lshl_b32 s44, s33, 6
    v_and_b32 v124, 15, v1
    v_lshl_add_u32 v124, v124, 2, s44
    v_lshrrev_b32 v125, 4, v1
    v_lshlrev_b32 v125, 6, v125
    v_add_u32 v124, 98560, v124
    v_add_u32 v125, 98560, v125
    v_lshrrev_b32 v3, 4, v1
    v_lshrrev_b32 v4, 5, v1
    v_and_b32 v5, 1, v3
    v_lshl_add_u32 v74, v5, 1, v4
    v_lshlrev_b32 v74, 4, v74
    v_lshlrev_b32 v75, 3, v3
    s_mov_b32 s58, 50000
    s_branch L_H3_W
L_H3_POLL:
    buffer_load_dwordx4 v[44:47], v242, s[16:19], s56 offen sc1
    buffer_load_dwordx4 v[48:51], v242, s[16:19], s56 offen offset:1024 sc1
L_H3_W:
    s_waitcnt vmcnt(0)
    v_cmp_ne_u32 vcc, s32, v47
    v_cmp_ne_u32 s[44:45], s32, v51
    s_or_b64 vcc, vcc, s[44:45]
    s_cbranch_vccz L_H3_OK
    s_sub_u32 s58, s58, 1
    s_cmp_lg_u32 s58, 0
    s_cbranch_scc1 L_H3_POLL
L_H3_OK:
    v_add_f32 v44, v44, v48
    v_add_f32 v45, v45, v49
    v_add_f32 v46, v46, v50
    v_mov_b32 v2, v44
    v_mov_b32 v3, v45
    v_mov_b32 v4, v46
    v_permlane32_swap_b32 v44, v2
    v_permlane32_swap_b32 v45, v3
    v_permlane32_swap_b32 v46, v4
    v_add_f32 v44, v44, v2
    v_add_f32 v45, v45, v3
    v_add_f32 v46, v46, v4
    v_mov_b32 v2, v44
    v_mov_b32 v3, v45
    v_mov_b32 v4, v46
    v_permlane16_swap_b32 v44, v2
    v_permlane16_swap_b32 v45, v3
    v_permlane16_swap_b32 v46, v4
    v_add_f32 v44, v44, v2
    v_add_f32 v45, v45, v3
    v_add_f32 v46, v46, v4
    v_mul_f32 v60, 0x3acccccd, v44
    v_mov_b32 v2, 0x3727c5ac
    v_fmac_f32 v2, 0x3acccccd, v45
    v_fma_f32 v2, -v60, v60, v2
    v_max_f32 v2, 0x3727c5ac, v2
    v_rsq_f32 v61, v2
    v_fma_f32 v3, -v60, v243, v46
    v_mul_f32 v62, v3, v61
    v_cvt_pk_bf16_f32 v2, v62, v62
    v_ashrrev_i32 v3, 31, v2
    v_or_b32 v3, 0x80008000, v3
    v_xor_b32 v2, v2, v3
    s_lshr_b32 s44, s39, 1
    s_cmp_lg_u32 s44, s33
    s_cbranch_scc1 L_P3_NOPUB
    v_mov_b32_dpp v3, v2 quad_perm:[1,1,3,3] row_mask:0xf bank_mask:0xf
    v_bfi_b32 v56, s48, v2, v3
    s_nop 1
    v_mov_b32_dpp v57, v56 quad_perm:[2,2,2,2] row_mask:0xf bank_mask:0xf
    s_mov_b64 exec, s[52:53]
    buffer_store_dwordx4 v[56:59], v7, s[16:19], s50 offen sc1
    s_mov_b64 exec, -1
L_P3_NOPUB:
    v_lshl_or_b32 v76, v2, 16, v76
    ds_write_b32 v124, v76 offset:9984
    s_waitcnt lgkmcnt(0)
    s_barrier
    ds_read_b128 v[108:111], v125 offset:9984
    ds_read_b128 v[112:115], v125 offset:10000
    ds_read_b128 v[116:119], v125 offset:10016
    ds_read_b128 v[120:123], v125 offset:10032
    v_mul_f32 v6, v60, v61
    v_mov_b32 v4, v61
    v_pk_fma_f32 v[88:89], v[20:21], v[4:5], v[6:7] op_sel_hi:[1,0,0] neg_lo:[0,0,1] neg_hi:[0,0,1]
    v_pk_fma_f32 v[90:91], v[22:23], v[4:5], v[6:7] op_sel_hi:[1,0,0] neg_lo:[0,0,1] neg_hi:[0,0,1]
    v_pk_fma_f32 v[92:93], v[24:25], v[4:5], v[6:7] op_sel_hi:[1,0,0] neg_lo:[0,0,1] neg_hi:[0,0,1]
    v_pk_fma_f32 v[94:95], v[26:27], v[4:5], v[6:7] op_sel_hi:[1,0,0] neg_lo:[0,0,1] neg_hi:[0,0,1]
    v_pk_fma_f32 v[96:97], v[28:29], v[4:5], v[6:7] op_sel_hi:[1,0,0] neg_lo:[0,0,1] neg_hi:[0,0,1]
    v_pk_fma_f32 v[98:99], v[30:31], v[4:5], v[6:7] op_sel_hi:[1,0,0] neg_lo:[0,0,1] neg_hi:[0,0,1]
    v_pk_fma_f32 v[100:101], v[32:33], v[4:5], v[6:7] op_sel_hi:[1,0,0] neg_lo:[0,0,1] neg_hi:[0,0,1]
    v_pk_fma_f32 v[102:103], v[34:35], v[4:5], v[6:7] op_sel_hi:[1,0,0] neg_lo:[0,0,1] neg_hi:[0,0,1]
    v_pk_fma_f32 v[104:105], v[36:37], v[4:5], v[6:7] op_sel_hi:[1,0,0] neg_lo:[0,0,1] neg_hi:[0,0,1]
    v_pk_fma_f32 v[106:107], v[38:39], v[4:5], v[6:7] op_sel_hi:[1,0,0] neg_lo:[0,0,1] neg_hi:[0,0,1]
    v_cvt_pk_bf16_f32 v64, v88, v89
    v_cvt_pk_bf16_f32 v65, v90, v91
    v_cvt_pk_bf16_f32 v66, v92, v93
    v_cvt_pk_bf16_f32 v67, v94, v95
    v_cvt_pk_bf16_f32 v68, v96, v97
    v_cvt_pk_bf16_f32 v69, v98, v99
    v_cvt_pk_bf16_f32 v70, v100, v101
    v_cvt_pk_bf16_f32 v71, v102, v103
    v_cvt_pk_bf16_f32 v72, v104, v105
    v_cvt_pk_bf16_f32 v73, v106, v107
    v_mov_b32 v124, 0
    v_mov_b32 v125, 0
    s_mul_i32 s50, s38, 10240
    s_mul_i32 s51, s39, 160
    s_add_u32 s50, s50, s51
    s_add_u32 s50, s50, 1048576
    s_movk_i32 s51, 1280
    s_waitcnt lgkmcnt(3)
    v_cmp_gt_u32 s[42:43], v108, v76
    v_cmp_gt_u32 s[44:45], v109, v76
    v_cmp_gt_u32 s[46:47], v110, v76
    v_cmp_gt_u32 s[48:49], v111, v76
    v_addc_co_u32 v124, vcc, 0, v124, s[42:43]
    v_addc_co_u32 v125, vcc, 0, v125, s[44:45]
    v_addc_co_u32 v124, vcc, 0, v124, s[46:47]
    v_addc_co_u32 v125, vcc, 0, v125, s[48:49]
    s_waitcnt lgkmcnt(2)
    v_cmp_gt_u32 s[42:43], v112, v76
    v_cmp_gt_u32 s[44:45], v113, v76
    v_cmp_gt_u32 s[46:47], v114, v76
    v_cmp_gt_u32 s[48:49], v115, v76
    v_addc_co_u32 v124, vcc, 0, v124, s[42:43]
    v_addc_co_u32 v125, vcc, 0, v125, s[44:45]
    v_addc_co_u32 v124, vcc, 0, v124, s[46:47]
    v_addc_co_u32 v125, vcc, 0, v125, s[48:49]
    s_waitcnt lgkmcnt(1)
    v_cmp_gt_u32 s[42:43], v116, v76
    v_cmp_gt_u32 s[44:45], v117, v76
    v_cmp_gt_u32 s[46:47], v118, v76
    v_cmp_gt_u32 s[48:49], v119, v76
    v_addc_co_u32 v124, vcc, 0, v124, s[42:43]
    v_addc_co_u32 v125, vcc, 0, v125, s[44:45]
    v_addc_co_u32 v124, vcc, 0, v124, s[46:47]
    v_addc_co_u32 v125, vcc, 0, v125, s[48:49]
    s_waitcnt lgkmcnt(0)
    v_cmp_gt_u32 s[42:43], v120, v76
    v_cmp_gt_u32 s[44:45], v121, v76
    v_cmp_gt_u32 s[46:47], v122, v76
    v_cmp_gt_u32 s[48:49], v123, v76
    v_addc_co_u32 v124, vcc, 0, v124, s[42:43]
    v_addc_co_u32 v125, vcc, 0, v125, s[44:45]
    v_addc_co_u32 v124, vcc, 0, v124, s[46:47]
    v_addc_co_u32 v125, vcc, 0, v125, s[48:49]
    v_add_u32 v124, v124, v125
    v_mov_b32 v125, v124
    s_nop 1
    v_permlane32_swap_b32 v124, v125
    v_add_u32 v124, v124, v125
    v_mov_b32 v125, v124
    s_nop 1
    v_permlane16_swap_b32 v124, v125
    v_add_u32 v124, v124, v125
    v_cmp_gt_u32 vcc, 8, v124
    v_mad_u32_u24 v2, v124, s51, v74
    v_mad_u32_u24 v3, v124, s51, v75
    s_cbranch_vccz L_P3_NC
    s_mov_b64 exec, vcc
    buffer_store_dwordx4 v[64:67], v2, s[16:19], s50 offen offset:0 sc1
    buffer_store_dwordx4 v[68:71], v2, s[16:19], s50 offen offset:64 sc1
    buffer_store_dwordx2 v[72:73], v3, s[16:19], s50 offen offset:128 sc1
    s_mov_b64 exec, -1
L_P3_NC:
    v_pk_add_f32 v[20:21], v[20:21], v[88:89]
    v_pk_add_f32 v[22:23], v[22:23], v[90:91]
    v_pk_add_f32 v[24:25], v[24:25], v[92:93]
    v_pk_add_f32 v[26:27], v[26:27], v[94:95]
    v_pk_add_f32 v[28:29], v[28:29], v[96:97]
    v_pk_add_f32 v[30:31], v[30:31], v[98:99]
    v_pk_add_f32 v[32:33], v[32:33], v[100:101]
    v_pk_add_f32 v[34:35], v[34:35], v[102:103]
    v_pk_add_f32 v[36:37], v[36:37], v[104:105]
    v_pk_add_f32 v[38:39], v[38:39], v[106:107]
    v_cvt_pk_bf16_f32 v8, v20, v21
    v_cvt_pk_bf16_f32 v9, v22, v23
    v_cvt_pk_bf16_f32 v10, v24, v25
    v_cvt_pk_bf16_f32 v11, v26, v27
    v_cvt_pk_bf16_f32 v12, v28, v29
    v_cvt_pk_bf16_f32 v13, v30, v31
    v_cvt_pk_bf16_f32 v14, v32, v33
    v_cvt_pk_bf16_f32 v15, v34, v35
    v_cvt_pk_bf16_f32 v16, v36, v37
    v_cvt_pk_bf16_f32 v17, v38, v39
    s_waitcnt vmcnt(0)
    s_barrier
    s_mul_i32 s50, s39, 768
    s_add_u32 s50, s50, 942080
    s_mov_b32 s51, 6144
    v_lshrrev_b32 v7, 4, v1
    v_lshlrev_b32 v7, 5, v7
    v_mov_b32 v6, 0
    v_mov_b32 v77, 0
    v_mov_b32 v78, 0
    s_barrier
    ds_read_b128 v[108:111], v6 offset:0
    ds_read_b128 v[112:115], v6 offset:16
    ds_read_b128 v[116:119], v6 offset:32
    ds_read_b128 v[120:123], v6 offset:48
    s_waitcnt lgkmcnt(2)
    v_min3_u32 v2, v108, v109, v110
    v_min3_u32 v3, v111, v112, v113
    v_min3_u32 v2, v2, v114, v115
    s_waitcnt lgkmcnt(0)
    v_min3_u32 v4, v116, v117, v118
    v_min3_u32 v5, v119, v120, v121
    v_min3_u32 v4, v4, v122, v123
    v_min_u32 v2, v2, v3
    v_min_u32 v4, v4, v5
    v_max_u32 v2, v2, v4
    v_cmp_le_u32 vcc, v2, v76
    s_not_b64 s[52:53], vcc
    s_cbranch_vccz L_P3_NCL
    s_mov_b64 exec, vcc
    buffer_store_dwordx4 v[8:11], v240, s[20:23], s62 offen offset:0 sc1
    buffer_store_dwordx4 v[12:15], v240, s[20:23], s62 offen offset:64 sc1
    buffer_store_dwordx2 v[16:17], v241, s[20:23], s62 offen offset:128 sc1
L_P3_NCL:
    s_mov_b64 exec, s[52:53]
    buffer_store_dwordx4 v[8:11], v240, s[20:23], s62 offen offset:0
    buffer_store_dwordx4 v[12:15], v240, s[20:23], s62 offen offset:64
    buffer_store_dwordx2 v[16:17], v241, s[20:23], s62 offen offset:128
    s_mov_b64 exec, -1
    s_barrier
    ds_read_b32 v6, v6 offset:64
    ds_read_b128 v[80:83], v7 offset:1024
    ds_read_b128 v[84:87], v7 offset:1040
    s_waitcnt lgkmcnt(1)
    v_cmp_gt_u32 s[42:43], v80, v76
    v_cmp_gt_u32 s[44:45], v81, v76
    v_cmp_gt_u32 s[46:47], v82, v76
    v_cmp_gt_u32 s[48:49], v83, v76
    v_addc_co_u32 v77, vcc, 0, v77, s[42:43]
    v_addc_co_u32 v78, vcc, 0, v78, s[44:45]
    v_addc_co_u32 v77, vcc, 0, v77, s[46:47]
    v_addc_co_u32 v78, vcc, 0, v78, s[48:49]
    s_waitcnt lgkmcnt(0)
    v_cmp_gt_u32 s[42:43], v84, v76
    v_cmp_gt_u32 s[44:45], v85, v76
    v_cmp_gt_u32 s[46:47], v86, v76
    v_cmp_gt_u32 s[48:49], v87, v76
    v_addc_co_u32 v77, vcc, 0, v77, s[42:43]
    v_addc_co_u32 v78, vcc, 0, v78, s[44:45]
    v_addc_co_u32 v77, vcc, 0, v77, s[46:47]
    v_addc_co_u32 v78, vcc, 0, v78, s[48:49]
    v_readfirstlane_b32 s54, v6
    s_cmp_gt_u32 s54, 32
    s_cbranch_scc1 L_RK_GEN
L_RK_DONE:
    v_add_u32 v77, v77, v78
    v_mov_b32 v78, v77
    s_nop 1
    v_permlane32_swap_b32 v77, v78
    v_add_u32 v77, v77, v78
    v_mov_b32 v78, v77
    s_nop 1
    v_permlane16_swap_b32 v77, v78
    v_add_u32 v77, v77, v78
    v_cmp_gt_u32 vcc, 8, v77
    v_mad_u32_u24 v74, v77, s51, v74
    v_mad_u32_u24 v75, v77, s51, v75
    s_not_b64 s[52:53], vcc
    s_mov_b64 s[56:57], vcc
    s_cmp_lg_u32 s40, 1
    s_cbranch_scc1 L_P3_NB
    s_barrier
L_P3_NB:
    s_cbranch_vccz L_P3_NSEL
    s_mov_b64 exec, vcc
    s_waitcnt vmcnt(3)
    buffer_store_dwordx4 v[8:11], v74, s[16:19], s50 offen offset:384 sc1
    buffer_store_dwordx4 v[12:15], v74, s[16:19], s50 offen offset:512 sc1
    buffer_store_dwordx2 v[16:17], v75, s[16:19], s50 offen offset:640 sc1
    s_cmp_lg_u32 s39, 0
    s_cbranch_scc1 L_P3_NK
    s_and_b64 exec, exec, 0xffff
    v_lshlrev_b32 v2, 7, v77
    s_mov_b32 s44, 991232
    buffer_store_dword v76, v2, s[16:19], s44 offen sc1
L_P3_NK:
    s_mov_b64 exec, -1
L_P3_NSEL:
    s_cmp_eq_u32 s40, 2
    s_cbranch_scc1 L_P3_CD
    s_cmp_eq_u32 s40, 1
    s_cbranch_scc1 L_MC_G
    s_branch L_END
L_MC_G:
    s_cmp_eq_u32 s33, 0
    s_cbranch_scc1 L_MC_0
    s_barrier
    s_branch L_END
L_MC_0:
    v_lshrrev_b32 v4, 5, v1
    v_bfe_u32 v5, v1, 1, 1
    v_lshl_add_u32 v4, v4, 1, v5
    v_bfe_u32 v5, v1, 2, 3
    v_lshl_add_u32 v4, v4, 4, v5
    v_and_b32 v5, 1, v1
    v_lshlrev_b32 v5, 3, v5
    v_lshl_add_u32 v4, v4, 4, v5
    v_lshlrev_b32 v5, 2, v1
    s_lshl_b32 s47, s41, 8
    s_add_u32 s47, s47, 917504
    s_barrier
    ds_read_b64 v[128:129], v4 offset:10240
    ds_read_b64 v[130:131], v4 offset:11264
    ds_read_b64 v[132:133], v4 offset:12288
    ds_read_b64 v[134:135], v4 offset:13312
    ds_read_b64 v[136:137], v4 offset:14336
    ds_read_b64 v[138:139], v4 offset:15360
    ds_read_b64 v[140:141], v4 offset:16384
    ds_read_b64 v[142:143], v4 offset:17408
    s_waitcnt lgkmcnt(4)
    v_pk_add_f32 v[128:129], v[128:129], v[130:131]
    v_pk_add_f32 v[132:133], v[132:133], v[134:135]
    v_pk_add_f32 v[128:129], v[128:129], v[132:133]
    v_mul_f32 v130, 0xbfb8aa3b, v128
    v_mul_f32 v131, 0xbfb8aa3b, v129
    v_exp_f32 v130, v130
    v_exp_f32 v131, v131
    s_waitcnt lgkmcnt(0)
    v_pk_add_f32 v[136:137], v[136:137], v[138:139]
    v_pk_add_f32 v[140:141], v[140:141], v[142:143]
    v_add_f32 v130, 1.0, v130
    v_add_f32 v131, 1.0, v131
    v_rcp_f32 v130, v130
    v_rcp_f32 v131, v131
    v_pk_add_f32 v[136:137], v[136:137], v[140:141]
    v_pk_mul_f32 v[128:129], v[128:129], v[136:137]
    v_pk_mul_f32 v[128:129], v[128:129], v[130:131]
    v_cvt_pk_bf16_f32 v128, v128, v129
    buffer_store_dword v128, v5, s[16:19], s47 offen sc1
    s_branch L_END
L_GR2:
    s_mov_b32 s44, s74
    s_mov_b32 s45, s75
    s_mov_b32 s46, 1966080
    s_mov_b32 s47, 0x20000
    s_bitcmp1_b32 s33, 0
    s_cselect_b32 s44, s76, s44
    s_cselect_b32 s45, s77, s45
    s_sub_u32 s49, s35, 18
    s_lshl_b32 s49, s49, 2
    s_add_u32 s49, s49, s33
    s_lshr_b32 s49, s49, 1
    s_mul_i32 s49, s49, 36864
    s_mul_i32 s3, s34, 384
    s_add_u32 s49, s49, s3
    v_min_u32 v59, 35, v1
    v_mul_u32_u24 v60, 86, v59
    v_lshrrev_b32 v60, 8, v60
    v_mul_u32_u24 v61, 3, v60
    v_sub_u32 v59, v59, v61
    v_mul_u32_u24 v60, 3072, v60
    v_lshl_add_u32 v59, v59, 7, v60
    buffer_load_dword v58, v59, s[44:47], s49 offen
    s_branch L_NGR2
    .fill 685, 4, 0xbf800000
L_P3_K:
    s_lshl_b32 s52, s52, 7
    s_add_u32 s52, s52, 262144
    v_mov_b32 v4, s32
    v_mov_b32 v5, 0
    s_waitcnt vmcnt(0)
    s_mov_b64 exec, 1
    s_cmp_eq_u32 s70, 0
    s_cbranch_scc1 LS_7_S
    buffer_store_dword v4, v5, s[16:19], s52 offen
LS_7_D:
    s_mov_b64 exec, -1
    s_barrier
    s_barrier
    s_cmp_lg_u32 s40, 1
    s_cbranch_scc1 L_K_GS1
    s_mov_b32 s44, s74
    s_mov_b32 s45, s75
    s_mov_b32 s46, 1966080
    s_mov_b32 s47, 0x20000
    s_add_u32 s3, s61, 0
    buffer_load_dwordx4 v[176:179], v247, s[24:27], s3 offen
L_K_GS1:
    s_cmp_eq_u32 s40, 0
    s_cbranch_scc1 L_GR2
L_NGR2:
    s_sub_u32 s49, s35, 18
    s_lshl_b32 s49, s49, 2
    s_add_u32 s49, s49, s33
    s_mul_i32 s49, s49, 33280
    s_mul_i32 s3, s34, 160
    s_and_b32 s3, s3, 0xffffff80
    s_add_u32 s49, s49, s3
    v_min_u32 v249, 51, v1
    v_lshrrev_b32 v3, 1, v249
    v_mul_u32_u24 v3, 1280, v3
    v_and_b32 v249, 1, v249
    v_lshl_add_u32 v249, v249, 7, v3
    s_cmp_lg_u32 s40, 0
    s_cbranch_scc1 L_NDPF
    s_mov_b32 s44, s78
    s_mov_b32 s45, s79
    s_mov_b32 s46, 1966080
    s_mov_b32 s47, 0x20000
    buffer_load_dword v250, v249, s[44:47], s49 offen
L_NDPF:
    s_cmp_lg_u32 s40, 1
    s_cbranch_scc1 L_K_GS2
    s_mov_b32 s44, s74
    s_mov_b32 s45, s75
    s_mov_b32 s46, 1966080
    s_mov_b32 s47, 0x20000
    s_waitcnt vmcnt(2)
    s_add_u32 s3, s61, 0
    buffer_load_dwordx4 v[196:199], v247, s[44:47], s3 offen
    s_waitcnt vmcnt(2)
    s_add_u32 s3, s61, 98304
    buffer_load_dwordx4 v[180:183], v247, s[24:27], s3 offen
    s_waitcnt vmcnt(2)
    s_add_u32 s3, s61, 98304
    buffer_load_dwordx4 v[200:203], v247, s[44:47], s3 offen
    s_waitcnt vmcnt(2)
    s_add_u32 s3, s61, 196608
    buffer_load_dwordx4 v[184:187], v247, s[24:27], s3 offen
    s_waitcnt vmcnt(2)
    s_add_u32 s3, s61, 196608
    buffer_load_dwordx4 v[204:207], v247, s[44:47], s3 offen
    s_waitcnt vmcnt(2)
    s_add_u32 s3, s61, 294912
    buffer_load_dwordx4 v[188:191], v247, s[24:27], s3 offen
    s_waitcnt vmcnt(2)
    s_add_u32 s3, s61, 294912
    buffer_load_dwordx4 v[208:211], v247, s[44:47], s3 offen
    s_waitcnt vmcnt(2)
    s_add_u32 s3, s61, 393216
    buffer_load_dwordx4 v[192:195], v247, s[24:27], s3 offen
    s_waitcnt vmcnt(2)
    s_add_u32 s3, s61, 393216
    buffer_load_dwordx4 v[212:215], v247, s[44:47], s3 offen
L_K_GS2:
    s_cmp_lg_u32 s40, 2
    s_cbranch_scc1 L_K_DS2
    s_mov_b32 s28, s78
    s_mov_b32 s29, s79
    s_mov_b32 s30, 1966080
    s_mov_b32 s31, 0x20000
    v_lshrrev_b32 v246, 1, v1
    v_mul_u32_u24 v246, 1280, v246
    v_and_b32 v251, 1, v1
    v_lshl_add_u32 v246, v251, 4, v246
    s_mul_i32 s44, s33, 7680
    s_waitcnt vmcnt(0)
    s_add_u32 m0, s44, 102400
    s_add_u32 s45, s61, 0
    buffer_load_dwordx4 v246, s[28:31], s45 offen lds
    s_waitcnt vmcnt(0)
    s_add_u32 m0, s44, 103424
    s_add_u32 s45, s61, 40960
    buffer_load_dwordx4 v246, s[28:31], s45 offen lds
    s_waitcnt vmcnt(0)
    s_add_u32 m0, s44, 104448
    s_add_u32 s45, s61, 81920
    buffer_load_dwordx4 v246, s[28:31], s45 offen lds
    s_waitcnt vmcnt(0)
    s_add_u32 m0, s44, 105472
    s_add_u32 s45, s61, 122880
    buffer_load_dwordx4 v246, s[28:31], s45 offen lds
    s_waitcnt vmcnt(0)
    s_add_u32 m0, s44, 106496
    s_add_u32 s45, s61, 163840
    buffer_load_dwordx4 v246, s[28:31], s45 offen lds
    s_waitcnt vmcnt(0)
    s_add_u32 m0, s44, 107520
    s_add_u32 s45, s61, 204800
    buffer_load_dwordx4 v246, s[28:31], s45 offen lds
L_K_DS2:
    v_lshrrev_b32 v5, 3, v1
    v_xor_b32 v5, v5, v1
    v_and_b32 v5, 7, v5
    v_lshlrev_b32 v217, 4, v5
    s_mul_i32 s57, s33, 3072
    s_add_u32 s57, s57, 8192
    v_and_b32 v4, 7, v1
    v_lshrrev_b32 v5, 4, v1
    v_xor_b32 v5, v5, v4
    v_lshl_add_u32 v4, v4, 7, s57
    v_lshl_add_u32 v218, v5, 4, v4
    v_xor_b32 v54, 64, v218
    v_and_b32 v48, 31, v1
    v_lshlrev_b32 v48, 2, v48
    v_lshrrev_b32 v49, 5, v1
    v_lshlrev_b32 v49, 6, v49
    s_lshl_b32 s60, s33, 5
    s_add_u32 s60, s60, 9600
    v_and_b32 v51, 7, v1
    v_lshl_add_u32 v51, v51, 2, s60
    v_lshrrev_b32 v50, 3, v1
    v_lshl_add_u32 v50, v50, 2, s60
    v_mov_b32 v2, 0
    v_lshlrev_b32 v3, 2, v1
    v_mov_b32 v52, v3
    s_sub_u32 s42, s33, 4
    s_lshl_b32 s43, s42, 9
    s_sub_u32 s43, 2047, s43
    v_sub_u32 v24, s43, v3
    v_subrev_u32 v25, 1, v24
    v_subrev_u32 v26, 2, v24
    v_subrev_u32 v27, 3, v24
    v_subrev_u32 v28, 256, v24
    v_subrev_u32 v29, 257, v24
    v_subrev_u32 v30, 258, v24
    v_subrev_u32 v31, 259, v24
    s_lshl_b32 s43, s42, 11
    s_add_u32 s43, s43, 786432
    v_lshlrev_b32 v4, 4, v1
    s_mov_b32 s48, 0xffff0000
    v_lshrrev_b32 v5, 3, v1
    v_lshlrev_b32 v5, 2, v5
    v_and_b32 v6, 7, v1
    v_lshlrev_b32 v6, 2, v6
    v_mov_b32 v7, 1
    s_waitcnt lgkmcnt(0)
    s_barrier
    ds_write_b32 v52, v2
    ds_write_b32 v52, v2 offset:1024
    s_waitcnt lgkmcnt(0)
    v_mov_b32 v53, v4
    s_mul_i32 s42, s33, 7680
    s_add_u32 s42, s42, 102400
    v_lshl_add_u32 v2, v1, 4, s42
    v_lshrrev_b32 v3, 4, v1
    v_bfe_u32 v4, v1, 2, 2
    v_lshl_add_u32 v3, v3, 3, v4
    v_and_b32 v4, 3, v1
    v_lshlrev_b32 v4, 3, v4
    v_lshl_add_u32 v3, v3, 5, v4
    v_add_u32 v3, s42, v3
    s_cmp_lg_u32 s40, 1
    s_cbranch_scc1 GB_8
    s_waitcnt vmcnt(0)
    ds_write_b128 v2, v[176:179] offset:0
    ds_write_b128 v2, v[180:183] offset:1024
    ds_write_b128 v2, v[184:187] offset:2048
    ds_write_b128 v2, v[188:191] offset:3072
    ds_write_b128 v2, v[192:195] offset:4096
    s_waitcnt lgkmcnt(0)
    ds_read_b64_tr_b16 v[176:177], v3 offset:0
    ds_read_b64_tr_b16 v[178:179], v3 offset:128
    ds_read_b64_tr_b16 v[180:181], v3 offset:1024
    ds_read_b64_tr_b16 v[182:183], v3 offset:1152
    ds_read_b64_tr_b16 v[184:185], v3 offset:2048
    ds_read_b64_tr_b16 v[186:187], v3 offset:2176
    ds_read_b64_tr_b16 v[188:189], v3 offset:3072
    ds_read_b64_tr_b16 v[190:191], v3 offset:3200
    ds_read_b64_tr_b16 v[192:193], v3 offset:4096
    ds_read_b64_tr_b16 v[194:195], v3 offset:4224
    ds_write_b128 v2, v[196:199] offset:0
    ds_write_b128 v2, v[200:203] offset:1024
    ds_write_b128 v2, v[204:207] offset:2048
    ds_write_b128 v2, v[208:211] offset:3072
    ds_write_b128 v2, v[212:215] offset:4096
    s_waitcnt lgkmcnt(0)
    ds_read_b64_tr_b16 v[196:197], v3 offset:0
    ds_read_b64_tr_b16 v[198:199], v3 offset:128
    ds_read_b64_tr_b16 v[200:201], v3 offset:1024
    ds_read_b64_tr_b16 v[202:203], v3 offset:1152
    ds_read_b64_tr_b16 v[204:205], v3 offset:2048
    ds_read_b64_tr_b16 v[206:207], v3 offset:2176
    ds_read_b64_tr_b16 v[208:209], v3 offset:3072
    ds_read_b64_tr_b16 v[210:211], v3 offset:3200
    ds_read_b64_tr_b16 v[212:213], v3 offset:4096
    ds_read_b64_tr_b16 v[214:215], v3 offset:4224
    s_waitcnt lgkmcnt(0)
GB_8:
    v_mov_b32 v2, 0
    v_mov_b32 v4, v53
    s_barrier
    s_mov_b32 s58, 50000
L_H4_POLL:
    buffer_load_dwordx4 v[8:11], v4, s[16:19], s43 offen sc1
    buffer_load_dwordx4 v[12:15], v4, s[16:19], s43 offen offset:1024 sc1
L_H4_W:
    s_waitcnt vmcnt(0)
    v_cmp_ne_u32 vcc, s32, v11
    v_cmp_ne_u32 s[44:45], s32, v15
    s_or_b64 vcc, vcc, s[44:45]
    s_cbranch_vccz L_H4_OK
    s_sub_u32 s58, s58, 1
    s_cmp_lg_u32 s58, 0
    s_cbranch_scc1 L_H4_POLL
L_H4_OK:
    v_lshl_or_b32 v16, v8, 16, v24
    v_and_or_b32 v17, v8, s48, v25
    v_lshl_or_b32 v18, v9, 16, v26
    v_and_or_b32 v19, v9, s48, v27
    v_lshl_or_b32 v20, v12, 16, v28
    v_and_or_b32 v21, v12, s48, v29
    v_lshl_or_b32 v22, v13, 16, v30
    v_and_or_b32 v23, v13, s48, v31
    v_max3_u32 v8, v16, v17, v18
    v_max3_u32 v9, v19, v20, v21
    v_max3_u32 v8, v8, v22, v23
    v_max_u32 v8, v8, v9
    ds_max_u32 v5, v8 offset:0
    ds_max_u32 v6, v8 offset:32
    s_waitcnt lgkmcnt(0)
    s_barrier
    ds_read_b128 v[32:35], v2 offset:0
    ds_read_b128 v[36:39], v2 offset:16
    ds_read_b128 v[40:43], v2 offset:32
    ds_read_b128 v[44:47], v2 offset:48
    s_waitcnt lgkmcnt(2)
    v_min3_u32 v8, v32, v33, v34
    v_min3_u32 v9, v35, v36, v37
    v_min3_u32 v8, v8, v38, v39
    s_waitcnt lgkmcnt(0)
    v_min3_u32 v10, v40, v41, v42
    v_min3_u32 v11, v43, v44, v45
    v_min3_u32 v10, v10, v46, v47
    v_min_u32 v8, v8, v9
    v_min_u32 v10, v10, v11
    v_max_u32 v8, v8, v10
    v_cmp_le_u32 s[42:43], v8, v16
    v_cmp_le_u32 s[44:45], v8, v17
    v_cmp_le_u32 s[46:47], v8, v18
    v_cmp_le_u32 s[48:49], v8, v19
    v_cmp_le_u32 s[50:51], v8, v20
    v_cmp_le_u32 s[52:53], v8, v21
    v_cmp_le_u32 s[54:55], v8, v22
    v_cmp_le_u32 s[56:57], v8, v23
    s_mov_b64 exec, s[42:43]
    ds_add_rtn_u32 v32, v2, v7 offset:64
    s_mov_b64 exec, s[44:45]
    ds_add_rtn_u32 v33, v2, v7 offset:64
    s_mov_b64 exec, s[46:47]
    ds_add_rtn_u32 v34, v2, v7 offset:64
    s_mov_b64 exec, s[48:49]
    ds_add_rtn_u32 v35, v2, v7 offset:64
    s_mov_b64 exec, s[50:51]
    ds_add_rtn_u32 v36, v2, v7 offset:64
    s_mov_b64 exec, s[52:53]
    ds_add_rtn_u32 v37, v2, v7 offset:64
    s_mov_b64 exec, s[54:55]
    ds_add_rtn_u32 v38, v2, v7 offset:64
    s_mov_b64 exec, s[56:57]
    ds_add_rtn_u32 v39, v2, v7 offset:64
    s_waitcnt lgkmcnt(0)
    s_mov_b64 exec, s[42:43]
    v_lshlrev_b32 v32, 2, v32
    ds_write_b32 v32, v16 offset:1024
    s_mov_b64 exec, s[44:45]
    v_lshlrev_b32 v33, 2, v33
    ds_write_b32 v33, v17 offset:1024
    s_mov_b64 exec, s[46:47]
    v_lshlrev_b32 v34, 2, v34
    ds_write_b32 v34, v18 offset:1024
    s_mov_b64 exec, s[48:49]
    v_lshlrev_b32 v35, 2, v35
    ds_write_b32 v35, v19 offset:1024
    s_mov_b64 exec, s[50:51]
    v_lshlrev_b32 v36, 2, v36
    ds_write_b32 v36, v20 offset:1024
    s_mov_b64 exec, s[52:53]
    v_lshlrev_b32 v37, 2, v37
    ds_write_b32 v37, v21 offset:1024
    s_mov_b64 exec, s[54:55]
    v_lshlrev_b32 v38, 2, v38
    ds_write_b32 v38, v22 offset:1024
    s_mov_b64 exec, s[56:57]
    v_lshlrev_b32 v39, 2, v39
    ds_write_b32 v39, v23 offset:1024
    s_mov_b64 exec, -1
    s_waitcnt lgkmcnt(0)
    s_barrier
    s_cmp_eq_u32 s40, 0
    s_cbranch_scc1 L_END
    s_cmp_eq_u32 s40, 2
    s_cbranch_scc1 L_MOE_D
    ds_read_b32 v11, v2 offset:64
    ds_read_b32 v8, v48 offset:1024
    ds_read_b128 v[12:15], v49 offset:1024
    ds_read_b128 v[16:19], v49 offset:1040
    ds_read_b128 v[20:23], v49 offset:1056
    ds_read_b128 v[24:27], v49 offset:1072
    v_mov_b32 v9, 0
    v_mov_b32 v10, 0
    s_sub_u32 s50, s33, 4
    s_lshl_b32 s51, s50, 10
    s_mul_i32 s50, s50, 320
    s_add_u32 s50, s50, 1048576
    s_add_u32 s51, s51, 10240
    v_lshl_add_u32 v55, v1, 4, s51
    s_movk_i32 s51, 1280
    s_mul_i32 s57, s33, 3072
    s_add_u32 s57, s57, 8192
    s_waitcnt lgkmcnt(3)
    v_cmp_gt_u32 s[42:43], v12, v8
    v_cmp_gt_u32 s[44:45], v13, v8
    v_cmp_gt_u32 s[46:47], v14, v8
    v_cmp_gt_u32 s[48:49], v15, v8
    v_addc_co_u32 v9, vcc, 0, v9, s[42:43]
    v_addc_co_u32 v10, vcc, 0, v10, s[44:45]
    v_addc_co_u32 v9, vcc, 0, v9, s[46:47]
    v_addc_co_u32 v10, vcc, 0, v10, s[48:49]
    s_waitcnt lgkmcnt(2)
    v_cmp_gt_u32 s[42:43], v16, v8
    v_cmp_gt_u32 s[44:45], v17, v8
    v_cmp_gt_u32 s[46:47], v18, v8
    v_cmp_gt_u32 s[48:49], v19, v8
    v_addc_co_u32 v9, vcc, 0, v9, s[42:43]
    v_addc_co_u32 v10, vcc, 0, v10, s[44:45]
    v_addc_co_u32 v9, vcc, 0, v9, s[46:47]
    v_addc_co_u32 v10, vcc, 0, v10, s[48:49]
    s_waitcnt lgkmcnt(1)
    v_cmp_gt_u32 s[42:43], v20, v8
    v_cmp_gt_u32 s[44:45], v21, v8
    v_cmp_gt_u32 s[46:47], v22, v8
    v_cmp_gt_u32 s[48:49], v23, v8
    v_addc_co_u32 v9, vcc, 0, v9, s[42:43]
    v_addc_co_u32 v10, vcc, 0, v10, s[44:45]
    v_addc_co_u32 v9, vcc, 0, v9, s[46:47]
    v_addc_co_u32 v10, vcc, 0, v10, s[48:49]
    s_waitcnt lgkmcnt(0)
    v_cmp_gt_u32 s[42:43], v24, v8
    v_cmp_gt_u32 s[44:45], v25, v8
    v_cmp_gt_u32 s[46:47], v26, v8
    v_cmp_gt_u32 s[48:49], v27, v8
    v_addc_co_u32 v9, vcc, 0, v9, s[42:43]
    v_addc_co_u32 v10, vcc, 0, v10, s[44:45]
    v_addc_co_u32 v9, vcc, 0, v9, s[46:47]
    v_addc_co_u32 v10, vcc, 0, v10, s[48:49]
    v_readfirstlane_b32 s54, v11
    s_cmp_gt_u32 s54, 32
    s_cbranch_scc1 L_GR_GEN
    v_add_u32 v9, v9, v10
    v_mov_b32 v10, v9
    s_nop 1
    v_permlane32_swap_b32 v9, v10
    v_add_u32 v9, v9, v10
    v_cmp_gt_u32 vcc, 8, v9
    v_lshl_add_u32 v9, v9, 2, s60
    s_mov_b64 exec, vcc
    ds_write_b32 v9, v8
    s_mov_b64 exec, -1
L_GR_DONE:
    ds_read_b32 v8, v50
    ds_read_b32 v9, v51
    s_waitcnt lgkmcnt(0)
    v_xor_b32 v10, v8, v9
    v_cmp_gt_u32 s[42:43], v9, v8
    v_and_b32 v10, 0x7c0, v10
    v_cmp_eq_u32 vcc, 0, v10
    v_bfe_u32 v8, v8, 6, 5
    s_and_b64 vcc, vcc, s[42:43]
    v_sub_u32 v8, 31, v8
    v_cndmask_b32 v9, 0, 1, vcc
    s_nop 1
    v_add_u32_dpp v9, v9, v9 quad_perm:[1,0,3,2] row_mask:0xf bank_mask:0xf
    s_nop 1
    v_add_u32_dpp v9, v9, v9 quad_perm:[2,3,0,1] row_mask:0xf bank_mask:0xf
    s_nop 1
    v_add_u32_dpp v9, v9, v9 row_half_mirror row_mask:0xf bank_mask:0xf
    v_lshl_add_u32 v8, v8, 3, v9
    v_mad_u32_u24 v217, v8, s51, v217
    s_add_u32 m0, s57, 0
    s_nop 0
    buffer_load_dwordx4 v217, s[16:19], s50 offen offset:0 sc1 lds
    s_add_u32 m0, s57, 896
    s_nop 0
    buffer_load_dwordx4 v217, s[16:19], s50 offen offset:128 sc1 lds
    s_add_u32 m0, s57, 1792
    s_nop 0
    buffer_load_dwordx4 v217, s[16:19], s50 offen offset:256 sc1 lds
    s_barrier
    s_mov_b32 s58, 50000
    s_branch L_H6_W
L_H6:
    s_add_u32 m0, s57, 0
    s_nop 0
    buffer_load_dwordx4 v217, s[16:19], s50 offen offset:0 sc1 lds
    s_add_u32 m0, s57, 896
    s_nop 0
    buffer_load_dwordx4 v217, s[16:19], s50 offen offset:128 sc1 lds
    s_add_u32 m0, s57, 1792
    s_nop 0
    buffer_load_dwordx4 v217, s[16:19], s50 offen offset:256 sc1 lds
L_H6_W:
    s_waitcnt vmcnt(0)
    ds_read_b128 v[128:131], v218 offset:0
    ds_read_b128 v[132:135], v54 offset:0
    ds_read_b128 v[136:139], v218 offset:1024
    ds_read_b128 v[140:143], v54 offset:1024
    ds_read_b128 v[144:147], v218 offset:2048
    s_waitcnt lgkmcnt(4)
    v_mfma_f32_16x16x32_bf16 v[152:155], v[196:199], v[128:131], 0
    v_mfma_f32_16x16x32_bf16 v[156:159], v[176:179], v[128:131], 0
    v_max3_u32 v2, v128, v129, 0
    v_max3_u32 v2, v130, v131, v2
    s_waitcnt lgkmcnt(3)
    v_mfma_f32_16x16x32_bf16 v[152:155], v[200:203], v[132:135], v[152:155]
    v_mfma_f32_16x16x32_bf16 v[156:159], v[180:183], v[132:135], v[156:159]
    v_max3_u32 v2, v132, v133, v2
    v_max3_u32 v2, v134, v135, v2
    s_waitcnt lgkmcnt(2)
    v_mfma_f32_16x16x32_bf16 v[152:155], v[204:207], v[136:139], v[152:155]
    v_mfma_f32_16x16x32_bf16 v[156:159], v[184:187], v[136:139], v[156:159]
    v_max3_u32 v2, v136, v137, v2
    v_max3_u32 v2, v138, v139, v2
    s_waitcnt lgkmcnt(1)
    v_mfma_f32_16x16x32_bf16 v[152:155], v[208:211], v[140:143], v[152:155]
    v_mfma_f32_16x16x32_bf16 v[156:159], v[188:191], v[140:143], v[156:159]
    v_max3_u32 v2, v140, v141, v2
    v_max3_u32 v2, v142, v143, v2
    s_waitcnt lgkmcnt(0)
    v_mfma_f32_16x16x32_bf16 v[152:155], v[212:215], v[144:147], v[152:155]
    v_mfma_f32_16x16x32_bf16 v[156:159], v[192:195], v[144:147], v[156:159]
    v_max3_u32 v2, v144, v145, v2
    v_max3_u32 v2, v146, v147, v2
    v_cmp_eq_u32 vcc, -1, v2
    s_cbranch_vccz L_H6_OK
    s_sub_u32 s58, s58, 1
    s_cmp_lg_u32 s58, 0
    s_cbranch_scc1 L_H6
L_H6_OK:
    s_nop 2
    ds_write_b128 v55, v[152:155]
    ds_write_b128 v55, v[156:159] offset:4096
    s_waitcnt lgkmcnt(0)
    s_barrier
    s_branch L_END
L_P3_CD:
    s_mov_b32 s28, s78
    s_mov_b32 s29, s79
    s_mov_b32 s30, 1966080
    s_mov_b32 s31, 0x20000
    v_lshrrev_b32 v246, 1, v1
    v_mul_u32_u24 v246, 1280, v246
    v_and_b32 v251, 1, v1
    v_lshl_add_u32 v246, v251, 4, v246
    s_mul_i32 s44, s33, 7680
    s_add_u32 m0, s44, 102400
    s_add_u32 s45, s61, 0
    buffer_load_dwordx4 v246, s[28:31], s45 offen lds
    s_add_u32 m0, s44, 103424
    s_add_u32 s45, s61, 40960
    buffer_load_dwordx4 v246, s[28:31], s45 offen lds
    s_add_u32 m0, s44, 104448
    s_add_u32 s45, s61, 81920
    buffer_load_dwordx4 v246, s[28:31], s45 offen lds
    s_add_u32 m0, s44, 105472
    s_add_u32 s45, s61, 122880
    buffer_load_dwordx4 v246, s[28:31], s45 offen lds
    s_add_u32 m0, s44, 106496
    s_add_u32 s45, s61, 163840
    buffer_load_dwordx4 v246, s[28:31], s45 offen lds
    s_add_u32 m0, s44, 107520
    s_add_u32 s45, s61, 204800
    buffer_load_dwordx4 v246, s[28:31], s45 offen lds
L_MOE_D:
    v_lshrrev_b32 v3, 4, v1
    v_and_b32 v4, 7, v1
    v_lshlrev_b32 v5, 4, v4
    v_lshl_add_u32 v54, v3, 7, v5
    s_lshl_b32 s47, s33, 10
    s_add_u32 s47, s47, 10240
    v_lshl_add_u32 v55, v1, 4, s47
    v_mov_b32 v46, 0
    s_mul_i32 s43, s33, 3072
    s_add_u32 s43, s43, 917504
    v_lshlrev_b32 v56, 7, v4
    v_mul_u32_u24 v4, 6144, v4
    v_lshl_add_u32 v57, v3, 3, v4
    v_lshlrev_b32 v58, 3, v3
    s_cmp_lg_u32 s33, 0
    s_cbranch_scc1 L_D_NPRE
    s_mul_i32 s44, s41, 52
    s_lshr_b32 s44, s44, 8
    s_mul_i32 s45, s44, 5
    s_sub_u32 s45, s41, s45
    s_mul_i32 s51, s44, 768
    s_lshr_b32 s44, s45, 1
    s_lshl_b32 s44, s44, 7
    s_and_b32 s45, s45, 1
    s_lshl_b32 s45, s45, 5
    s_add_u32 s51, s51, s44
    s_add_u32 s51, s51, s45
    s_add_u32 s51, s51, 942464
    s_lshl_b32 s50, s41, 5
    s_mov_b32 s46, 991232
    s_mov_b32 s58, 50000
L_H7:
    buffer_load_dword v47, v56, s[16:19], s46 offen sc1
    buffer_load_dwordx2 v[48:49], v57, s[16:19], s51 offen sc1
    s_waitcnt vmcnt(1)
    v_mov_b32 v2, v47
    s_waitcnt vmcnt(0)
    v_max3_u32 v2, v2, v48, v49
    v_cmp_eq_u32 vcc, -1, v2
    s_cbranch_vccz L_H7_OK
    s_sub_u32 s58, s58, 1
    s_cmp_lg_u32 s58, 0
    s_cbranch_scc1 L_H7
L_H7_OK:
    v_and_b32 v46, 0x7ff, v47
    v_sub_u32 v46, 0x7ff, v46
    v_mul_u32_u24 v46, 1280, v46
    v_add_u32 v46, v58, v46
    v_ashrrev_i32 v5, 31, v47
    v_not_b32 v5, v5
    v_or_b32 v5, 0x80000000, v5
    v_xor_b32 v47, v47, v5
    v_and_b32 v47, 0xffff0000, v47
    v_mul_f32 v47, 0xbfb8aa3b, v47
    v_exp_f32 v47, v47
    v_lshlrev_b32 v50, 16, v48
    v_and_b32 v51, 0xffff0000, v48
    v_lshlrev_b32 v52, 16, v49
    v_and_b32 v53, 0xffff0000, v49
    v_add_f32 v47, 1.0, v47
    v_rcp_f32 v47, v47
L_D_NPRE:
    s_mul_i32 s42, s33, 7680
    s_add_u32 s42, s42, 102400
    v_lshl_add_u32 v2, v1, 4, s42
    v_lshrrev_b32 v3, 4, v1
    v_bfe_u32 v4, v1, 2, 2
    v_lshl_add_u32 v3, v3, 3, v4
    v_and_b32 v4, 3, v1
    v_lshlrev_b32 v4, 3, v4
    v_lshl_add_u32 v3, v3, 5, v4
    v_add_u32 v3, s42, v3
    v_bfe_u32 v4, v1, 3, 1
    v_lshl_add_u32 v54, v4, 9, v54
    s_waitcnt vmcnt(0)
    s_barrier
    ds_read_b64_tr_b16 v[176:177], v3 offset:0
    ds_read_b64_tr_b16 v[178:179], v3 offset:128
    ds_read_b64_tr_b16 v[180:181], v3 offset:1024
    ds_read_b64_tr_b16 v[182:183], v3 offset:1152
    ds_read_b64_tr_b16 v[184:185], v3 offset:2048
    ds_read_b64_tr_b16 v[186:187], v3 offset:2176
    ds_read_b64_tr_b16 v[188:189], v3 offset:3072
    ds_read_b64_tr_b16 v[190:191], v3 offset:3200
    ds_read_b64_tr_b16 v[192:193], v3 offset:4096
    ds_read_b64_tr_b16 v[194:195], v3 offset:4224
    ds_read_b64_tr_b16 v[196:197], v3 offset:5120
    ds_read_b64_tr_b16 v[198:199], v3 offset:5248
    s_mov_b32 s58, 50000
L_H5:
    buffer_load_dwordx4 v[128:131], v54, s[16:19], s43 offen offset:0 sc1
    buffer_load_dwordx4 v[132:135], v54, s[16:19], s43 offen offset:1024 sc1
    buffer_load_dwordx4 v[136:139], v54, s[16:19], s43 offen offset:2048 sc1
    s_waitcnt vmcnt(2)
    v_max3_u32 v2, v128, v129, v130
    v_max_u32 v2, v2, v131
    s_waitcnt vmcnt(1)
    v_max3_u32 v2, v2, v132, v133
    v_max3_u32 v2, v2, v134, v135
    s_waitcnt vmcnt(0)
    v_max3_u32 v2, v2, v136, v137
    v_max3_u32 v2, v2, v138, v139
    v_cmp_eq_u32 vcc, -1, v2
    s_cbranch_vccz L_H5_OK
    s_sub_u32 s58, s58, 1
    s_cmp_lg_u32 s58, 0
    s_cbranch_scc1 L_H5
L_H5_OK:
    s_waitcnt lgkmcnt(0)
    v_mfma_f32_16x16x32_bf16 v[152:155], v[176:179], v[128:131], 0
    v_mfma_f32_16x16x32_bf16 v[156:159], v[180:183], v[128:131], 0
    v_mfma_f32_16x16x32_bf16 v[152:155], v[184:187], v[132:135], v[152:155]
    v_mfma_f32_16x16x32_bf16 v[156:159], v[188:191], v[132:135], v[156:159]
    v_mfma_f32_16x16x32_bf16 v[152:155], v[192:195], v[136:139], v[152:155]
    v_mfma_f32_16x16x32_bf16 v[156:159], v[196:199], v[136:139], v[156:159]
    s_nop 7
    v_add_f32_dpp v152, v156, v152 row_ror:8 row_mask:0xf bank_mask:0xf
    v_add_f32_dpp v153, v157, v153 row_ror:8 row_mask:0xf bank_mask:0xf
    v_add_f32_dpp v154, v158, v154 row_ror:8 row_mask:0xf bank_mask:0xf
    v_add_f32_dpp v155, v159, v155 row_ror:8 row_mask:0xf bank_mask:0xf
    ds_write_b128 v55, v[152:155]
    s_waitcnt lgkmcnt(0)
    s_barrier
    s_cmp_lg_u32 s33, 0
    s_cbranch_scc1 L_END
    ds_read_b128 v[88:91], v55 offset:0
    ds_read_b128 v[92:95], v55 offset:1024
    ds_read_b128 v[96:99], v55 offset:2048
    ds_read_b128 v[100:103], v55 offset:3072
    ds_read_b128 v[104:107], v55 offset:4096
    ds_read_b128 v[108:111], v55 offset:5120
    ds_read_b128 v[112:115], v55 offset:6144
    ds_read_b128 v[116:119], v55 offset:7168
    s_waitcnt lgkmcnt(6)
    v_pk_add_f32 v[88:89], v[88:89], v[92:93]
    v_pk_add_f32 v[90:91], v[90:91], v[94:95]
    s_waitcnt lgkmcnt(4)
    v_pk_add_f32 v[96:97], v[96:97], v[100:101]
    v_pk_add_f32 v[98:99], v[98:99], v[102:103]
    s_waitcnt lgkmcnt(2)
    v_pk_add_f32 v[104:105], v[104:105], v[108:109]
    v_pk_add_f32 v[106:107], v[106:107], v[110:111]
    s_waitcnt lgkmcnt(0)
    v_pk_add_f32 v[112:113], v[112:113], v[116:117]
    v_pk_add_f32 v[114:115], v[114:115], v[118:119]
    v_pk_add_f32 v[88:89], v[88:89], v[96:97]
    v_pk_add_f32 v[90:91], v[90:91], v[98:99]
    v_pk_add_f32 v[104:105], v[104:105], v[112:113]
    v_pk_add_f32 v[106:107], v[106:107], v[114:115]
    v_pk_add_f32 v[88:89], v[88:89], v[104:105]
    v_pk_add_f32 v[90:91], v[90:91], v[106:107]
    v_fmac_f32 v50, v47, v88
    v_fmac_f32 v51, v47, v89
    v_fmac_f32 v52, v47, v90
    v_fmac_f32 v53, v47, v91
    v_cvt_pk_bf16_f32 v48, v50, v51
    v_cvt_pk_bf16_f32 v49, v52, v53
    s_mov_b32 exec_lo, 0x00ff00ff
    s_mov_b32 exec_hi, 0x00ff00ff
    buffer_store_dwordx2 v[48:49], v46, s[20:23], s50 offen
    s_cmp_lg_u32 s41, 0
    s_cbranch_scc1 L_END
    s_mov_b64 exec, 1
    v_mov_b32 v2, s32
    v_mov_b32 v3, 0
    buffer_store_dword v2, v3, s[16:19], 0 offen
L_END:
L_EXIT:
    s_endpgm
L_H1_SP0:
    s_mov_b64 exec, 15
L_H1_SQ:
    buffer_load_dword v161, v3, s[16:19], s59 offen sc1
    s_waitcnt vmcnt(0)
    v_cmp_ne_u32 vcc, s32, v161
    s_cbranch_vccz L_H1_SQ1
    s_sub_u32 s58, s58, 1
    s_cmp_lg_u32 s58, 0
    s_cbranch_scc1 L_H1_SQ
L_H1_SQ1:
    s_mov_b64 exec, -1
    s_mov_b32 s58, 50000
L_H1_SP:
    buffer_load_dword v161, v3, s[16:19], s59 offen sc1
    s_waitcnt vmcnt(0)
    v_cmp_ne_u32 vcc, s32, v161
    s_mov_b32 s63, vcc_lo
    s_and_b32 vcc_lo, vcc_lo, 0xf0f00f0f
    s_cbranch_scc0 L_H1_OK
    s_sub_u32 s58, s58, 1
    s_cmp_lg_u32 s58, 0
    s_cbranch_scc1 L_H1_SP
    s_branch L_H1_OK
LS_4_S:
    buffer_store_dwordx4 v[32:35], v139, s[20:23], s53 offen sc1
    s_mov_b32 exec_hi, 0
    buffer_store_dwordx2 v[36:37], v140, s[20:23], s53 offen offset:1024 sc1
    s_mov_b64 exec, -1
    s_branch LS_4_D
LS_5_S:
    buffer_store_dword v251, v252, s[16:19], s63 offen sc1
    s_branch LS_5_D
L_DY_ST0:
    buffer_load_dword v250, v245, s[16:19], s69 offen sc1
    s_waitcnt vmcnt(0)
    s_sub_u32 s58, s58, 1
    v_cmp_eq_u32 vcc, s32, v250
    s_lshr_b32 s44, vcc_lo, 1
    s_and_b32 s44, s44, vcc_lo
    s_and_b32 s44, s44, s45
    s_cbranch_scc1 L_DY_TK0
    s_cmp_gt_i32 s58, 0
    s_cbranch_scc1 L_DY_ST0
    s_mov_b32 s44, s45
    s_branch L_DY_TK0
L_DY_ST1:
    buffer_load_dword v250, v245, s[16:19], s69 offen sc1
    s_waitcnt vmcnt(0)
    s_sub_u32 s58, s58, 1
    v_cmp_eq_u32 vcc, s32, v250
    s_lshr_b32 s44, vcc_lo, 1
    s_and_b32 s44, s44, vcc_lo
    s_and_b32 s44, s44, s45
    s_cbranch_scc1 L_DY_TK1
    s_cmp_gt_i32 s58, 0
    s_cbranch_scc1 L_DY_ST1
    s_mov_b32 s44, s45
    s_branch L_DY_TK1
L_DY_ST2:
    buffer_load_dword v250, v245, s[16:19], s69 offen sc1
    s_waitcnt vmcnt(0)
    s_sub_u32 s58, s58, 1
    v_cmp_eq_u32 vcc, s32, v250
    s_lshr_b32 s44, vcc_lo, 1
    s_and_b32 s44, s44, vcc_lo
    s_and_b32 s44, s44, s45
    s_cbranch_scc1 L_DY_TK2
    s_cmp_gt_i32 s58, 0
    s_cbranch_scc1 L_DY_ST2
    s_mov_b32 s44, s45
    s_branch L_DY_TK2
L_DY_ST3:
    buffer_load_dword v250, v245, s[16:19], s69 offen sc1
    s_waitcnt vmcnt(0)
    s_sub_u32 s58, s58, 1
    v_cmp_eq_u32 vcc, s32, v250
    s_lshr_b32 s44, vcc_lo, 1
    s_and_b32 s44, s44, vcc_lo
    s_and_b32 s44, s44, s45
    s_cbranch_scc1 L_DY_TK3
    s_cmp_gt_i32 s58, 0
    s_cbranch_scc1 L_DY_ST3
    s_mov_b32 s44, s45
    s_branch L_DY_TK3
L_DY_ST4:
    buffer_load_dword v250, v245, s[16:19], s69 offen sc1
    s_waitcnt vmcnt(0)
    s_sub_u32 s58, s58, 1
    v_cmp_eq_u32 vcc, s32, v250
    s_lshr_b32 s44, vcc_lo, 1
    s_and_b32 s44, s44, vcc_lo
    s_and_b32 s44, s44, s45
    s_cbranch_scc1 L_DY_TK4
    s_cmp_gt_i32 s58, 0
    s_cbranch_scc1 L_DY_ST4
    s_mov_b32 s44, s45
    s_branch L_DY_TK4
L_DY_ST5:
    buffer_load_dword v250, v245, s[16:19], s69 offen sc1
    s_waitcnt vmcnt(0)
    s_sub_u32 s58, s58, 1
    v_cmp_eq_u32 vcc, s32, v250
    s_lshr_b32 s44, vcc_lo, 1
    s_and_b32 s44, s44, vcc_lo
    s_and_b32 s44, s44, s45
    s_cbranch_scc1 L_DY_TK5
    s_cmp_gt_i32 s58, 0
    s_cbranch_scc1 L_DY_ST5
    s_mov_b32 s44, s45
    s_branch L_DY_TK5
L_DY_ST6:
    buffer_load_dword v250, v245, s[16:19], s69 offen sc1
    s_waitcnt vmcnt(0)
    s_sub_u32 s58, s58, 1
    v_cmp_eq_u32 vcc, s32, v250
    s_lshr_b32 s44, vcc_lo, 1
    s_and_b32 s44, s44, vcc_lo
    s_and_b32 s44, s44, s45
    s_cbranch_scc1 L_DY_TK6
    s_cmp_gt_i32 s58, 0
    s_cbranch_scc1 L_DY_ST6
    s_mov_b32 s44, s45
    s_branch L_DY_TK6
L_DY_ST7:
    buffer_load_dword v250, v245, s[16:19], s69 offen sc1
    s_waitcnt vmcnt(0)
    s_sub_u32 s58, s58, 1
    v_cmp_eq_u32 vcc, s32, v250
    s_lshr_b32 s44, vcc_lo, 1
    s_and_b32 s44, s44, vcc_lo
    s_and_b32 s44, s44, s45
    s_cbranch_scc1 L_DY_TK7
    s_cmp_gt_i32 s58, 0
    s_cbranch_scc1 L_DY_ST7
    s_mov_b32 s44, s45
    s_branch L_DY_TK7
LS_6_S:
    buffer_store_dwordx4 v[40:43], v242, s[16:19], s57 offen sc1
    s_branch LS_6_D
L_RK_GEN:
    v_add_u32 v3, s54, v1
    v_lshlrev_b32 v3, 2, v3
    v_mov_b32 v2, 0
    ds_write_b32 v3, v2 offset:1024
    s_mov_b32 s55, 32
L_RK_G1:
    v_add_u32 v7, 128, v7
    ds_read_b128 v[80:83], v7 offset:1024
    ds_read_b128 v[84:87], v7 offset:1040
    s_waitcnt lgkmcnt(1)
    v_cmp_gt_u32 s[42:43], v80, v76
    v_cmp_gt_u32 s[44:45], v81, v76
    v_cmp_gt_u32 s[46:47], v82, v76
    v_cmp_gt_u32 s[48:49], v83, v76
    v_addc_co_u32 v77, vcc, 0, v77, s[42:43]
    v_addc_co_u32 v78, vcc, 0, v78, s[44:45]
    v_addc_co_u32 v77, vcc, 0, v77, s[46:47]
    v_addc_co_u32 v78, vcc, 0, v78, s[48:49]
    s_waitcnt lgkmcnt(0)
    v_cmp_gt_u32 s[42:43], v84, v76
    v_cmp_gt_u32 s[44:45], v85, v76
    v_cmp_gt_u32 s[46:47], v86, v76
    v_cmp_gt_u32 s[48:49], v87, v76
    v_addc_co_u32 v77, vcc, 0, v77, s[42:43]
    v_addc_co_u32 v78, vcc, 0, v78, s[44:45]
    v_addc_co_u32 v77, vcc, 0, v77, s[46:47]
    v_addc_co_u32 v78, vcc, 0, v78, s[48:49]
    s_add_u32 s55, s55, 32
    s_cmp_lt_u32 s55, s54
    s_cbranch_scc1 L_RK_G1
    s_branch L_RK_DONE
LS_7_S:
    buffer_store_dword v4, v5, s[16:19], s52 offen sc1
    s_branch LS_7_D
L_GR_GEN:
    v_add_u32 v3, s54, v1
    v_lshlrev_b32 v3, 2, v3
    v_mov_b32 v4, 0
    ds_write_b32 v3, v4 offset:1024
    s_mov_b32 s55, 0
    v_mov_b32 v5, v49
L_GR_G1:
    s_mov_b32 s56, 0
    v_mov_b32 v9, 0
    v_mov_b32 v10, 0
    v_mov_b32 v49, v5
L_GR_G2:
    ds_read_b32 v8, v48 offset:1024
    ds_read_b128 v[12:15], v49 offset:1024
    ds_read_b128 v[16:19], v49 offset:1040
    ds_read_b128 v[20:23], v49 offset:1056
    ds_read_b128 v[24:27], v49 offset:1072
    s_waitcnt lgkmcnt(3)
    v_cmp_gt_u32 s[42:43], v12, v8
    v_cmp_gt_u32 s[44:45], v13, v8
    v_cmp_gt_u32 s[46:47], v14, v8
    v_cmp_gt_u32 s[48:49], v15, v8
    v_addc_co_u32 v9, vcc, 0, v9, s[42:43]
    v_addc_co_u32 v10, vcc, 0, v10, s[44:45]
    v_addc_co_u32 v9, vcc, 0, v9, s[46:47]
    v_addc_co_u32 v10, vcc, 0, v10, s[48:49]
    s_waitcnt lgkmcnt(2)
    v_cmp_gt_u32 s[42:43], v16, v8
    v_cmp_gt_u32 s[44:45], v17, v8
    v_cmp_gt_u32 s[46:47], v18, v8
    v_cmp_gt_u32 s[48:49], v19, v8
    v_addc_co_u32 v9, vcc, 0, v9, s[42:43]
    v_addc_co_u32 v10, vcc, 0, v10, s[44:45]
    v_addc_co_u32 v9, vcc, 0, v9, s[46:47]
    v_addc_co_u32 v10, vcc, 0, v10, s[48:49]
    s_waitcnt lgkmcnt(1)
    v_cmp_gt_u32 s[42:43], v20, v8
    v_cmp_gt_u32 s[44:45], v21, v8
    v_cmp_gt_u32 s[46:47], v22, v8
    v_cmp_gt_u32 s[48:49], v23, v8
    v_addc_co_u32 v9, vcc, 0, v9, s[42:43]
    v_addc_co_u32 v10, vcc, 0, v10, s[44:45]
    v_addc_co_u32 v9, vcc, 0, v9, s[46:47]
    v_addc_co_u32 v10, vcc, 0, v10, s[48:49]
    s_waitcnt lgkmcnt(0)
    v_cmp_gt_u32 s[42:43], v24, v8
    v_cmp_gt_u32 s[44:45], v25, v8
    v_cmp_gt_u32 s[46:47], v26, v8
    v_cmp_gt_u32 s[48:49], v27, v8
    v_addc_co_u32 v9, vcc, 0, v9, s[42:43]
    v_addc_co_u32 v10, vcc, 0, v10, s[44:45]
    v_addc_co_u32 v9, vcc, 0, v9, s[46:47]
    v_addc_co_u32 v10, vcc, 0, v10, s[48:49]
    v_add_u32 v49, 128, v49
    s_add_u32 s56, s56, 32
    s_cmp_lt_u32 s56, s54
    s_cbranch_scc1 L_GR_G2
    v_add_u32 v9, v9, v10
    v_mov_b32 v10, v9
    s_nop 1
    v_permlane32_swap_b32 v9, v10
    v_add_u32 v9, v9, v10
    v_cmp_gt_u32 vcc, 8, v9
    v_lshl_add_u32 v9, v9, 2, s60
    s_mov_b64 exec, vcc
    ds_write_b32 v9, v8
    s_mov_b64 exec, -1
    v_add_u32 v48, 128, v48
    s_add_u32 s55, s55, 32
    s_cmp_lt_u32 s55, s54
    s_cbranch_scc1 L_GR_G1
    s_branch L_GR_DONE
L_CODE_END:
    s_endpgm
.section .rodata,"a"
.p2align 6
.amdhsa_kernel sequential_preLN__sliding_block__moe_arch_mod__prompt_kernel
  .amdhsa_next_free_vgpr 256
  .amdhsa_next_free_sgpr 102
  .amdhsa_accum_offset 256
  .amdhsa_group_segment_fixed_size 0
  .amdhsa_kernarg_size 88
  .amdhsa_user_sgpr_count 2
  .amdhsa_user_sgpr_kernarg_segment_ptr 1
  .amdhsa_system_sgpr_workgroup_id_x 1
.end_amdhsa_kernel
```
